```python
import torch

def _softmax(x, axis=-1):
    return torch.softmax(x, dim=axis)
def _gelu(x):
    return torch.nn.functional.gelu(x, approximate="tanh")
def _silu(x):
    return torch.nn.functional.silu(x)
def _sigmoid(x):
    return torch.sigmoid(x)
def _layernorm(x, axis=-1, eps=1e-5):
    m = x.mean(dim=axis, keepdim=True)
    v = x.var(dim=axis, keepdim=True, unbiased=False)
    return (x - m) / torch.sqrt(v + eps)
def _scatter_add(tgt, idx, src, axis=0):
    return tgt.clone().index_add_(axis, idx, src)
def _segment_sum(src, seg, n):
    out = torch.zeros((n,) + src.shape[1:], dtype=src.dtype)
    return out.index_add_(0, seg, src)
def _pad(x, pw):
    flat = tuple(v for pair in reversed(pw) for v in pair)
    return torch.nn.functional.pad(x, flat)

kernel_name = 'standalone__weight_only_int_quip__prompt'

def setup_inputs():

    _w = (lambda a: (lambda t: t.to(torch.bfloat16) if t.is_floating_point() else t)(torch.as_tensor(a)))
    B, S, D, F = 1, 2048, 1024, 3584
    G = 128 if 128 > 0 else D
    D = (D // G) * G
    ng = D // G
    bits = 3 if 3 > 0 else 4
    qmax = 1 << bits
    qw = torch.randint(0, qmax, (D, F)).to(torch.int32)
    U, _ = (lambda *_a, **_k: torch.linalg.qr(*[torch.as_tensor(_x).float() for _x in _a], **_k))((lambda *s: torch.randn(*s, dtype=torch.bfloat16) * 0.05)(D, D))
    V, _ = (lambda *_a, **_k: torch.linalg.qr(*[torch.as_tensor(_x).float() for _x in _a], **_k))((lambda *s: torch.randn(*s, dtype=torch.bfloat16) * 0.05)(F, F))
    return {
        "x": _w((lambda *s: torch.randn(*s, dtype=torch.bfloat16) * 0.05)(B, S, D)),
        "qw": _w(qw),
        "scales": _w(torch.abs((lambda *s: torch.randn(*s, dtype=torch.bfloat16) * 0.05)(ng, F)) * 0.02 + 0.005),
        "zeros": _w(torch.full((ng, F), qmax / 2.0, dtype=float)),
        "U": _w(U.to(float)),
        "V": _w(V.to(float)),
    }

def reference(x, qw, scales, zeros, U, V):
    B, S, D = x.shape
    ng, F = scales.shape
    G = D // ng
    s = (lambda x, n, axis: torch.repeat_interleave(x, n, dim=axis))(scales, G, axis=0)
    z = (lambda x, n, axis: torch.repeat_interleave(x, n, dim=axis))(zeros, G, axis=0)
    wq = ((lambda x, dt: x.to(dt))(qw, x.dtype) - z) * s
    xr = torch.einsum("bsd,de->bse", x, U)
    h  = torch.einsum("bse,ef->bsf", xr, wq)
    y  = torch.einsum("bsf,fg->bsg", h, V)
    return y
```

```asm
; @launch grid=(256,1,1) block=(256,1,1) lds=163840
.amdgcn_target "amdgcn-amd-amdhsa--gfx950"
.text
.macro MA d, a, b
v_mfma_f32_16x16x32_bf16 v[\d:\d+3], a[\a:\a+3], v[\b:\b+3], v[\d:\d+3]
.endm
.macro MB d, a, b
v_mfma_f32_16x16x32_bf16 v[\d:\d+3], v[\a:\a+3], a[\b:\b+3], v[\d:\d+3]
.endm
.macro TR d, p, o
ds_read_b64_tr_b16 v[\d:\d+1], v\p offset:\o
.endm
.macro LW n
s_waitcnt lgkmcnt(\n)
.endm
.globl standalone__weight_only_int_quip__prompt_kernel
.p2align 8
.type standalone__weight_only_int_quip__prompt_kernel,@function
standalone__weight_only_int_quip__prompt_kernel:
    s_cmp_ge_u32 s2, 256
    s_cbranch_scc0 L_go
L_exit0:
    s_endpgm
L_go:
    s_load_dwordx16 s[64:79], s[0:1], 0
    s_load_dwordx2 s[80:81], s[0:1], 64
    s_memrealtime s[82:83]
    s_getpc_b64 s[24:25]
L_pc0:
    s_mov_b32 s26, L_codeend-L_pc0
    s_mov_b32 s27, 0x00020000
    s_lshr_b32 s84, s2, 3
    s_cmp_ge_u32 s84, 16
    s_cselect_b32 s85, L_g1-L_pc0-8192, 0
    s_mul_i32 s84, s84, 512
    s_add_u32 s84, s84, s85
    v_min_u32 v254, 3, v0
    v_lshlrev_b32 v254, 7, v254
    buffer_load_dword v254, v254, s[24:27], s84 offen
    v_lshrrev_b32 v1, 6, v0
    v_and_b32 v0, 63, v0
    s_and_b32 s33, s2, 7
    v_readfirstlane_b32 s32, v1
    s_lshr_b32 s34, s2, 3
    s_and_b32 s84, s34, 3
    s_lshl_b32 s84, s84, 1
    s_and_b32 s85, s33, 1
    s_add_u32 s35, s84, s85
    s_lshr_b32 s84, s33, 1
    s_mul_i32 s84, s84, 7
    s_lshr_b32 s85, s34, 2
    s_add_u32 s36, s84, s85
    s_lshl_b32 s38, s32, 12
    s_and_b32 s84, s33, 1
    s_lshl_b32 s84, s84, 3
    s_and_b32 s85, s34, 7
    s_add_u32 s60, s84, s85
    s_lshr_b32 s84, s33, 1
    s_lshl_b32 s84, s84, 2
    s_lshr_b32 s85, s34, 3
    s_add_u32 s61, s84, s85
    v_lshlrev_b32 v29, 3, v0
    s_mov_b32 s100, 0
    s_mov_b32 s63, 0
LW 0
    s_mov_b32 s4, s74
    s_mov_b32 s5, s75
    s_mov_b32 s6, 0x1880000
    s_mov_b32 s7, 0x00020000
    s_mov_b32 s8, s80
    s_mov_b32 s9, s81
    s_mov_b32 s10, 0x2200000
    s_mov_b32 s11, 0x00020000
    s_mov_b32 s12, s76
    s_mov_b32 s13, s77
    s_mov_b32 s14, 0xe00000
    s_mov_b32 s15, 0x00020000
    s_mov_b64 s[98:99], s[76:77]
    s_mov_b32 s28, s78
    s_mov_b32 s29, s79
    s_mov_b32 s30, 0x100
    s_mov_b32 s31, 0x00020000
    s_or_b32 s39, s2, s32
    s_cmp_lg_u32 s39, 0
    s_cbranch_scc1 L_nononce
    v_mov_b32 v2, s82
    v_mov_b32 v3, s83
    v_or_b32 v3, 0x40000000, v3
    s_mov_b64 exec, 0xffff
    buffer_store_dwordx2 v[2:3], v29, s[28:31], 0 offen sc1
    s_mov_b64 exec, -1
L_nononce:
    s_cmp_ge_u32 s34, 28
    s_cbranch_scc1 L_g1
    s_cmp_eq_u32 s32, 0
    s_cselect_b32 s100, 1, 0
    s_cmp_ge_u32 s34, 12
    s_cselect_b32 s84, 1, 0
    s_cselect_b32 s85, 12, 0
    s_sub_u32 s85, s34, s85
    s_lshl_b32 s39, s32, 1
    s_add_u32 s84, s84, s39
    s_cmp_lt_u32 s85, 8
    s_cselect_b32 s12, s64, s72
    s_cselect_b32 s13, s65, s73
    s_mov_b32 s39, 2097152
    s_cselect_b32 s14, 4194304, s39
    s_cbranch_scc0 L_pfu
    s_lshl_b32 s39, s33, 3
    s_add_u32 s85, s85, s39
    s_lshl_b32 s85, s85, 16
    s_lshl_b32 s84, s84, 8
    s_add_u32 s85, s85, s84
    v_lshrrev_b32 v1, 1, v0
    v_and_b32 v2, 1, v0
    v_lshlrev_b32 v1, 11, v1
    v_lshl_add_u32 v15, v2, 7, v1
    s_branch L_pfj
L_pfu:
    s_cmp_ge_u32 s85, 12
    s_cselect_b32 s14, 0, s14
    s_sub_u32 s85, s85, 8
    s_lshl_b32 s85, s85, 13
    s_lshl_b32 s84, s84, 18
    s_add_u32 s85, s85, s84
    s_lshl_b32 s84, s33, 15
    s_add_u32 s85, s85, s84
    v_lshlrev_b32 v15, 7, v0
L_pfj:
    v_add_u32 v15, s85, v15
    s_sub_u32 s39, s32, 0
    s_cmp_ge_u32 s39, 2
    s_cbranch_scc1 L_nog1
    buffer_load_dword v15, v15, s[12:15], 0 offen
L_nog1:
    s_sub_u32 s84, s32, 1
    s_cmp_ge_u32 s84, 1
    s_cbranch_scc1 L_nogu
    s_mov_b32 s16, s72
    s_mov_b32 s17, s73
    s_mov_b32 s18, 0x200000
    s_mov_b32 s19, 0x00020000
    s_lshl_b32 s85, s33, 2
    s_add_u32 s85, s85, s34
    s_add_u32 s85, s85, 4
    s_and_b32 s85, s85, 31
    s_lshl_b32 s84, s84, 5
    s_add_u32 s85, s85, s84
    s_lshl_b32 s85, s85, 13
    v_lshlrev_b32 v253, 7, v0
    buffer_load_dword v253, v253, s[16:19], s85 offen
L_nogu:
    s_mov_b32 s16, s66
    s_mov_b32 s17, s67
    s_mov_b32 s18, 0xe00000
    s_mov_b32 s19, 0x00020000
    s_mov_b32 s20, s68
    s_mov_b32 s21, s69
    s_mov_b32 s22, 0xe000
    s_mov_b32 s23, 0x00020000
    s_mov_b32 s24, s70
    s_mov_b32 s25, s71
    s_mov_b32 s26, 0xe000
    s_mov_b32 s27, 0x00020000
    s_lshl_b32 s59, s35, 2
    s_add_u32 s59, s59, s32
    s_cmp_ge_u32 s36, 14
    s_cselect_b32 s64, 1, 0
    s_cselect_b32 s65, 14, 0
    s_sub_u32 s65, s36, s65
    s_lshl_b32 s66, s35, 1
    s_add_u32 s64, s64, s66
    s_lshl_b32 s66, s64, 4
    s_add_u32 s66, s66, s65
    s_lshl_b32 s66, s66, 9
    s_add_u32 s54, s66, 30408704
    s_lshl_b32 s64, s64, 2
    s_add_u32 s52, s64, s32
    s_and_b32 s64, s65, 1
    s_mul_i32 s64, s64, 28
    s_lshr_b32 s65, s65, 1
    s_add_u32 s53, s64, s65
    s_mul_i32 s64, s52, 229376
    s_lshl_b32 s65, s53, 8
    s_add_u32 s64, s64, s65
    s_add_u32 s65, s64, 114688
    s_add_u32 s66, s64, 3584
    s_add_u32 s67, s65, 3584
    s_mul_i32 s68, s35, 7168
    s_lshl_b32 s39, s53, 7
    s_add_u32 s68, s68, s39
    v_lshrrev_b32 v1, 3, v0
    v_and_b32 v2, 7, v0
    v_mul_u32_u24 v3, 14336, v1
    v_lshl_add_u32 v3, v2, 4, v3
    v_lshrrev_b32 v6, 1, v1
    v_mul_u32_u24 v6, 896, v6
    v_and_b32 v7, 1, v1
    v_lshl_add_u32 v6, v7, 6, v6
    v_lshl_add_u32 v6, v2, 3, v6
    buffer_load_dwordx2 v[16:17], v6, s[20:23], s68 offen
    buffer_load_dwordx2 v[18:19], v6, s[24:27], s68 offen
    buffer_load_dwordx4 v[64:67], v3, s[16:19], s64 offen offset:0 nt
    buffer_load_dwordx4 v[68:71], v3, s[16:19], s64 offen offset:128 nt
    buffer_load_dwordx4 v[72:75], v3, s[16:19], s65 offen offset:0 nt
    buffer_load_dwordx4 v[76:79], v3, s[16:19], s65 offen offset:128 nt
    buffer_load_dwordx4 v[80:83], v3, s[16:19], s64 offen offset:1792 nt
    buffer_load_dwordx4 v[84:87], v3, s[16:19], s64 offen offset:1920 nt
    buffer_load_dwordx4 v[88:91], v3, s[16:19], s65 offen offset:1792 nt
    buffer_load_dwordx4 v[92:95], v3, s[16:19], s65 offen offset:1920 nt
    v_lshrrev_b32 v7, 2, v2
    v_lshlrev_b32 v7, 11, v7
    v_and_b32 v8, 3, v2
    v_lshl_add_u32 v7, v8, 8, v7
    v_lshl_add_u32 v164, v1, 4, v7
    s_lshl_b32 s39, s32, 10
    s_add_u32 s39, s39, 147456
    v_add_u32 v20, s39, v29
    v_lshlrev_b32 v21, 3, v2
    v_add_u32 v21, s39, v21
    s_lshr_b32 s69, s52, 1
    s_mul_i32 s69, s69, 229376
    s_and_b32 s39, s52, 1
    s_lshl_b32 s39, s39, 10
    s_add_u32 s69, s69, s39
    s_lshl_b32 s39, s53, 12
    s_add_u32 s55, s69, s39
    s_mov_b32 s69, 0xffff0000
    s_waitcnt vmcnt(8)
    ds_write_b64 v20, v[16:17]
    ds_write_b64 v20, v[18:19] offset:512
LW 0
    ds_read_b64 v[32:33], v21 offset:0
    ds_read_b64 v[36:37], v21 offset:512
    ds_read_b64 v[34:35], v21 offset:64
    ds_read_b64 v[38:39], v21 offset:576
    ds_read_b64 v[40:41], v21 offset:128
    ds_read_b64 v[44:45], v21 offset:640
    ds_read_b64 v[42:43], v21 offset:192
    ds_read_b64 v[46:47], v21 offset:704
    ds_read_b64 v[48:49], v21 offset:256
    ds_read_b64 v[52:53], v21 offset:768
    ds_read_b64 v[50:51], v21 offset:320
    ds_read_b64 v[54:55], v21 offset:832
    ds_read_b64 v[56:57], v21 offset:384
    ds_read_b64 v[60:61], v21 offset:896
    ds_read_b64 v[58:59], v21 offset:448
    ds_read_b64 v[62:63], v21 offset:960
LW 0
    v_lshlrev_b32 v128, 16, v32
    v_and_b32 v129, s69, v32
    v_lshlrev_b32 v130, 16, v33
    v_and_b32 v131, s69, v33
    v_lshlrev_b32 v132, 16, v34
    v_and_b32 v133, s69, v34
    v_lshlrev_b32 v134, 16, v35
    v_and_b32 v135, s69, v35
    v_lshlrev_b32 v136, 16, v36
    v_and_b32 v137, s69, v36
    v_lshlrev_b32 v138, 16, v37
    v_and_b32 v139, s69, v37
    v_lshlrev_b32 v140, 16, v38
    v_and_b32 v141, s69, v38
    v_lshlrev_b32 v142, 16, v39
    v_and_b32 v143, s69, v39
    s_waitcnt vmcnt(4)
    buffer_load_dwordx4 v[96:99], v3, s[16:19], s66 offen offset:0 nt
    buffer_load_dwordx4 v[100:103], v3, s[16:19], s66 offen offset:128 nt
    buffer_load_dwordx4 v[104:107], v3, s[16:19], s67 offen offset:0 nt
    buffer_load_dwordx4 v[108:111], v3, s[16:19], s67 offen offset:128 nt
    v_cvt_f32_i32 v64, v64
    v_cvt_f32_i32 v65, v65
    v_cvt_f32_i32 v66, v66
    v_cvt_f32_i32 v67, v67
    v_cvt_f32_i32 v68, v68
    v_cvt_f32_i32 v69, v69
    v_cvt_f32_i32 v70, v70
    v_cvt_f32_i32 v71, v71
    v_cvt_pk_bf16_f32 v160, v64, v65
    v_cvt_pk_bf16_f32 v161, v66, v67
    v_cvt_pk_bf16_f32 v162, v68, v69
    v_cvt_pk_bf16_f32 v163, v70, v71
    v_lshlrev_b32 v64, 16, v160
    v_and_b32 v65, s69, v160
    v_lshlrev_b32 v66, 16, v161
    v_and_b32 v67, s69, v161
    v_lshlrev_b32 v68, 16, v162
    v_and_b32 v69, s69, v162
    v_lshlrev_b32 v70, 16, v163
    v_and_b32 v71, s69, v163
    v_pk_add_f32 v[64:65], v[64:65], v[136:137] neg_lo:[0,1] neg_hi:[0,1]
    v_pk_add_f32 v[66:67], v[66:67], v[138:139] neg_lo:[0,1] neg_hi:[0,1]
    v_pk_add_f32 v[68:69], v[68:69], v[140:141] neg_lo:[0,1] neg_hi:[0,1]
    v_pk_add_f32 v[70:71], v[70:71], v[142:143] neg_lo:[0,1] neg_hi:[0,1]
    v_cvt_pk_bf16_f32 v160, v64, v65
    v_cvt_pk_bf16_f32 v161, v66, v67
    v_cvt_pk_bf16_f32 v162, v68, v69
    v_cvt_pk_bf16_f32 v163, v70, v71
    v_lshlrev_b32 v64, 16, v160
    v_and_b32 v65, s69, v160
    v_lshlrev_b32 v66, 16, v161
    v_and_b32 v67, s69, v161
    v_lshlrev_b32 v68, 16, v162
    v_and_b32 v69, s69, v162
    v_lshlrev_b32 v70, 16, v163
    v_and_b32 v71, s69, v163
    v_pk_mul_f32 v[64:65], v[64:65], v[128:129]
    v_pk_mul_f32 v[66:67], v[66:67], v[130:131]
    v_pk_mul_f32 v[68:69], v[68:69], v[132:133]
    v_pk_mul_f32 v[70:71], v[70:71], v[134:135]
    v_cvt_pk_bf16_f32 v216, v64, v65
    v_cvt_pk_bf16_f32 v217, v66, v67
    v_cvt_pk_bf16_f32 v218, v68, v69
    v_cvt_pk_bf16_f32 v219, v70, v71
    buffer_store_dwordx4 v[216:219], v164, s[8:11], s55 offen offset:0 sc1
    v_cvt_f32_i32 v72, v72
    v_cvt_f32_i32 v73, v73
    v_cvt_f32_i32 v74, v74
    v_cvt_f32_i32 v75, v75
    v_cvt_f32_i32 v76, v76
    v_cvt_f32_i32 v77, v77
    v_cvt_f32_i32 v78, v78
    v_cvt_f32_i32 v79, v79
    v_cvt_pk_bf16_f32 v160, v72, v73
    v_cvt_pk_bf16_f32 v161, v74, v75
    v_cvt_pk_bf16_f32 v162, v76, v77
    v_cvt_pk_bf16_f32 v163, v78, v79
    v_lshlrev_b32 v72, 16, v160
    v_and_b32 v73, s69, v160
    v_lshlrev_b32 v74, 16, v161
    v_and_b32 v75, s69, v161
    v_lshlrev_b32 v76, 16, v162
    v_and_b32 v77, s69, v162
    v_lshlrev_b32 v78, 16, v163
    v_and_b32 v79, s69, v163
    v_pk_add_f32 v[72:73], v[72:73], v[136:137] neg_lo:[0,1] neg_hi:[0,1]
    v_pk_add_f32 v[74:75], v[74:75], v[138:139] neg_lo:[0,1] neg_hi:[0,1]
    v_pk_add_f32 v[76:77], v[76:77], v[140:141] neg_lo:[0,1] neg_hi:[0,1]
    v_pk_add_f32 v[78:79], v[78:79], v[142:143] neg_lo:[0,1] neg_hi:[0,1]
    v_cvt_pk_bf16_f32 v160, v72, v73
    v_cvt_pk_bf16_f32 v161, v74, v75
    v_cvt_pk_bf16_f32 v162, v76, v77
    v_cvt_pk_bf16_f32 v163, v78, v79
    v_lshlrev_b32 v72, 16, v160
    v_and_b32 v73, s69, v160
    v_lshlrev_b32 v74, 16, v161
    v_and_b32 v75, s69, v161
    v_lshlrev_b32 v76, 16, v162
    v_and_b32 v77, s69, v162
    v_lshlrev_b32 v78, 16, v163
    v_and_b32 v79, s69, v163
    v_pk_mul_f32 v[72:73], v[72:73], v[128:129]
    v_pk_mul_f32 v[74:75], v[74:75], v[130:131]
    v_pk_mul_f32 v[76:77], v[76:77], v[132:133]
    v_pk_mul_f32 v[78:79], v[78:79], v[134:135]
    v_cvt_pk_bf16_f32 v220, v72, v73
    v_cvt_pk_bf16_f32 v221, v74, v75
    v_cvt_pk_bf16_f32 v222, v76, v77
    v_cvt_pk_bf16_f32 v223, v78, v79
    buffer_store_dwordx4 v[220:223], v164, s[8:11], s55 offen offset:128 sc1
    s_add_u32 s55, s55, 28672
    v_lshlrev_b32 v128, 16, v40
    v_and_b32 v129, s69, v40
    v_lshlrev_b32 v130, 16, v41
    v_and_b32 v131, s69, v41
    v_lshlrev_b32 v132, 16, v42
    v_and_b32 v133, s69, v42
    v_lshlrev_b32 v134, 16, v43
    v_and_b32 v135, s69, v43
    v_lshlrev_b32 v136, 16, v44
    v_and_b32 v137, s69, v44
    v_lshlrev_b32 v138, 16, v45
    v_and_b32 v139, s69, v45
    v_lshlrev_b32 v140, 16, v46
    v_and_b32 v141, s69, v46
    v_lshlrev_b32 v142, 16, v47
    v_and_b32 v143, s69, v47
    s_waitcnt vmcnt(6)
    buffer_load_dwordx2 v[4:5], off, s[28:31], 0 sc1
    buffer_load_dwordx4 v[112:115], v3, s[16:19], s66 offen offset:1792 nt
    buffer_load_dwordx4 v[116:119], v3, s[16:19], s66 offen offset:1920 nt
    buffer_load_dwordx4 v[120:123], v3, s[16:19], s67 offen offset:1792 nt
    buffer_load_dwordx4 v[124:127], v3, s[16:19], s67 offen offset:1920 nt
    v_cvt_f32_i32 v80, v80
    v_cvt_f32_i32 v81, v81
    v_cvt_f32_i32 v82, v82
    v_cvt_f32_i32 v83, v83
    v_cvt_f32_i32 v84, v84
    v_cvt_f32_i32 v85, v85
    v_cvt_f32_i32 v86, v86
    v_cvt_f32_i32 v87, v87
    v_cvt_pk_bf16_f32 v160, v80, v81
    v_cvt_pk_bf16_f32 v161, v82, v83
    v_cvt_pk_bf16_f32 v162, v84, v85
    v_cvt_pk_bf16_f32 v163, v86, v87
    v_lshlrev_b32 v80, 16, v160
    v_and_b32 v81, s69, v160
    v_lshlrev_b32 v82, 16, v161
    v_and_b32 v83, s69, v161
    v_lshlrev_b32 v84, 16, v162
    v_and_b32 v85, s69, v162
    v_lshlrev_b32 v86, 16, v163
    v_and_b32 v87, s69, v163
    v_pk_add_f32 v[80:81], v[80:81], v[136:137] neg_lo:[0,1] neg_hi:[0,1]
    v_pk_add_f32 v[82:83], v[82:83], v[138:139] neg_lo:[0,1] neg_hi:[0,1]
    v_pk_add_f32 v[84:85], v[84:85], v[140:141] neg_lo:[0,1] neg_hi:[0,1]
    v_pk_add_f32 v[86:87], v[86:87], v[142:143] neg_lo:[0,1] neg_hi:[0,1]
    v_cvt_pk_bf16_f32 v160, v80, v81
    v_cvt_pk_bf16_f32 v161, v82, v83
    v_cvt_pk_bf16_f32 v162, v84, v85
    v_cvt_pk_bf16_f32 v163, v86, v87
    v_lshlrev_b32 v80, 16, v160
    v_and_b32 v81, s69, v160
    v_lshlrev_b32 v82, 16, v161
    v_and_b32 v83, s69, v161
    v_lshlrev_b32 v84, 16, v162
    v_and_b32 v85, s69, v162
    v_lshlrev_b32 v86, 16, v163
    v_and_b32 v87, s69, v163
    v_pk_mul_f32 v[80:81], v[80:81], v[128:129]
    v_pk_mul_f32 v[82:83], v[82:83], v[130:131]
    v_pk_mul_f32 v[84:85], v[84:85], v[132:133]
    v_pk_mul_f32 v[86:87], v[86:87], v[134:135]
    v_cvt_pk_bf16_f32 v224, v80, v81
    v_cvt_pk_bf16_f32 v225, v82, v83
    v_cvt_pk_bf16_f32 v226, v84, v85
    v_cvt_pk_bf16_f32 v227, v86, v87
    buffer_store_dwordx4 v[224:227], v164, s[8:11], s55 offen offset:0 sc1
    v_cvt_f32_i32 v88, v88
    v_cvt_f32_i32 v89, v89
    v_cvt_f32_i32 v90, v90
    v_cvt_f32_i32 v91, v91
    v_cvt_f32_i32 v92, v92
    v_cvt_f32_i32 v93, v93
    v_cvt_f32_i32 v94, v94
    v_cvt_f32_i32 v95, v95
    v_cvt_pk_bf16_f32 v160, v88, v89
    v_cvt_pk_bf16_f32 v161, v90, v91
    v_cvt_pk_bf16_f32 v162, v92, v93
    v_cvt_pk_bf16_f32 v163, v94, v95
    v_lshlrev_b32 v88, 16, v160
    v_and_b32 v89, s69, v160
    v_lshlrev_b32 v90, 16, v161
    v_and_b32 v91, s69, v161
    v_lshlrev_b32 v92, 16, v162
    v_and_b32 v93, s69, v162
    v_lshlrev_b32 v94, 16, v163
    v_and_b32 v95, s69, v163
    v_pk_add_f32 v[88:89], v[88:89], v[136:137] neg_lo:[0,1] neg_hi:[0,1]
    v_pk_add_f32 v[90:91], v[90:91], v[138:139] neg_lo:[0,1] neg_hi:[0,1]
    v_pk_add_f32 v[92:93], v[92:93], v[140:141] neg_lo:[0,1] neg_hi:[0,1]
    v_pk_add_f32 v[94:95], v[94:95], v[142:143] neg_lo:[0,1] neg_hi:[0,1]
    v_cvt_pk_bf16_f32 v160, v88, v89
    v_cvt_pk_bf16_f32 v161, v90, v91
    v_cvt_pk_bf16_f32 v162, v92, v93
    v_cvt_pk_bf16_f32 v163, v94, v95
    v_lshlrev_b32 v88, 16, v160
    v_and_b32 v89, s69, v160
    v_lshlrev_b32 v90, 16, v161
    v_and_b32 v91, s69, v161
    v_lshlrev_b32 v92, 16, v162
    v_and_b32 v93, s69, v162
    v_lshlrev_b32 v94, 16, v163
    v_and_b32 v95, s69, v163
    v_pk_mul_f32 v[88:89], v[88:89], v[128:129]
    v_pk_mul_f32 v[90:91], v[90:91], v[130:131]
    v_pk_mul_f32 v[92:93], v[92:93], v[132:133]
    v_pk_mul_f32 v[94:95], v[94:95], v[134:135]
    v_cvt_pk_bf16_f32 v228, v88, v89
    v_cvt_pk_bf16_f32 v229, v90, v91
    v_cvt_pk_bf16_f32 v230, v92, v93
    v_cvt_pk_bf16_f32 v231, v94, v95
    buffer_store_dwordx4 v[228:231], v164, s[8:11], s55 offen offset:128 sc1
    s_add_u32 s55, s55, 28672
    s_and_b32 s65, s33, 1
    s_mul_i32 s67, s65, 114688
    s_mul_i32 s64, s59, 229376
    s_add_u32 s64, s64, s67
    v_lshlrev_b32 v1, 4, v0
    v_add_u32 v7, s64, v1
    s_xor_b32 s64, s59, 4
    s_mul_i32 s64, s64, 229376
    s_add_u32 s64, s64, s67
    v_add_u32 v8, s64, v1
    v_lshrrev_b32 v1, 4, v0
    v_and_b32 v2, 15, v0
    v_mul_u32_u24 v6, 7168, v1
    s_mul_i32 s64, s32, 114688
    s_mul_i32 s67, s65, 12845056
    s_add_u32 s64, s64, s67
    s_lshl_b32 s67, s36, 8
    s_add_u32 s64, s64, s67
    v_or_b32 v3, 0, v1
    v_lshlrev_b32 v3, 1, v3
    v_xor_b32 v3, v3, v2
    v_lshl_add_u32 v3, v3, 4, v6
    s_add_u32 s67, s64, 0
    v_add_u32 v9, s67, v3
    v_or_b32 v3, 4, v1
    v_lshlrev_b32 v3, 1, v3
    v_xor_b32 v3, v3, v2
    v_lshl_add_u32 v3, v3, 4, v6
    s_add_u32 s67, s64, 27648
    v_add_u32 v10, s67, v3
    v_or_b32 v3, 0, v1
    v_lshlrev_b32 v3, 1, v3
    v_xor_b32 v3, v3, v2
    v_lshl_add_u32 v3, v3, 4, v6
    s_add_u32 s67, s64, 55296
    v_add_u32 v11, s67, v3
    v_or_b32 v3, 4, v1
    v_lshlrev_b32 v3, 1, v3
    v_xor_b32 v3, v3, v2
    v_lshl_add_u32 v3, v3, 4, v6
    s_add_u32 s67, s64, 82944
    v_add_u32 v12, s67, v3
    s_and_b32 s40, s34, 3
    s_add_u32 s40, s40, s36
    s_and_b32 s40, s40, 3
    v_and_b32 v1, 7, v0
    v_min_u32 v1, 6, v1
    v_bfe_u32 v2, v0, 3, 2
    v_lshlrev_b32 v1, 1, v1
    v_lshl_add_u32 v1, v2, 4, v1
    s_and_b32 s64, s35, 6
    s_lshl_b32 s64, s64, 5
    s_add_u32 s64, s64, s65
    s_lshl_b32 s64, s64, 9
    s_add_u32 s64, s64, 30408704
    v_lshlrev_b32 v1, 9, v1
    v_add_u32 v22, s64, v1
    s_mov_b32 s64, 0x10
    s_lshl_b32 s68, s40, 2
    s_lshr_b32 s64, s64, s68
    s_and_b32 s46, s64, 15
    s_mov_b32 s64, 0x1201
    s_lshl_b32 s68, s40, 2
    s_lshr_b32 s64, s64, s68
    s_and_b32 s47, s64, 15
    v_bfe_u32 v2, v0, 2, 2
    v_lshrrev_b32 v1, 4, v0
    v_lshl_add_u32 v1, v1, 2, v2
    v_and_b32 v6, 7, v1
    v_lshlrev_b32 v1, 8, v1
    v_and_b32 v3, 3, v0
    v_lshl_add_u32 v1, v3, 3, v1
    v_lshl_add_u32 v1, v6, 5, v1
    v_xor_b32 v192, 0, v1
    v_add_u32 v200, 0x10000, v192
    v_add_u32 v208, 0x20000, v192
    v_xor_b32 v193, 32, v1
    v_add_u32 v201, 0x10000, v193
    v_add_u32 v209, 0x20000, v193
    v_xor_b32 v194, 64, v1
    v_add_u32 v202, 0x10000, v194
    v_add_u32 v210, 0x20000, v194
    v_xor_b32 v195, 96, v1
    v_add_u32 v203, 0x10000, v195
    v_add_u32 v211, 0x20000, v195
    v_xor_b32 v196, 128, v1
    v_add_u32 v204, 0x10000, v196
    v_add_u32 v212, 0x20000, v196
    v_xor_b32 v197, 160, v1
    v_add_u32 v205, 0x10000, v197
    v_add_u32 v213, 0x20000, v197
    v_xor_b32 v198, 192, v1
    v_add_u32 v206, 0x10000, v198
    v_add_u32 v214, 0x20000, v198
    v_xor_b32 v199, 224, v1
    v_add_u32 v207, 0x10000, v199
    v_add_u32 v215, 0x20000, v199
    s_lshl_b32 s64, s2, 2
    s_add_u32 s64, s64, s32
    s_lshl_b32 s41, s64, 13
    s_add_u32 s41, s41, 20971520
    s_xor_b32 s42, s41, 32768
    s_lshl_b32 s43, s64, 9
    s_add_u32 s43, s43, 29884416
    s_xor_b32 s64, s43, 2048
    v_mov_b32 v13, s64
    s_and_b32 s64, s35, 1
    s_lshl_b32 s64, s64, 4
    s_lshr_b32 s65, s35, 1
    s_lshl_b32 s65, s65, 2
    s_add_u32 s64, s64, s65
    s_add_u32 s64, s64, s32
    s_lshl_b32 s64, s64, 11
    s_lshl_b32 s65, s36, 18
    s_add_u32 s64, s64, s65
    s_add_u32 s62, s64, 8388608
    v_bfe_u32 v1, v0, 3, 1
    v_and_b32 v2, 0x33, v0
    v_lshl_add_u32 v2, v1, 2, v2
    v_lshlrev_b32 v2, 4, v2
    v_bfe_u32 v1, v0, 2, 1
    v_lshl_add_u32 v2, v1, 10, v2
    s_lshl_b32 s64, s36, 5
    s_add_u32 s64, s64, s35
    s_lshl_b32 s64, s64, 7
    s_add_u32 s63, s64, 29622272
    v_lshlrev_b32 v1, 4, v0
    s_lshl_b32 s64, s60, 2
    s_add_u32 s64, s64, s32
    s_lshr_b32 s65, s64, 1
    s_lshl_b32 s65, s65, 10
    s_add_u32 s65, s65, 29425664
    v_and_b32 v3, 3, v0
    v_lshlrev_b32 v3, 8, v3
    v_add_u32 v3, s65, v3
    s_lshl_b32 s64, s64, 16
    s_add_u32 s64, s64, 16777216
    v_lshlrev_b32 v6, 4, v0
    v_add_u32 v6, s64, v6
    v_lshrrev_b32 v30, 4, v0
    v_and_b32 v31, 0x78, v29
    v_lshl_add_u32 v30, v30, 10, v31
    v_mov_b32 v24, 0
    v_mov_b32 v25, 0
    v_mov_b32 v26, 0
    v_mov_b32 v27, 0
    s_getpc_b64 s[24:25]
L_pc2:
    s_add_u32 s24, s24, L_code0-L_pc2
    s_addc_u32 s25, s25, 0
    s_mov_b32 s26, L_codeend-L_code0
    s_lshl_b32 s64, s34, 2
    s_add_u32 s64, s64, s32
    s_mul_i32 s64, s64, 1152
    v_min_u32 v14, 8, v0
    v_lshlrev_b32 v14, 7, v14
    v_add_u32 v14, s64, v14
    buffer_load_dword v255, v14, s[24:27], 0 offen
    v_lshlrev_b32 v128, 16, v48
    v_and_b32 v129, s69, v48
    v_lshlrev_b32 v130, 16, v49
    v_and_b32 v131, s69, v49
    v_lshlrev_b32 v132, 16, v50
    v_and_b32 v133, s69, v50
    v_lshlrev_b32 v134, 16, v51
    v_and_b32 v135, s69, v51
    v_lshlrev_b32 v136, 16, v52
    v_and_b32 v137, s69, v52
    v_lshlrev_b32 v138, 16, v53
    v_and_b32 v139, s69, v53
    v_lshlrev_b32 v140, 16, v54
    v_and_b32 v141, s69, v54
    v_lshlrev_b32 v142, 16, v55
    v_and_b32 v143, s69, v55
    s_waitcnt vmcnt(10)
    v_cvt_f32_i32 v96, v96
    v_cvt_f32_i32 v97, v97
    v_cvt_f32_i32 v98, v98
    v_cvt_f32_i32 v99, v99
    v_cvt_f32_i32 v100, v100
    v_cvt_f32_i32 v101, v101
    v_cvt_f32_i32 v102, v102
    v_cvt_f32_i32 v103, v103
    v_cvt_pk_bf16_f32 v160, v96, v97
    v_cvt_pk_bf16_f32 v161, v98, v99
    v_cvt_pk_bf16_f32 v162, v100, v101
    v_cvt_pk_bf16_f32 v163, v102, v103
    v_lshlrev_b32 v96, 16, v160
    v_and_b32 v97, s69, v160
    v_lshlrev_b32 v98, 16, v161
    v_and_b32 v99, s69, v161
    v_lshlrev_b32 v100, 16, v162
    v_and_b32 v101, s69, v162
    v_lshlrev_b32 v102, 16, v163
    v_and_b32 v103, s69, v163
    v_pk_add_f32 v[96:97], v[96:97], v[136:137] neg_lo:[0,1] neg_hi:[0,1]
    v_pk_add_f32 v[98:99], v[98:99], v[138:139] neg_lo:[0,1] neg_hi:[0,1]
    v_pk_add_f32 v[100:101], v[100:101], v[140:141] neg_lo:[0,1] neg_hi:[0,1]
    v_pk_add_f32 v[102:103], v[102:103], v[142:143] neg_lo:[0,1] neg_hi:[0,1]
    v_cvt_pk_bf16_f32 v160, v96, v97
    v_cvt_pk_bf16_f32 v161, v98, v99
    v_cvt_pk_bf16_f32 v162, v100, v101
    v_cvt_pk_bf16_f32 v163, v102, v103
    v_lshlrev_b32 v96, 16, v160
    v_and_b32 v97, s69, v160
    v_lshlrev_b32 v98, 16, v161
    v_and_b32 v99, s69, v161
    v_lshlrev_b32 v100, 16, v162
    v_and_b32 v101, s69, v162
    v_lshlrev_b32 v102, 16, v163
    v_and_b32 v103, s69, v163
    v_pk_mul_f32 v[96:97], v[96:97], v[128:129]
    v_pk_mul_f32 v[98:99], v[98:99], v[130:131]
    v_pk_mul_f32 v[100:101], v[100:101], v[132:133]
    v_pk_mul_f32 v[102:103], v[102:103], v[134:135]
    v_cvt_pk_bf16_f32 v232, v96, v97
    v_cvt_pk_bf16_f32 v233, v98, v99
    v_cvt_pk_bf16_f32 v234, v100, v101
    v_cvt_pk_bf16_f32 v235, v102, v103
    buffer_store_dwordx4 v[232:235], v164, s[8:11], s55 offen offset:0 sc1
    v_cvt_f32_i32 v104, v104
    v_cvt_f32_i32 v105, v105
    v_cvt_f32_i32 v106, v106
    v_cvt_f32_i32 v107, v107
    v_cvt_f32_i32 v108, v108
    v_cvt_f32_i32 v109, v109
    v_cvt_f32_i32 v110, v110
    v_cvt_f32_i32 v111, v111
    v_cvt_pk_bf16_f32 v160, v104, v105
    v_cvt_pk_bf16_f32 v161, v106, v107
    v_cvt_pk_bf16_f32 v162, v108, v109
    v_cvt_pk_bf16_f32 v163, v110, v111
    v_lshlrev_b32 v104, 16, v160
    v_and_b32 v105, s69, v160
    v_lshlrev_b32 v106, 16, v161
    v_and_b32 v107, s69, v161
    v_lshlrev_b32 v108, 16, v162
    v_and_b32 v109, s69, v162
    v_lshlrev_b32 v110, 16, v163
    v_and_b32 v111, s69, v163
    v_pk_add_f32 v[104:105], v[104:105], v[136:137] neg_lo:[0,1] neg_hi:[0,1]
    v_pk_add_f32 v[106:107], v[106:107], v[138:139] neg_lo:[0,1] neg_hi:[0,1]
    v_pk_add_f32 v[108:109], v[108:109], v[140:141] neg_lo:[0,1] neg_hi:[0,1]
    v_pk_add_f32 v[110:111], v[110:111], v[142:143] neg_lo:[0,1] neg_hi:[0,1]
    v_cvt_pk_bf16_f32 v160, v104, v105
    v_cvt_pk_bf16_f32 v161, v106, v107
    v_cvt_pk_bf16_f32 v162, v108, v109
    v_cvt_pk_bf16_f32 v163, v110, v111
    v_lshlrev_b32 v104, 16, v160
    v_and_b32 v105, s69, v160
    v_lshlrev_b32 v106, 16, v161
    v_and_b32 v107, s69, v161
    v_lshlrev_b32 v108, 16, v162
    v_and_b32 v109, s69, v162
    v_lshlrev_b32 v110, 16, v163
    v_and_b32 v111, s69, v163
    v_pk_mul_f32 v[104:105], v[104:105], v[128:129]
    v_pk_mul_f32 v[106:107], v[106:107], v[130:131]
    v_pk_mul_f32 v[108:109], v[108:109], v[132:133]
    v_pk_mul_f32 v[110:111], v[110:111], v[134:135]
    v_cvt_pk_bf16_f32 v236, v104, v105
    v_cvt_pk_bf16_f32 v237, v106, v107
    v_cvt_pk_bf16_f32 v238, v108, v109
    v_cvt_pk_bf16_f32 v239, v110, v111
    buffer_store_dwordx4 v[236:239], v164, s[8:11], s55 offen offset:128 sc1
    s_add_u32 s55, s55, 28672
    v_lshlrev_b32 v128, 16, v56
    v_and_b32 v129, s69, v56
    v_lshlrev_b32 v130, 16, v57
    v_and_b32 v131, s69, v57
    v_lshlrev_b32 v132, 16, v58
    v_and_b32 v133, s69, v58
    v_lshlrev_b32 v134, 16, v59
    v_and_b32 v135, s69, v59
    v_lshlrev_b32 v136, 16, v60
    v_and_b32 v137, s69, v60
    v_lshlrev_b32 v138, 16, v61
    v_and_b32 v139, s69, v61
    v_lshlrev_b32 v140, 16, v62
    v_and_b32 v141, s69, v62
    v_lshlrev_b32 v142, 16, v63
    v_and_b32 v143, s69, v63
    s_waitcnt vmcnt(5)
    s_mov_b32 s39, 4194304
    s_branch L_nchk3
L_npoll3:
    buffer_load_dwordx2 v[4:5], off, s[28:31], 0 sc1
    s_waitcnt vmcnt(0)
L_nchk3:
    v_readfirstlane_b32 s56, v4
    v_readfirstlane_b32 s57, v5
    s_sub_u32 s39, s39, 1
    s_cbranch_scc1 L_exit0
    s_cmp_eq_u64 s[56:57], 0
    s_cbranch_scc1 L_npoll3
    s_barrier
    s_cmp_eq_u32 s100, 0
    s_cbranch_scc1 L_nof4
    s_mov_b64 exec, 0xffff
    buffer_store_dwordx2 v[4:5], v29, s[8:11], s54 offen offset:0 sc1
    s_mov_b64 exec, -1
L_nof4:
    v_cvt_f32_i32 v112, v112
    v_cvt_f32_i32 v113, v113
    v_cvt_f32_i32 v114, v114
    v_cvt_f32_i32 v115, v115
    v_cvt_f32_i32 v116, v116
    v_cvt_f32_i32 v117, v117
    v_cvt_f32_i32 v118, v118
    v_cvt_f32_i32 v119, v119
    v_cvt_pk_bf16_f32 v160, v112, v113
    v_cvt_pk_bf16_f32 v161, v114, v115
    v_cvt_pk_bf16_f32 v162, v116, v117
    v_cvt_pk_bf16_f32 v163, v118, v119
    v_lshlrev_b32 v112, 16, v160
    v_and_b32 v113, s69, v160
    v_lshlrev_b32 v114, 16, v161
    v_and_b32 v115, s69, v161
    v_lshlrev_b32 v116, 16, v162
    v_and_b32 v117, s69, v162
    v_lshlrev_b32 v118, 16, v163
    v_and_b32 v119, s69, v163
    v_pk_add_f32 v[112:113], v[112:113], v[136:137] neg_lo:[0,1] neg_hi:[0,1]
    v_pk_add_f32 v[114:115], v[114:115], v[138:139] neg_lo:[0,1] neg_hi:[0,1]
    v_pk_add_f32 v[116:117], v[116:117], v[140:141] neg_lo:[0,1] neg_hi:[0,1]
    v_pk_add_f32 v[118:119], v[118:119], v[142:143] neg_lo:[0,1] neg_hi:[0,1]
    v_cvt_pk_bf16_f32 v160, v112, v113
    v_cvt_pk_bf16_f32 v161, v114, v115
    v_cvt_pk_bf16_f32 v162, v116, v117
    v_cvt_pk_bf16_f32 v163, v118, v119
    v_lshlrev_b32 v112, 16, v160
    v_and_b32 v113, s69, v160
    v_lshlrev_b32 v114, 16, v161
    v_and_b32 v115, s69, v161
    v_lshlrev_b32 v116, 16, v162
    v_and_b32 v117, s69, v162
    v_lshlrev_b32 v118, 16, v163
    v_and_b32 v119, s69, v163
    v_pk_mul_f32 v[112:113], v[112:113], v[128:129]
    v_pk_mul_f32 v[114:115], v[114:115], v[130:131]
    v_pk_mul_f32 v[116:117], v[116:117], v[132:133]
    v_pk_mul_f32 v[118:119], v[118:119], v[134:135]
    v_cvt_pk_bf16_f32 v240, v112, v113
    v_cvt_pk_bf16_f32 v241, v114, v115
    v_cvt_pk_bf16_f32 v242, v116, v117
    v_cvt_pk_bf16_f32 v243, v118, v119
    buffer_store_dwordx4 v[240:243], v164, s[8:11], s55 offen offset:0 sc1
    v_cvt_f32_i32 v120, v120
    v_cvt_f32_i32 v121, v121
    v_cvt_f32_i32 v122, v122
    v_cvt_f32_i32 v123, v123
    v_cvt_f32_i32 v124, v124
    v_cvt_f32_i32 v125, v125
    v_cvt_f32_i32 v126, v126
    v_cvt_f32_i32 v127, v127
    v_cvt_pk_bf16_f32 v160, v120, v121
    v_cvt_pk_bf16_f32 v161, v122, v123
    v_cvt_pk_bf16_f32 v162, v124, v125
    v_cvt_pk_bf16_f32 v163, v126, v127
    v_lshlrev_b32 v120, 16, v160
    v_and_b32 v121, s69, v160
    v_lshlrev_b32 v122, 16, v161
    v_and_b32 v123, s69, v161
    v_lshlrev_b32 v124, 16, v162
    v_and_b32 v125, s69, v162
    v_lshlrev_b32 v126, 16, v163
    v_and_b32 v127, s69, v163
    v_pk_add_f32 v[120:121], v[120:121], v[136:137] neg_lo:[0,1] neg_hi:[0,1]
    v_pk_add_f32 v[122:123], v[122:123], v[138:139] neg_lo:[0,1] neg_hi:[0,1]
    v_pk_add_f32 v[124:125], v[124:125], v[140:141] neg_lo:[0,1] neg_hi:[0,1]
    v_pk_add_f32 v[126:127], v[126:127], v[142:143] neg_lo:[0,1] neg_hi:[0,1]
    v_cvt_pk_bf16_f32 v160, v120, v121
    v_cvt_pk_bf16_f32 v161, v122, v123
    v_cvt_pk_bf16_f32 v162, v124, v125
    v_cvt_pk_bf16_f32 v163, v126, v127
    v_lshlrev_b32 v120, 16, v160
    v_and_b32 v121, s69, v160
    v_lshlrev_b32 v122, 16, v161
    v_and_b32 v123, s69, v161
    v_lshlrev_b32 v124, 16, v162
    v_and_b32 v125, s69, v162
    v_lshlrev_b32 v126, 16, v163
    v_and_b32 v127, s69, v163
    v_pk_mul_f32 v[120:121], v[120:121], v[128:129]
    v_pk_mul_f32 v[122:123], v[122:123], v[130:131]
    v_pk_mul_f32 v[124:125], v[124:125], v[132:133]
    v_pk_mul_f32 v[126:127], v[126:127], v[134:135]
    v_cvt_pk_bf16_f32 v244, v120, v121
    v_cvt_pk_bf16_f32 v245, v122, v123
    v_cvt_pk_bf16_f32 v246, v124, v125
    v_cvt_pk_bf16_f32 v247, v126, v127
    buffer_store_dwordx4 v[244:247], v164, s[8:11], s55 offen offset:128 sc1
    s_add_u32 s55, s55, 28672
L_code0:
    s_mul_i32 s64, s46, 917504
    s_add_u32 m0, s38, 0
    s_nop 0
    buffer_load_dwordx4 v9, s[4:7], s64 offen offset:0 lds
    buffer_load_dwordx4 v10, s[4:7], s64 offen offset:1024 lds
    buffer_load_dwordx4 v11, s[4:7], s64 offen offset:2048 lds
    buffer_load_dwordx4 v12, s[4:7], s64 offen offset:3072 lds
    s_mul_i32 s64, s46, 917504
    s_add_u32 s64, s64, 458752
    s_add_u32 m0, s38, 16384
    s_nop 0
    buffer_load_dwordx4 v9, s[4:7], s64 offen offset:0 lds
    buffer_load_dwordx4 v10, s[4:7], s64 offen offset:1024 lds
    buffer_load_dwordx4 v11, s[4:7], s64 offen offset:2048 lds
    buffer_load_dwordx4 v12, s[4:7], s64 offen offset:3072 lds
    v_mfma_f32_32x32x16_bf16 v[64:79], v[24:27], v[24:27], 0
    v_mfma_f32_32x32x16_bf16 v[80:95], v[24:27], v[24:27], 0
    v_mfma_f32_32x32x16_bf16 v[96:111], v[24:27], v[24:27], 0
    v_mfma_f32_32x32x16_bf16 v[112:127], v[24:27], v[24:27], 0
    v_mfma_f32_32x32x16_bf16 v[128:143], v[24:27], v[24:27], 0
    v_mfma_f32_32x32x16_bf16 v[144:159], v[24:27], v[24:27], 0
    v_mfma_f32_32x32x16_bf16 v[160:175], v[24:27], v[24:27], 0
    v_mfma_f32_32x32x16_bf16 v[176:191], v[24:27], v[24:27], 0
    s_waitcnt vmcnt(13)
    s_barrier
    s_cmp_eq_u32 s100, 0
    s_cbranch_scc1 L_nof5
    s_mov_b64 exec, 0xffff
    buffer_store_dwordx2 v[4:5], v29, s[8:11], s54 offen offset:128 sc1
    s_mov_b64 exec, -1
L_nof5:
    s_cmp_lg_u32 s32, 0
    s_cbranch_scc1 L_pdone6
    s_mov_b32 s39, 4194304
    s_branch L_pld6
L_poll6:
    s_sub_u32 s39, s39, 1
    s_cbranch_scc1 L_exit0
    s_sleep 1
L_pld6:
    buffer_load_dwordx2 v[60:61], v22, s[8:11], 0 offen offset:0 sc1
    s_waitcnt vmcnt(0)
L_pchk6:
    v_cmp_ne_u64 vcc, s[56:57], v[60:61]
    s_nop 1
    s_cmp_lg_u64 vcc, 0
    s_cbranch_scc1 L_poll6
L_pdone6:
    s_barrier
    s_lshl_b32 s64, s46, 13
    s_add_u32 s65, s64, 4096
    buffer_load_dwordx4 a[128:131], v7, s[8:11], s64 offen offset:0 sc1
    buffer_load_dwordx4 a[132:135], v7, s[8:11], s64 offen offset:1024 sc1
    buffer_load_dwordx4 a[0:3], v8, s[8:11], s64 offen offset:0 sc1
    buffer_load_dwordx4 a[4:7], v8, s[8:11], s64 offen offset:1024 sc1
    buffer_load_dwordx4 a[136:139], v7, s[8:11], s64 offen offset:2048 sc1
    buffer_load_dwordx4 a[140:143], v7, s[8:11], s64 offen offset:3072 sc1
    buffer_load_dwordx4 a[8:11], v8, s[8:11], s64 offen offset:2048 sc1
    buffer_load_dwordx4 a[12:15], v8, s[8:11], s64 offen offset:3072 sc1
    buffer_load_dwordx4 a[144:147], v7, s[8:11], s65 offen offset:0 sc1
    buffer_load_dwordx4 a[148:151], v7, s[8:11], s65 offen offset:1024 sc1
    buffer_load_dwordx4 a[16:19], v8, s[8:11], s65 offen offset:0 sc1
    buffer_load_dwordx4 a[20:23], v8, s[8:11], s65 offen offset:1024 sc1
    buffer_load_dwordx4 a[152:155], v7, s[8:11], s65 offen offset:2048 sc1
    buffer_load_dwordx4 a[156:159], v7, s[8:11], s65 offen offset:3072 sc1
    buffer_load_dwordx4 a[24:27], v8, s[8:11], s65 offen offset:2048 sc1
    buffer_load_dwordx4 a[28:31], v8, s[8:11], s65 offen offset:3072 sc1
    s_cmp_eq_u32 s40, 1
    s_cbranch_scc1 L_var1
    s_cmp_eq_u32 s40, 2
    s_cbranch_scc1 L_var2
    s_cmp_eq_u32 s40, 3
    s_cbranch_scc1 L_var3
L_var0:
    buffer_store_dwordx2 v[24:25], v29, s[8:11], s43 offen sc1
    s_cmp_eq_u32 s100, 0
    s_cbranch_scc1 L_noz7
    buffer_store_dwordx2 v[24:25], v30, s[8:11], s63 offen sc1
L_noz7:
    s_waitcnt vmcnt(9)
    s_barrier
    s_cmp_eq_u32 s100, 0
    s_cbranch_scc1 L_nof8
    s_mov_b64 exec, 0xffff
    buffer_store_dwordx2 v[4:5], v29, s[8:11], s54 offen offset:256 sc1
    s_mov_b64 exec, -1
L_nof8:
TR 32,192,0
TR 34,192,8192
TR 36,193,0
TR 38,193,8192
TR 40,194,0
TR 42,194,8192
LW 4
MA 64,128,32
TR 44,195,0
    s_add_u32 m0, s38, 32768
MA 68,132,32
TR 46,195,8192
    s_mov_b32 s44, 917504
MA 128,0,32
    buffer_load_dwordx4 v9, s[4:7], s44 offen offset:0 lds
MA 132,4,32
LW 4
MA 72,128,36
TR 48,196,0
MA 76,132,36
TR 50,196,8192
MA 136,0,36
    buffer_load_dwordx4 v10, s[4:7], s44 offen offset:1024 lds
MA 140,4,36
LW 4
MA 80,128,40
TR 52,197,0
MA 84,132,40
TR 54,197,8192
MA 144,0,40
    buffer_load_dwordx4 v11, s[4:7], s44 offen offset:2048 lds
MA 148,4,40
LW 4
MA 88,128,44
TR 56,198,0
MA 92,132,44
TR 58,198,8192
MA 152,0,44
    buffer_load_dwordx4 v12, s[4:7], s44 offen offset:3072 lds
MA 156,4,44
LW 4
MA 96,128,48
TR 60,199,0
    s_add_u32 m0, s38, 49152
MA 100,132,48
TR 62,199,8192
    s_mov_b32 s44, 1376256
MA 160,0,48
    buffer_load_dwordx4 v9, s[4:7], s44 offen offset:0 lds
MA 164,4,48
LW 4
MA 104,128,52
TR 32,192,4096
MA 108,132,52
TR 34,192,12288
MA 168,0,52
    buffer_load_dwordx4 v10, s[4:7], s44 offen offset:1024 lds
MA 172,4,52
LW 4
MA 112,128,56
TR 36,193,4096
MA 116,132,56
TR 38,193,12288
MA 176,0,56
    buffer_load_dwordx4 v11, s[4:7], s44 offen offset:2048 lds
MA 180,4,56
LW 4
MA 120,128,60
TR 40,194,4096
MA 124,132,60
TR 42,194,12288
MA 184,0,60
    buffer_load_dwordx4 v12, s[4:7], s44 offen offset:3072 lds
MA 188,4,60
LW 4
MA 64,136,32
TR 44,195,4096
    s_mov_b32 s45, 8192
MA 68,140,32
TR 46,195,12288
MA 128,8,32
    buffer_load_dwordx4 a[160:163], v7, s[8:11], s45 offen offset:0 sc1
MA 132,12,32
LW 4
MA 72,136,36
TR 48,196,4096
MA 76,140,36
TR 50,196,12288
MA 136,8,36
    buffer_load_dwordx4 a[164:167], v7, s[8:11], s45 offen offset:1024 sc1
MA 140,12,36
LW 4
MA 80,136,40
TR 52,197,4096
MA 84,140,40
TR 54,197,12288
MA 144,8,40
    buffer_load_dwordx4 a[32:35], v8, s[8:11], s45 offen offset:0 sc1
MA 148,12,40
LW 4
MA 88,136,44
TR 56,198,4096
MA 92,140,44
TR 58,198,12288
MA 152,8,44
    buffer_load_dwordx4 a[36:39], v8, s[8:11], s45 offen offset:1024 sc1
MA 156,12,44
LW 4
MA 96,136,48
TR 60,199,4096
MA 100,140,48
TR 62,199,12288
MA 160,8,48
    buffer_load_dwordx4 a[168:171], v7, s[8:11], s45 offen offset:2048 sc1
MA 164,12,48
LW 4
MA 104,136,52
    s_waitcnt vmcnt(14)
    s_barrier
TR 32,192,16384
MA 108,140,52
TR 34,192,24576
MA 168,8,52
    buffer_load_dwordx4 a[172:175], v7, s[8:11], s45 offen offset:3072 sc1
MA 172,12,52
LW 4
MA 112,136,56
TR 36,193,16384
MA 116,140,56
TR 38,193,24576
MA 176,8,56
    buffer_load_dwordx4 a[40:43], v8, s[8:11], s45 offen offset:2048 sc1
MA 180,12,56
LW 4
MA 120,136,60
TR 40,194,16384
MA 124,140,60
TR 42,194,24576
MA 184,8,60
    buffer_load_dwordx4 a[44:47], v8, s[8:11], s45 offen offset:3072 sc1
MA 188,12,60
LW 4
MA 64,144,32
TR 44,195,16384
    s_mov_b32 s45, 12288
MA 68,148,32
TR 46,195,24576
MA 128,16,32
    buffer_load_dwordx4 a[176:179], v7, s[8:11], s45 offen offset:0 sc1
MA 132,20,32
LW 4
MA 72,144,36
TR 48,196,16384
MA 76,148,36
TR 50,196,24576
MA 136,16,36
    buffer_load_dwordx4 a[180:183], v7, s[8:11], s45 offen offset:1024 sc1
MA 140,20,36
LW 4
MA 80,144,40
TR 52,197,16384
MA 84,148,40
TR 54,197,24576
MA 144,16,40
    buffer_load_dwordx4 a[48:51], v8, s[8:11], s45 offen offset:0 sc1
MA 148,20,40
LW 4
MA 88,144,44
TR 56,198,16384
MA 92,148,44
TR 58,198,24576
MA 152,16,44
    buffer_load_dwordx4 a[52:55], v8, s[8:11], s45 offen offset:1024 sc1
MA 156,20,44
LW 4
MA 96,144,48
TR 60,199,16384
MA 100,148,48
TR 62,199,24576
MA 160,16,48
    buffer_load_dwordx4 a[184:187], v7, s[8:11], s45 offen offset:2048 sc1
MA 164,20,48
LW 4
MA 104,144,52
TR 32,192,20480
MA 108,148,52
TR 34,192,28672
MA 168,16,52
    buffer_load_dwordx4 a[188:191], v7, s[8:11], s45 offen offset:3072 sc1
MA 172,20,52
LW 4
MA 112,144,56
TR 36,193,20480
MA 116,148,56
TR 38,193,28672
MA 176,16,56
    buffer_load_dwordx4 a[56:59], v8, s[8:11], s45 offen offset:2048 sc1
MA 180,20,56
LW 4
MA 120,144,60
TR 40,194,20480
MA 124,148,60
TR 42,194,28672
MA 184,16,60
    buffer_load_dwordx4 a[60:63], v8, s[8:11], s45 offen offset:3072 sc1
MA 188,20,60
LW 4
MA 64,152,32
TR 44,195,20480
    s_add_u32 m0, s38, 65536
MA 68,156,32
TR 46,195,28672
    s_mov_b32 s44, 1835008
MA 128,24,32
    buffer_load_dwordx4 v9, s[4:7], s44 offen offset:0 lds
MA 132,28,32
LW 4
MA 72,152,36
TR 48,196,20480
MA 76,156,36
TR 50,196,28672
MA 136,24,36
    buffer_load_dwordx4 v10, s[4:7], s44 offen offset:1024 lds
MA 140,28,36
LW 4
MA 80,152,40
TR 52,197,20480
MA 84,156,40
TR 54,197,28672
MA 144,24,40
    buffer_load_dwordx4 v11, s[4:7], s44 offen offset:2048 lds
MA 148,28,40
LW 4
MA 88,152,44
TR 56,198,20480
MA 92,156,44
TR 58,198,28672
MA 152,24,44
    buffer_load_dwordx4 v12, s[4:7], s44 offen offset:3072 lds
MA 156,28,44
LW 4
MA 96,152,48
TR 60,199,20480
    s_add_u32 m0, s38, 81920
MA 100,156,48
TR 62,199,28672
    s_mov_b32 s44, 2293760
MA 160,24,48
    buffer_load_dwordx4 v9, s[4:7], s44 offen offset:0 lds
MA 164,28,48
LW 4
MA 104,152,52
    s_waitcnt vmcnt(13)
    s_barrier
TR 32,192,32768
MA 108,156,52
TR 34,192,40960
MA 168,24,52
    buffer_load_dwordx4 v10, s[4:7], s44 offen offset:1024 lds
MA 172,28,52
LW 4
MA 112,152,56
TR 36,193,32768
MA 116,156,56
TR 38,193,40960
MA 176,24,56
    buffer_load_dwordx4 v11, s[4:7], s44 offen offset:2048 lds
MA 180,28,56
LW 4
MA 120,152,60
TR 40,194,32768
MA 124,156,60
TR 42,194,40960
MA 184,24,60
    buffer_load_dwordx4 v12, s[4:7], s44 offen offset:3072 lds
MA 188,28,60
LW 4
MA 64,160,32
TR 44,195,32768
    s_mov_b32 s45, 16384
MA 68,164,32
TR 46,195,40960
MA 128,32,32
    buffer_load_dwordx4 a[192:195], v7, s[8:11], s45 offen offset:0 sc1
MA 132,36,32
LW 4
MA 72,160,36
TR 48,196,32768
MA 76,164,36
TR 50,196,40960
MA 136,32,36
    buffer_load_dwordx4 a[196:199], v7, s[8:11], s45 offen offset:1024 sc1
MA 140,36,36
LW 4
MA 80,160,40
TR 52,197,32768
MA 84,164,40
TR 54,197,40960
MA 144,32,40
    buffer_load_dwordx4 a[64:67], v8, s[8:11], s45 offen offset:0 sc1
MA 148,36,40
LW 4
MA 88,160,44
TR 56,198,32768
MA 92,164,44
TR 58,198,40960
MA 152,32,44
    buffer_load_dwordx4 a[68:71], v8, s[8:11], s45 offen offset:1024 sc1
MA 156,36,44
LW 4
MA 96,160,48
TR 60,199,32768
MA 100,164,48
TR 62,199,40960
MA 160,32,48
    buffer_load_dwordx4 a[200:203], v7, s[8:11], s45 offen offset:2048 sc1
MA 164,36,48
LW 4
MA 104,160,52
TR 32,192,36864
MA 108,164,52
TR 34,192,45056
MA 168,32,52
    buffer_load_dwordx4 a[204:207], v7, s[8:11], s45 offen offset:3072 sc1
MA 172,36,52
LW 4
MA 112,160,56
TR 36,193,36864
MA 116,164,56
TR 38,193,45056
MA 176,32,56
    buffer_load_dwordx4 a[72:75], v8, s[8:11], s45 offen offset:2048 sc1
MA 180,36,56
LW 4
MA 120,160,60
TR 40,194,36864
MA 124,164,60
TR 42,194,45056
MA 184,32,60
    buffer_load_dwordx4 a[76:79], v8, s[8:11], s45 offen offset:3072 sc1
MA 188,36,60
LW 4
MA 64,168,32
TR 44,195,36864
    s_mov_b32 s45, 20480
MA 68,172,32
TR 46,195,45056
MA 128,40,32
    buffer_load_dwordx4 a[208:211], v7, s[8:11], s45 offen offset:0 sc1
MA 132,44,32
LW 4
MA 72,168,36
TR 48,196,36864
MA 76,172,36
TR 50,196,45056
MA 136,40,36
    buffer_load_dwordx4 a[212:215], v7, s[8:11], s45 offen offset:1024 sc1
MA 140,44,36
LW 4
MA 80,168,40
TR 52,197,36864
MA 84,172,40
TR 54,197,45056
MA 144,40,40
    buffer_load_dwordx4 a[80:83], v8, s[8:11], s45 offen offset:0 sc1
MA 148,44,40
LW 4
MA 88,168,44
TR 56,198,36864
MA 92,172,44
TR 58,198,45056
MA 152,40,44
    buffer_load_dwordx4 a[84:87], v8, s[8:11], s45 offen offset:1024 sc1
MA 156,44,44
LW 4
MA 96,168,48
TR 60,199,36864
MA 100,172,48
TR 62,199,45056
MA 160,40,48
    buffer_load_dwordx4 a[216:219], v7, s[8:11], s45 offen offset:2048 sc1
MA 164,44,48
LW 4
MA 104,168,52
    s_waitcnt vmcnt(21)
    s_barrier
TR 32,192,49152
MA 108,172,52
TR 34,192,57344
MA 168,40,52
    buffer_load_dwordx4 a[220:223], v7, s[8:11], s45 offen offset:3072 sc1
MA 172,44,52
LW 4
MA 112,168,56
TR 36,193,49152
MA 116,172,56
TR 38,193,57344
MA 176,40,56
    buffer_load_dwordx4 a[88:91], v8, s[8:11], s45 offen offset:2048 sc1
MA 180,44,56
LW 4
MA 120,168,60
TR 40,194,49152
MA 124,172,60
TR 42,194,57344
MA 184,40,60
    buffer_load_dwordx4 a[92:95], v8, s[8:11], s45 offen offset:3072 sc1
MA 188,44,60
LW 4
MA 64,176,32
TR 44,195,49152
    s_add_u32 m0, s38, 98304
MA 68,180,32
TR 46,195,57344
    s_mov_b32 s44, 3670016
MA 128,48,32
    buffer_load_dwordx4 v9, s[4:7], s44 offen offset:0 lds
MA 132,52,32
LW 4
MA 72,176,36
TR 48,196,49152
MA 76,180,36
TR 50,196,57344
MA 136,48,36
    buffer_load_dwordx4 v10, s[4:7], s44 offen offset:1024 lds
MA 140,52,36
LW 4
MA 80,176,40
TR 52,197,49152
MA 84,180,40
TR 54,197,57344
MA 144,48,40
    buffer_load_dwordx4 v11, s[4:7], s44 offen offset:2048 lds
MA 148,52,40
LW 4
MA 88,176,44
TR 56,198,49152
MA 92,180,44
TR 58,198,57344
MA 152,48,44
    buffer_load_dwordx4 v12, s[4:7], s44 offen offset:3072 lds
MA 156,52,44
LW 4
MA 96,176,48
TR 60,199,49152
    s_add_u32 m0, s38, 114688
MA 100,180,48
TR 62,199,57344
    s_mov_b32 s44, 4128768
MA 160,48,48
    buffer_load_dwordx4 v9, s[4:7], s44 offen offset:0 lds
MA 164,52,48
LW 4
MA 104,176,52
TR 32,192,53248
MA 108,180,52
TR 34,192,61440
MA 168,48,52
    buffer_load_dwordx4 v10, s[4:7], s44 offen offset:1024 lds
MA 172,52,52
    buffer_load_dwordx2 v[26:27], v22, s[8:11], 0 offen offset:128 sc1
LW 4
MA 112,176,56
TR 36,193,53248
MA 116,180,56
TR 38,193,61440
MA 176,48,56
    buffer_load_dwordx4 v11, s[4:7], s44 offen offset:2048 lds
MA 180,52,56
LW 4
MA 120,176,60
TR 40,194,53248
MA 124,180,60
TR 42,194,61440
MA 184,48,60
    buffer_load_dwordx4 v12, s[4:7], s44 offen offset:3072 lds
    s_sub_u32 s39, s32, 2
    s_cmp_ge_u32 s39, 2
    s_cbranch_scc1 L_nog9
    buffer_load_dword v15, v15, s[12:15], 0 offen
L_nog9:
MA 188,52,60
LW 4
MA 64,184,32
TR 44,195,53248
MA 68,188,32
TR 46,195,61440
MA 128,56,32
MA 132,60,32
LW 4
MA 72,184,36
TR 48,196,53248
MA 76,188,36
TR 50,196,61440
MA 136,56,36
MA 140,60,36
LW 4
MA 80,184,40
TR 52,197,53248
MA 84,188,40
TR 54,197,61440
MA 144,56,40
MA 148,60,40
LW 4
MA 88,184,44
TR 56,198,53248
MA 92,188,44
TR 58,198,61440
MA 152,56,44
MA 156,60,44
LW 4
MA 96,184,48
TR 60,199,53248
MA 100,188,48
TR 62,199,61440
MA 160,56,48
MA 164,60,48
LW 4
MA 104,184,52
    s_waitcnt vmcnt(17)
    s_barrier
TR 32,200,0
MA 108,188,52
TR 34,200,8192
MA 168,56,52
MA 172,60,52
LW 4
MA 112,184,56
TR 36,201,0
MA 116,188,56
TR 38,201,8192
MA 176,56,56
MA 180,60,56
LW 4
MA 120,184,60
TR 40,202,0
MA 124,188,60
TR 42,202,8192
MA 184,56,60
MA 188,60,60
LW 4
MA 64,192,32
TR 44,203,0
MA 68,196,32
TR 46,203,8192
MA 128,64,32
MA 132,68,32
LW 4
MA 72,192,36
TR 48,204,0
MA 76,196,36
TR 50,204,8192
MA 136,64,36
MA 140,68,36
LW 4
MA 80,192,40
TR 52,205,0
MA 84,196,40
TR 54,205,8192
MA 144,64,40
MA 148,68,40
LW 4
MA 88,192,44
TR 56,206,0
MA 92,196,44
TR 58,206,8192
MA 152,64,44
MA 156,68,44
    s_waitcnt vmcnt(2)
    v_cmp_ne_u64 vcc, s[56:57], v[26:27]
    s_nop 1
    s_cmp_lg_u64 vcc, 0
    s_cbranch_scc1 L_miss10
L_back10:
LW 4
MA 96,192,48
TR 60,207,0
    s_mov_b32 s45, 32768
MA 100,196,48
TR 62,207,8192
MA 160,64,48
    buffer_load_dwordx4 a[224:227], v7, s[8:11], s45 offen offset:0 sc1
MA 164,68,48
LW 4
MA 104,192,52
TR 32,200,4096
MA 108,196,52
TR 34,200,12288
MA 168,64,52
    buffer_load_dwordx4 a[228:231], v7, s[8:11], s45 offen offset:1024 sc1
MA 172,68,52
LW 4
MA 112,192,56
TR 36,201,4096
MA 116,196,56
TR 38,201,12288
MA 176,64,56
    buffer_load_dwordx4 a[96:99], v8, s[8:11], s45 offen offset:0 sc1
MA 180,68,56
LW 4
MA 120,192,60
TR 40,202,4096
MA 124,196,60
TR 42,202,12288
MA 184,64,60
    buffer_load_dwordx4 a[100:103], v8, s[8:11], s45 offen offset:1024 sc1
MA 188,68,60
LW 4
MA 64,200,32
TR 44,203,4096
MA 68,204,32
TR 46,203,12288
MA 128,72,32
    buffer_load_dwordx4 a[232:235], v7, s[8:11], s45 offen offset:2048 sc1
MA 132,76,32
LW 4
MA 72,200,36
TR 48,204,4096
MA 76,204,36
TR 50,204,12288
MA 136,72,36
    buffer_load_dwordx4 a[236:239], v7, s[8:11], s45 offen offset:3072 sc1
MA 140,76,36
LW 4
MA 80,200,40
TR 52,205,4096
MA 84,204,40
TR 54,205,12288
MA 144,72,40
    buffer_load_dwordx4 a[104:107], v8, s[8:11], s45 offen offset:2048 sc1
MA 148,76,40
LW 4
MA 88,200,44
TR 56,206,4096
MA 92,204,44
TR 58,206,12288
MA 152,72,44
    buffer_load_dwordx4 a[108:111], v8, s[8:11], s45 offen offset:3072 sc1
MA 156,76,44
LW 4
MA 96,200,48
TR 60,207,4096
    s_mov_b32 s45, 36864
MA 100,204,48
TR 62,207,12288
MA 160,72,48
    buffer_load_dwordx4 a[240:243], v7, s[8:11], s45 offen offset:0 sc1
MA 164,76,48
LW 4
MA 104,200,52
    s_barrier
TR 32,200,16384
MA 108,204,52
TR 34,200,24576
MA 168,72,52
    buffer_load_dwordx4 a[244:247], v7, s[8:11], s45 offen offset:1024 sc1
MA 172,76,52
LW 4
MA 112,200,56
TR 36,201,16384
MA 116,204,56
TR 38,201,24576
MA 176,72,56
    buffer_load_dwordx4 a[112:115], v8, s[8:11], s45 offen offset:0 sc1
MA 180,76,56
LW 4
MA 120,200,60
TR 40,202,16384
MA 124,204,60
TR 42,202,24576
MA 184,72,60
    buffer_load_dwordx4 a[116:119], v8, s[8:11], s45 offen offset:1024 sc1
MA 188,76,60
LW 4
MA 64,208,32
TR 44,203,16384
MA 68,212,32
TR 46,203,24576
MA 128,80,32
    buffer_load_dwordx4 a[248:251], v7, s[8:11], s45 offen offset:2048 sc1
MA 132,84,32
LW 4
MA 72,208,36
TR 48,204,16384
MA 76,212,36
TR 50,204,24576
MA 136,80,36
    buffer_load_dwordx4 a[252:255], v7, s[8:11], s45 offen offset:3072 sc1
MA 140,84,36
LW 4
MA 80,208,40
TR 52,205,16384
MA 84,212,40
TR 54,205,24576
MA 144,80,40
    buffer_load_dwordx4 a[120:123], v8, s[8:11], s45 offen offset:2048 sc1
MA 148,84,40
LW 4
MA 88,208,44
TR 56,206,16384
MA 92,212,44
TR 58,206,24576
MA 152,80,44
    buffer_load_dwordx4 a[124:127], v8, s[8:11], s45 offen offset:3072 sc1
MA 156,84,44
LW 4
MA 96,208,48
TR 60,207,16384
    s_add_u32 m0, s38, 131072
MA 100,212,48
TR 62,207,24576
    s_mov_b32 s44, 2752512
MA 160,80,48
    buffer_load_dwordx4 v9, s[4:7], s44 offen offset:0 lds
MA 164,84,48
LW 4
MA 104,208,52
TR 32,200,20480
MA 108,212,52
TR 34,200,28672
MA 168,80,52
    buffer_load_dwordx4 v10, s[4:7], s44 offen offset:1024 lds
MA 172,84,52
LW 4
MA 112,208,56
TR 36,201,20480
MA 116,212,56
TR 38,201,28672
MA 176,80,56
    buffer_load_dwordx4 v11, s[4:7], s44 offen offset:2048 lds
MA 180,84,56
LW 4
MA 120,208,60
TR 40,202,20480
MA 124,212,60
TR 42,202,28672
MA 184,80,60
    buffer_load_dwordx4 v12, s[4:7], s44 offen offset:3072 lds
MA 188,84,60
LW 4
MA 64,216,32
TR 44,203,20480
    s_add_u32 m0, s38, 147456
MA 68,220,32
TR 46,203,28672
    s_mov_b32 s44, 3211264
MA 128,88,32
    buffer_load_dwordx4 v9, s[4:7], s44 offen offset:0 lds
MA 132,92,32
LW 4
MA 72,216,36
TR 48,204,20480
MA 76,220,36
TR 50,204,28672
MA 136,88,36
    buffer_load_dwordx4 v10, s[4:7], s44 offen offset:1024 lds
MA 140,92,36
LW 4
MA 80,216,40
TR 52,205,20480
MA 84,220,40
TR 54,205,28672
MA 144,88,40
    buffer_load_dwordx4 v11, s[4:7], s44 offen offset:2048 lds
MA 148,92,40
LW 4
MA 88,216,44
TR 56,206,20480
MA 92,220,44
TR 58,206,28672
MA 152,88,44
    buffer_load_dwordx4 v12, s[4:7], s44 offen offset:3072 lds
MA 156,92,44
LW 4
MA 96,216,48
TR 60,207,20480
    s_mov_b32 s45, 24576
MA 100,220,48
TR 62,207,28672
MA 160,88,48
    buffer_load_dwordx4 a[128:131], v7, s[8:11], s45 offen offset:0 sc1
MA 164,92,48
LW 4
MA 104,216,52
    s_waitcnt vmcnt(17)
    s_barrier
TR 32,200,32768
MA 108,220,52
TR 34,200,40960
MA 168,88,52
    buffer_load_dwordx4 a[132:135], v7, s[8:11], s45 offen offset:1024 sc1
MA 172,92,52
LW 4
MA 112,216,56
TR 36,201,32768
MA 116,220,56
TR 38,201,40960
MA 176,88,56
    buffer_load_dwordx4 a[0:3], v8, s[8:11], s45 offen offset:0 sc1
MA 180,92,56
LW 4
MA 120,216,60
TR 40,202,32768
MA 124,220,60
TR 42,202,40960
MA 184,88,60
    buffer_load_dwordx4 a[4:7], v8, s[8:11], s45 offen offset:1024 sc1
MA 188,92,60
LW 4
MA 64,224,32
TR 44,203,32768
MA 68,228,32
TR 46,203,40960
MA 128,96,32
    buffer_load_dwordx4 a[136:139], v7, s[8:11], s45 offen offset:2048 sc1
MA 132,100,32
LW 4
MA 72,224,36
TR 48,204,32768
MA 76,228,36
TR 50,204,40960
MA 136,96,36
    buffer_load_dwordx4 a[140:143], v7, s[8:11], s45 offen offset:3072 sc1
MA 140,100,36
LW 4
MA 80,224,40
TR 52,205,32768
MA 84,228,40
TR 54,205,40960
MA 144,96,40
    buffer_load_dwordx4 a[8:11], v8, s[8:11], s45 offen offset:2048 sc1
MA 148,100,40
LW 4
MA 88,224,44
TR 56,206,32768
MA 92,228,44
TR 58,206,40960
MA 152,96,44
    buffer_load_dwordx4 a[12:15], v8, s[8:11], s45 offen offset:3072 sc1
MA 156,100,44
LW 4
MA 96,224,48
TR 60,207,32768
    s_mov_b32 s45, 28672
MA 100,228,48
TR 62,207,40960
MA 160,96,48
    buffer_load_dwordx4 a[144:147], v7, s[8:11], s45 offen offset:0 sc1
MA 164,100,48
LW 4
MA 104,224,52
TR 32,200,36864
MA 108,228,52
TR 34,200,45056
MA 168,96,52
    buffer_load_dwordx4 a[148:151], v7, s[8:11], s45 offen offset:1024 sc1
MA 172,100,52
LW 4
MA 112,224,56
TR 36,201,36864
MA 116,228,56
TR 38,201,45056
MA 176,96,56
    buffer_load_dwordx4 a[16:19], v8, s[8:11], s45 offen offset:0 sc1
MA 180,100,56
LW 4
MA 120,224,60
TR 40,202,36864
MA 124,228,60
TR 42,202,45056
MA 184,96,60
    buffer_load_dwordx4 a[20:23], v8, s[8:11], s45 offen offset:1024 sc1
MA 188,100,60
LW 4
MA 64,232,32
TR 44,203,36864
MA 68,236,32
TR 46,203,45056
MA 128,104,32
    buffer_load_dwordx4 a[152:155], v7, s[8:11], s45 offen offset:2048 sc1
MA 132,108,32
LW 4
MA 72,232,36
TR 48,204,36864
MA 76,236,36
TR 50,204,45056
MA 136,104,36
    buffer_load_dwordx4 a[156:159], v7, s[8:11], s45 offen offset:3072 sc1
MA 140,108,36
LW 4
MA 80,232,40
TR 52,205,36864
MA 84,236,40
TR 54,205,45056
MA 144,104,40
    buffer_load_dwordx4 a[24:27], v8, s[8:11], s45 offen offset:2048 sc1
MA 148,108,40
LW 4
MA 88,232,44
TR 56,206,36864
MA 92,236,44
TR 58,206,45056
MA 152,104,44
    buffer_load_dwordx4 a[28:31], v8, s[8:11], s45 offen offset:3072 sc1
MA 156,108,44
LW 4
MA 96,232,48
TR 60,207,36864
    s_add_u32 m0, s38, 0
MA 100,236,48
TR 62,207,45056
    s_mov_b32 s44, 4587520
MA 160,104,48
    buffer_load_dwordx4 v9, s[4:7], s44 offen offset:0 lds
MA 164,108,48
LW 4
MA 104,232,52
    s_waitcnt vmcnt(25)
    s_barrier
TR 32,200,49152
MA 108,236,52
TR 34,200,57344
MA 168,104,52
    buffer_load_dwordx4 v10, s[4:7], s44 offen offset:1024 lds
MA 172,108,52
LW 4
MA 112,232,56
TR 36,201,49152
MA 116,236,56
TR 38,201,57344
MA 176,104,56
    buffer_load_dwordx4 v11, s[4:7], s44 offen offset:2048 lds
MA 180,108,56
LW 4
MA 120,232,60
TR 40,202,49152
MA 124,236,60
TR 42,202,57344
MA 184,104,60
    buffer_load_dwordx4 v12, s[4:7], s44 offen offset:3072 lds
MA 188,108,60
LW 4
MA 64,240,32
TR 44,203,49152
    s_add_u32 m0, s38, 16384
MA 68,244,32
TR 46,203,57344
    s_mov_b32 s44, 5046272
MA 128,112,32
    buffer_load_dwordx4 v9, s[4:7], s44 offen offset:0 lds
MA 132,116,32
LW 4
MA 72,240,36
TR 48,204,49152
MA 76,244,36
TR 50,204,57344
MA 136,112,36
    buffer_load_dwordx4 v10, s[4:7], s44 offen offset:1024 lds
MA 140,116,36
LW 4
MA 80,240,40
TR 52,205,49152
MA 84,244,40
TR 54,205,57344
MA 144,112,40
    buffer_load_dwordx4 v11, s[4:7], s44 offen offset:2048 lds
MA 148,116,40
LW 4
MA 88,240,44
TR 56,206,49152
MA 92,244,44
TR 58,206,57344
MA 152,112,44
    buffer_load_dwordx4 v12, s[4:7], s44 offen offset:3072 lds
MA 156,116,44
LW 4
MA 96,240,48
TR 60,207,49152
    s_mov_b32 s45, 40960
MA 100,244,48
TR 62,207,57344
MA 160,112,48
    buffer_load_dwordx4 a[160:163], v7, s[8:11], s45 offen offset:0 sc1
MA 164,116,48
LW 4
MA 104,240,52
TR 32,200,53248
MA 108,244,52
TR 34,200,61440
MA 168,112,52
    buffer_load_dwordx4 a[164:167], v7, s[8:11], s45 offen offset:1024 sc1
MA 172,116,52
LW 4
MA 112,240,56
TR 36,201,53248
MA 116,244,56
TR 38,201,61440
MA 176,112,56
    buffer_load_dwordx4 a[32:35], v8, s[8:11], s45 offen offset:0 sc1
MA 180,116,56
LW 4
MA 120,240,60
TR 40,202,53248
MA 124,244,60
TR 42,202,61440
MA 184,112,60
    buffer_load_dwordx4 a[36:39], v8, s[8:11], s45 offen offset:1024 sc1
MA 188,116,60
LW 4
MA 64,248,32
TR 44,203,53248
MA 68,252,32
TR 46,203,61440
MA 128,120,32
    buffer_load_dwordx4 a[168:171], v7, s[8:11], s45 offen offset:2048 sc1
MA 132,124,32
LW 4
MA 72,248,36
TR 48,204,53248
MA 76,252,36
TR 50,204,61440
MA 136,120,36
    buffer_load_dwordx4 a[172:175], v7, s[8:11], s45 offen offset:3072 sc1
MA 140,124,36
LW 4
MA 80,248,40
TR 52,205,53248
MA 84,252,40
TR 54,205,61440
MA 144,120,40
    buffer_load_dwordx4 a[40:43], v8, s[8:11], s45 offen offset:2048 sc1
MA 148,124,40
LW 4
MA 88,248,44
TR 56,206,53248
MA 92,252,44
TR 58,206,61440
MA 152,120,44
    buffer_load_dwordx4 a[44:47], v8, s[8:11], s45 offen offset:3072 sc1
MA 156,124,44
LW 4
MA 96,248,48
TR 60,207,53248
    s_mov_b32 s45, 45056
MA 100,252,48
TR 62,207,61440
MA 160,120,48
    buffer_load_dwordx4 a[176:179], v7, s[8:11], s45 offen offset:0 sc1
MA 164,124,48
LW 4
MA 104,248,52
    s_waitcnt vmcnt(25)
    s_barrier
TR 32,208,0
MA 108,252,52
TR 34,208,8192
MA 168,120,52
    buffer_load_dwordx4 a[180:183], v7, s[8:11], s45 offen offset:1024 sc1
MA 172,124,52
LW 4
MA 112,248,56
TR 36,209,0
MA 116,252,56
TR 38,209,8192
MA 176,120,56
    buffer_load_dwordx4 a[48:51], v8, s[8:11], s45 offen offset:0 sc1
MA 180,124,56
LW 4
MA 120,248,60
TR 40,210,0
MA 124,252,60
TR 42,210,8192
MA 184,120,60
    buffer_load_dwordx4 a[52:55], v8, s[8:11], s45 offen offset:1024 sc1
MA 188,124,60
LW 4
MA 64,128,32
TR 44,211,0
MA 68,132,32
TR 46,211,8192
MA 128,0,32
    buffer_load_dwordx4 a[184:187], v7, s[8:11], s45 offen offset:2048 sc1
MA 132,4,32
LW 4
MA 72,128,36
TR 48,212,0
MA 76,132,36
TR 50,212,8192
MA 136,0,36
    buffer_load_dwordx4 a[188:191], v7, s[8:11], s45 offen offset:3072 sc1
MA 140,4,36
LW 4
MA 80,128,40
TR 52,213,0
MA 84,132,40
TR 54,213,8192
MA 144,0,40
    buffer_load_dwordx4 a[56:59], v8, s[8:11], s45 offen offset:2048 sc1
MA 148,4,40
LW 4
MA 88,128,44
TR 56,214,0
MA 92,132,44
TR 58,214,8192
MA 152,0,44
    buffer_load_dwordx4 a[60:63], v8, s[8:11], s45 offen offset:3072 sc1
MA 156,4,44
LW 4
MA 96,128,48
TR 60,215,0
    s_add_u32 m0, s38, 32768
MA 100,132,48
TR 62,215,8192
    s_mov_b32 s44, 5505024
MA 160,0,48
    buffer_load_dwordx4 v9, s[4:7], s44 offen offset:0 lds
MA 164,4,48
LW 4
MA 104,128,52
TR 32,208,4096
MA 108,132,52
TR 34,208,12288
MA 168,0,52
    buffer_load_dwordx4 v10, s[4:7], s44 offen offset:1024 lds
MA 172,4,52
LW 4
MA 112,128,56
TR 36,209,4096
MA 116,132,56
TR 38,209,12288
MA 176,0,56
    buffer_load_dwordx4 v11, s[4:7], s44 offen offset:2048 lds
MA 180,4,56
LW 4
MA 120,128,60
TR 40,210,4096
MA 124,132,60
TR 42,210,12288
MA 184,0,60
    buffer_load_dwordx4 v12, s[4:7], s44 offen offset:3072 lds
MA 188,4,60
LW 4
MA 64,136,32
TR 44,211,4096
    s_add_u32 m0, s38, 49152
MA 68,140,32
TR 46,211,12288
    s_mov_b32 s44, 5963776
MA 128,8,32
    buffer_load_dwordx4 v9, s[4:7], s44 offen offset:0 lds
MA 132,12,32
LW 4
MA 72,136,36
TR 48,212,4096
MA 76,140,36
TR 50,212,12288
MA 136,8,36
    buffer_load_dwordx4 v10, s[4:7], s44 offen offset:1024 lds
MA 140,12,36
LW 4
MA 80,136,40
TR 52,213,4096
MA 84,140,40
TR 54,213,12288
MA 144,8,40
    buffer_load_dwordx4 v11, s[4:7], s44 offen offset:2048 lds
MA 148,12,40
LW 4
MA 88,136,44
TR 56,214,4096
MA 92,140,44
TR 58,214,12288
MA 152,8,44
    buffer_load_dwordx4 v12, s[4:7], s44 offen offset:3072 lds
MA 156,12,44
LW 4
MA 96,136,48
TR 60,215,4096
    s_mov_b32 s45, 49152
MA 100,140,48
TR 62,215,12288
MA 160,8,48
    buffer_load_dwordx4 a[192:195], v7, s[8:11], s45 offen offset:0 sc1
MA 164,12,48
LW 4
MA 104,136,52
    s_waitcnt vmcnt(33)
    s_barrier
TR 32,208,16384
MA 108,140,52
TR 34,208,24576
MA 168,8,52
    buffer_load_dwordx4 a[196:199], v7, s[8:11], s45 offen offset:1024 sc1
MA 172,12,52
LW 4
MA 112,136,56
TR 36,209,16384
MA 116,140,56
TR 38,209,24576
MA 176,8,56
    buffer_load_dwordx4 a[64:67], v8, s[8:11], s45 offen offset:0 sc1
MA 180,12,56
LW 4
MA 120,136,60
TR 40,210,16384
MA 124,140,60
TR 42,210,24576
MA 184,8,60
    buffer_load_dwordx4 a[68:71], v8, s[8:11], s45 offen offset:1024 sc1
MA 188,12,60
LW 4
MA 64,144,32
TR 44,211,16384
MA 68,148,32
TR 46,211,24576
MA 128,16,32
    buffer_load_dwordx4 a[200:203], v7, s[8:11], s45 offen offset:2048 sc1
MA 132,20,32
LW 4
MA 72,144,36
TR 48,212,16384
MA 76,148,36
TR 50,212,24576
MA 136,16,36
    buffer_load_dwordx4 a[204:207], v7, s[8:11], s45 offen offset:3072 sc1
MA 140,20,36
LW 4
MA 80,144,40
TR 52,213,16384
MA 84,148,40
TR 54,213,24576
MA 144,16,40
    buffer_load_dwordx4 a[72:75], v8, s[8:11], s45 offen offset:2048 sc1
MA 148,20,40
LW 4
MA 88,144,44
TR 56,214,16384
MA 92,148,44
TR 58,214,24576
MA 152,16,44
    buffer_load_dwordx4 a[76:79], v8, s[8:11], s45 offen offset:3072 sc1
MA 156,20,44
LW 4
MA 96,144,48
TR 60,215,16384
    s_mov_b32 s45, 53248
MA 100,148,48
TR 62,215,24576
MA 160,16,48
    buffer_load_dwordx4 a[208:211], v7, s[8:11], s45 offen offset:0 sc1
MA 164,20,48
LW 4
MA 104,144,52
TR 32,208,20480
MA 108,148,52
TR 34,208,28672
MA 168,16,52
    buffer_load_dwordx4 a[212:215], v7, s[8:11], s45 offen offset:1024 sc1
MA 172,20,52
LW 4
MA 112,144,56
TR 36,209,20480
MA 116,148,56
TR 38,209,28672
MA 176,16,56
    buffer_load_dwordx4 a[80:83], v8, s[8:11], s45 offen offset:0 sc1
MA 180,20,56
LW 4
MA 120,144,60
TR 40,210,20480
MA 124,148,60
TR 42,210,28672
MA 184,16,60
    buffer_load_dwordx4 a[84:87], v8, s[8:11], s45 offen offset:1024 sc1
MA 188,20,60
LW 4
MA 64,152,32
TR 44,211,20480
MA 68,156,32
TR 46,211,28672
MA 128,24,32
    buffer_load_dwordx4 a[216:219], v7, s[8:11], s45 offen offset:2048 sc1
MA 132,28,32
LW 4
MA 72,152,36
TR 48,212,20480
MA 76,156,36
TR 50,212,28672
MA 136,24,36
    buffer_load_dwordx4 a[220:223], v7, s[8:11], s45 offen offset:3072 sc1
MA 140,28,36
LW 4
MA 80,152,40
TR 52,213,20480
MA 84,156,40
TR 54,213,28672
MA 144,24,40
    buffer_load_dwordx4 a[88:91], v8, s[8:11], s45 offen offset:2048 sc1
MA 148,28,40
LW 4
MA 88,152,44
TR 56,214,20480
MA 92,156,44
TR 58,214,28672
MA 152,24,44
    buffer_load_dwordx4 a[92:95], v8, s[8:11], s45 offen offset:3072 sc1
MA 156,28,44
LW 4
MA 96,152,48
TR 60,215,20480
    s_add_u32 m0, s38, 65536
MA 100,156,48
TR 62,215,28672
    s_mov_b32 s44, 7340032
MA 160,24,48
    buffer_load_dwordx4 v9, s[4:7], s44 offen offset:0 lds
MA 164,28,48
LW 4
MA 104,152,52
    s_waitcnt vmcnt(33)
    s_barrier
TR 32,192,0
MA 108,156,52
TR 34,192,8192
MA 168,24,52
    buffer_load_dwordx4 v10, s[4:7], s44 offen offset:1024 lds
MA 172,28,52
LW 4
MA 112,152,56
TR 36,193,0
MA 116,156,56
TR 38,193,8192
MA 176,24,56
    buffer_load_dwordx4 v11, s[4:7], s44 offen offset:2048 lds
MA 180,28,56
LW 4
MA 120,152,60
TR 40,194,0
MA 124,156,60
TR 42,194,8192
MA 184,24,60
    buffer_load_dwordx4 v12, s[4:7], s44 offen offset:3072 lds
MA 188,28,60
LW 4
MA 64,160,32
TR 44,195,0
    s_add_u32 m0, s38, 81920
MA 68,164,32
TR 46,195,8192
    s_mov_b32 s44, 7798784
MA 128,32,32
    buffer_load_dwordx4 v9, s[4:7], s44 offen offset:0 lds
MA 132,36,32
LW 4
MA 72,160,36
TR 48,196,0
MA 76,164,36
TR 50,196,8192
MA 136,32,36
    buffer_load_dwordx4 v10, s[4:7], s44 offen offset:1024 lds
MA 140,36,36
    buffer_load_dwordx2 v[26:27], v22, s[8:11], 0 offen offset:256 sc1
LW 4
MA 80,160,40
TR 52,197,0
MA 84,164,40
TR 54,197,8192
MA 144,32,40
    buffer_load_dwordx4 v11, s[4:7], s44 offen offset:2048 lds
MA 148,36,40
LW 4
MA 88,160,44
TR 56,198,0
MA 92,164,44
TR 58,198,8192
MA 152,32,44
    buffer_load_dwordx4 v12, s[4:7], s44 offen offset:3072 lds
MA 156,36,44
LW 4
MA 96,160,48
TR 60,199,0
MA 100,164,48
TR 62,199,8192
MA 160,32,48
MA 164,36,48
LW 4
MA 104,160,52
TR 32,192,4096
MA 108,164,52
TR 34,192,12288
MA 168,32,52
MA 172,36,52
LW 4
MA 112,160,56
TR 36,193,4096
MA 116,164,56
TR 38,193,12288
MA 176,32,56
MA 180,36,56
LW 4
MA 120,160,60
TR 40,194,4096
MA 124,164,60
TR 42,194,12288
MA 184,32,60
MA 188,36,60
LW 4
MA 64,168,32
TR 44,195,4096
MA 68,172,32
TR 46,195,12288
MA 128,40,32
MA 132,44,32
LW 4
MA 72,168,36
TR 48,196,4096
MA 76,172,36
TR 50,196,12288
MA 136,40,36
MA 140,44,36
LW 4
MA 80,168,40
TR 52,197,4096
MA 84,172,40
TR 54,197,12288
MA 144,40,40
MA 148,44,40
LW 4
MA 88,168,44
TR 56,198,4096
MA 92,172,44
TR 58,198,12288
MA 152,40,44
MA 156,44,44
LW 4
MA 96,168,48
TR 60,199,4096
MA 100,172,48
TR 62,199,12288
MA 160,40,48
MA 164,44,48
LW 4
MA 104,168,52
    s_waitcnt vmcnt(33)
    s_barrier
TR 32,192,16384
MA 108,172,52
TR 34,192,24576
MA 168,40,52
MA 172,44,52
LW 4
MA 112,168,56
TR 36,193,16384
MA 116,172,56
TR 38,193,24576
MA 176,40,56
MA 180,44,56
LW 4
MA 120,168,60
TR 40,194,16384
MA 124,172,60
TR 42,194,24576
MA 184,40,60
MA 188,44,60
    s_waitcnt vmcnt(2)
    v_cmp_ne_u64 vcc, s[56:57], v[26:27]
    s_nop 1
    s_cmp_lg_u64 vcc, 0
    s_cbranch_scc1 L_miss11
L_back11:
LW 4
MA 64,176,32
TR 44,195,16384
    s_mov_b32 s45, 65536
MA 68,180,32
TR 46,195,24576
MA 128,48,32
    buffer_load_dwordx4 a[224:227], v7, s[8:11], s45 offen offset:0 sc1
MA 132,52,32
LW 4
MA 72,176,36
TR 48,196,16384
MA 76,180,36
TR 50,196,24576
MA 136,48,36
    buffer_load_dwordx4 a[228:231], v7, s[8:11], s45 offen offset:1024 sc1
MA 140,52,36
LW 4
MA 80,176,40
TR 52,197,16384
MA 84,180,40
TR 54,197,24576
MA 144,48,40
    buffer_load_dwordx4 a[96:99], v8, s[8:11], s45 offen offset:0 sc1
MA 148,52,40
LW 4
MA 88,176,44
TR 56,198,16384
MA 92,180,44
TR 58,198,24576
MA 152,48,44
    buffer_load_dwordx4 a[100:103], v8, s[8:11], s45 offen offset:1024 sc1
MA 156,52,44
LW 4
MA 96,176,48
TR 60,199,16384
MA 100,180,48
TR 62,199,24576
MA 160,48,48
    buffer_load_dwordx4 a[232:235], v7, s[8:11], s45 offen offset:2048 sc1
MA 164,52,48
LW 4
MA 104,176,52
TR 32,192,20480
MA 108,180,52
TR 34,192,28672
MA 168,48,52
    buffer_load_dwordx4 a[236:239], v7, s[8:11], s45 offen offset:3072 sc1
MA 172,52,52
LW 4
MA 112,176,56
TR 36,193,20480
MA 116,180,56
TR 38,193,28672
MA 176,48,56
    buffer_load_dwordx4 a[104:107], v8, s[8:11], s45 offen offset:2048 sc1
MA 180,52,56
LW 4
MA 120,176,60
TR 40,194,20480
MA 124,180,60
TR 42,194,28672
MA 184,48,60
    buffer_load_dwordx4 a[108:111], v8, s[8:11], s45 offen offset:3072 sc1
MA 188,52,60
LW 4
MA 64,184,32
TR 44,195,20480
    s_mov_b32 s45, 69632
MA 68,188,32
TR 46,195,28672
MA 128,56,32
    buffer_load_dwordx4 a[240:243], v7, s[8:11], s45 offen offset:0 sc1
MA 132,60,32
LW 4
MA 72,184,36
TR 48,196,20480
MA 76,188,36
TR 50,196,28672
MA 136,56,36
    buffer_load_dwordx4 a[244:247], v7, s[8:11], s45 offen offset:1024 sc1
MA 140,60,36
LW 4
MA 80,184,40
TR 52,197,20480
MA 84,188,40
TR 54,197,28672
MA 144,56,40
    buffer_load_dwordx4 a[112:115], v8, s[8:11], s45 offen offset:0 sc1
MA 148,60,40
LW 4
MA 88,184,44
TR 56,198,20480
MA 92,188,44
TR 58,198,28672
MA 152,56,44
    buffer_load_dwordx4 a[116:119], v8, s[8:11], s45 offen offset:1024 sc1
MA 156,60,44
LW 4
MA 96,184,48
TR 60,199,20480
MA 100,188,48
TR 62,199,28672
MA 160,56,48
    buffer_load_dwordx4 a[248:251], v7, s[8:11], s45 offen offset:2048 sc1
MA 164,60,48
LW 4
MA 104,184,52
    s_barrier
TR 32,192,32768
MA 108,188,52
TR 34,192,40960
MA 168,56,52
    buffer_load_dwordx4 a[252:255], v7, s[8:11], s45 offen offset:3072 sc1
MA 172,60,52
LW 4
MA 112,184,56
TR 36,193,32768
MA 116,188,56
TR 38,193,40960
MA 176,56,56
    buffer_load_dwordx4 a[120:123], v8, s[8:11], s45 offen offset:2048 sc1
MA 180,60,56
LW 4
MA 120,184,60
TR 40,194,32768
MA 124,188,60
TR 42,194,40960
MA 184,56,60
    buffer_load_dwordx4 a[124:127], v8, s[8:11], s45 offen offset:3072 sc1
MA 188,60,60
LW 4
MA 64,192,32
TR 44,195,32768
    s_add_u32 m0, s38, 98304
MA 68,196,32
TR 46,195,40960
    s_mov_b32 s44, 6422528
MA 128,64,32
    buffer_load_dwordx4 v9, s[4:7], s44 offen offset:0 lds
MA 132,68,32
LW 4
MA 72,192,36
TR 48,196,32768
MA 76,196,36
TR 50,196,40960
MA 136,64,36
    buffer_load_dwordx4 v10, s[4:7], s44 offen offset:1024 lds
MA 140,68,36
LW 4
MA 80,192,40
TR 52,197,32768
MA 84,196,40
TR 54,197,40960
MA 144,64,40
    buffer_load_dwordx4 v11, s[4:7], s44 offen offset:2048 lds
MA 148,68,40
LW 4
MA 88,192,44
TR 56,198,32768
MA 92,196,44
TR 58,198,40960
MA 152,64,44
    buffer_load_dwordx4 v12, s[4:7], s44 offen offset:3072 lds
MA 156,68,44
LW 4
MA 96,192,48
TR 60,199,32768
    s_add_u32 m0, s38, 114688
MA 100,196,48
TR 62,199,40960
    s_mov_b32 s44, 6881280
MA 160,64,48
    buffer_load_dwordx4 v9, s[4:7], s44 offen offset:0 lds
MA 164,68,48
LW 4
MA 104,192,52
TR 32,192,36864
MA 108,196,52
TR 34,192,45056
MA 168,64,52
    buffer_load_dwordx4 v10, s[4:7], s44 offen offset:1024 lds
MA 172,68,52
LW 4
MA 112,192,56
TR 36,193,36864
MA 116,196,56
TR 38,193,45056
MA 176,64,56
    buffer_load_dwordx4 v11, s[4:7], s44 offen offset:2048 lds
MA 180,68,56
LW 4
MA 120,192,60
TR 40,194,36864
MA 124,196,60
TR 42,194,45056
MA 184,64,60
    buffer_load_dwordx4 v12, s[4:7], s44 offen offset:3072 lds
MA 188,68,60
LW 4
MA 64,200,32
TR 44,195,36864
    s_mov_b32 s45, 57344
MA 68,204,32
TR 46,195,45056
MA 128,72,32
    buffer_load_dwordx4 a[128:131], v7, s[8:11], s45 offen offset:0 sc1
MA 132,76,32
LW 4
MA 72,200,36
TR 48,196,36864
MA 76,204,36
TR 50,196,45056
MA 136,72,36
    buffer_load_dwordx4 a[132:135], v7, s[8:11], s45 offen offset:1024 sc1
MA 140,76,36
LW 4
MA 80,200,40
TR 52,197,36864
MA 84,204,40
TR 54,197,45056
MA 144,72,40
    buffer_load_dwordx4 a[0:3], v8, s[8:11], s45 offen offset:0 sc1
MA 148,76,40
LW 4
MA 88,200,44
TR 56,198,36864
MA 92,204,44
TR 58,198,45056
MA 152,72,44
    buffer_load_dwordx4 a[4:7], v8, s[8:11], s45 offen offset:1024 sc1
MA 156,76,44
LW 4
MA 96,200,48
TR 60,199,36864
MA 100,204,48
TR 62,199,45056
MA 160,72,48
    buffer_load_dwordx4 a[136:139], v7, s[8:11], s45 offen offset:2048 sc1
MA 164,76,48
LW 4
MA 104,200,52
    s_barrier
TR 32,192,49152
MA 108,204,52
TR 34,192,57344
MA 168,72,52
    buffer_load_dwordx4 a[140:143], v7, s[8:11], s45 offen offset:3072 sc1
MA 172,76,52
LW 4
MA 112,200,56
TR 36,193,49152
MA 116,204,56
TR 38,193,57344
MA 176,72,56
    buffer_load_dwordx4 a[8:11], v8, s[8:11], s45 offen offset:2048 sc1
MA 180,76,56
LW 4
MA 120,200,60
TR 40,194,49152
MA 124,204,60
TR 42,194,57344
MA 184,72,60
    buffer_load_dwordx4 a[12:15], v8, s[8:11], s45 offen offset:3072 sc1
MA 188,76,60
LW 4
MA 64,208,32
TR 44,195,49152
    s_mov_b32 s45, 61440
MA 68,212,32
TR 46,195,57344
MA 128,80,32
    buffer_load_dwordx4 a[144:147], v7, s[8:11], s45 offen offset:0 sc1
MA 132,84,32
LW 4
MA 72,208,36
TR 48,196,49152
MA 76,212,36
TR 50,196,57344
MA 136,80,36
    buffer_load_dwordx4 a[148:151], v7, s[8:11], s45 offen offset:1024 sc1
MA 140,84,36
LW 4
MA 80,208,40
TR 52,197,49152
MA 84,212,40
TR 54,197,57344
MA 144,80,40
    buffer_load_dwordx4 a[16:19], v8, s[8:11], s45 offen offset:0 sc1
MA 148,84,40
LW 4
MA 88,208,44
TR 56,198,49152
MA 92,212,44
TR 58,198,57344
MA 152,80,44
    buffer_load_dwordx4 a[20:23], v8, s[8:11], s45 offen offset:1024 sc1
MA 156,84,44
LW 4
MA 96,208,48
TR 60,199,49152
MA 100,212,48
TR 62,199,57344
MA 160,80,48
    buffer_load_dwordx4 a[152:155], v7, s[8:11], s45 offen offset:2048 sc1
MA 164,84,48
LW 4
MA 104,208,52
TR 32,192,53248
MA 108,212,52
TR 34,192,61440
MA 168,80,52
    buffer_load_dwordx4 a[156:159], v7, s[8:11], s45 offen offset:3072 sc1
MA 172,84,52
LW 4
MA 112,208,56
TR 36,193,53248
MA 116,212,56
TR 38,193,61440
MA 176,80,56
    buffer_load_dwordx4 a[24:27], v8, s[8:11], s45 offen offset:2048 sc1
MA 180,84,56
LW 4
MA 120,208,60
TR 40,194,53248
MA 124,212,60
TR 42,194,61440
MA 184,80,60
    buffer_load_dwordx4 a[28:31], v8, s[8:11], s45 offen offset:3072 sc1
MA 188,84,60
LW 4
MA 64,216,32
TR 44,195,53248
    s_add_u32 m0, s38, 131072
MA 68,220,32
TR 46,195,61440
    s_mov_b32 s44, 8257536
MA 128,88,32
    buffer_load_dwordx4 v9, s[4:7], s44 offen offset:0 lds
MA 132,92,32
LW 4
MA 72,216,36
TR 48,196,53248
MA 76,220,36
TR 50,196,61440
MA 136,88,36
    buffer_load_dwordx4 v10, s[4:7], s44 offen offset:1024 lds
MA 140,92,36
LW 4
MA 80,216,40
TR 52,197,53248
MA 84,220,40
TR 54,197,61440
MA 144,88,40
    buffer_load_dwordx4 v11, s[4:7], s44 offen offset:2048 lds
MA 148,92,40
LW 4
MA 88,216,44
TR 56,198,53248
MA 92,220,44
TR 58,198,61440
MA 152,88,44
    buffer_load_dwordx4 v12, s[4:7], s44 offen offset:3072 lds
MA 156,92,44
LW 4
MA 96,216,48
TR 60,199,53248
    s_add_u32 m0, s38, 147456
MA 100,220,48
TR 62,199,61440
    s_mov_b32 s44, 8716288
MA 160,88,48
    buffer_load_dwordx4 v9, s[4:7], s44 offen offset:0 lds
MA 164,92,48
LW 4
MA 104,216,52
    s_waitcnt vmcnt(37)
    s_barrier
TR 32,200,0
MA 108,220,52
TR 34,200,8192
MA 168,88,52
    buffer_load_dwordx4 v10, s[4:7], s44 offen offset:1024 lds
MA 172,92,52
LW 4
MA 112,216,56
TR 36,201,0
MA 116,220,56
TR 38,201,8192
MA 176,88,56
    buffer_load_dwordx4 v11, s[4:7], s44 offen offset:2048 lds
MA 180,92,56
LW 4
MA 120,216,60
TR 40,202,0
MA 124,220,60
TR 42,202,8192
MA 184,88,60
    buffer_load_dwordx4 v12, s[4:7], s44 offen offset:3072 lds
MA 188,92,60
LW 4
MA 64,224,32
TR 44,203,0
    s_mov_b32 s45, 73728
MA 68,228,32
TR 46,203,8192
MA 128,96,32
    buffer_load_dwordx4 a[160:163], v7, s[8:11], s45 offen offset:0 sc1
MA 132,100,32
LW 4
MA 72,224,36
TR 48,204,0
MA 76,228,36
TR 50,204,8192
MA 136,96,36
    buffer_load_dwordx4 a[164:167], v7, s[8:11], s45 offen offset:1024 sc1
MA 140,100,36
LW 4
MA 80,224,40
TR 52,205,0
MA 84,228,40
TR 54,205,8192
MA 144,96,40
    buffer_load_dwordx4 a[32:35], v8, s[8:11], s45 offen offset:0 sc1
MA 148,100,40
LW 4
MA 88,224,44
TR 56,206,0
MA 92,228,44
TR 58,206,8192
MA 152,96,44
    buffer_load_dwordx4 a[36:39], v8, s[8:11], s45 offen offset:1024 sc1
MA 156,100,44
LW 4
MA 96,224,48
TR 60,207,0
MA 100,228,48
TR 62,207,8192
MA 160,96,48
    buffer_load_dwordx4 a[168:171], v7, s[8:11], s45 offen offset:2048 sc1
MA 164,100,48
LW 4
MA 104,224,52
TR 32,200,4096
MA 108,228,52
TR 34,200,12288
MA 168,96,52
    buffer_load_dwordx4 a[172:175], v7, s[8:11], s45 offen offset:3072 sc1
MA 172,100,52
LW 4
MA 112,224,56
TR 36,201,4096
MA 116,228,56
TR 38,201,12288
MA 176,96,56
    buffer_load_dwordx4 a[40:43], v8, s[8:11], s45 offen offset:2048 sc1
MA 180,100,56
LW 4
MA 120,224,60
TR 40,202,4096
MA 124,228,60
TR 42,202,12288
MA 184,96,60
    buffer_load_dwordx4 a[44:47], v8, s[8:11], s45 offen offset:3072 sc1
MA 188,100,60
LW 4
MA 64,232,32
TR 44,203,4096
    s_mov_b32 s45, 77824
MA 68,236,32
TR 46,203,12288
MA 128,104,32
    buffer_load_dwordx4 a[176:179], v7, s[8:11], s45 offen offset:0 sc1
MA 132,108,32
LW 4
MA 72,232,36
TR 48,204,4096
MA 76,236,36
TR 50,204,12288
MA 136,104,36
    buffer_load_dwordx4 a[180:183], v7, s[8:11], s45 offen offset:1024 sc1
MA 140,108,36
LW 4
MA 80,232,40
TR 52,205,4096
MA 84,236,40
TR 54,205,12288
MA 144,104,40
    buffer_load_dwordx4 a[48:51], v8, s[8:11], s45 offen offset:0 sc1
MA 148,108,40
LW 4
MA 88,232,44
TR 56,206,4096
MA 92,236,44
TR 58,206,12288
MA 152,104,44
    buffer_load_dwordx4 a[52:55], v8, s[8:11], s45 offen offset:1024 sc1
MA 156,108,44
LW 4
MA 96,232,48
TR 60,207,4096
MA 100,236,48
TR 62,207,12288
MA 160,104,48
    buffer_load_dwordx4 a[184:187], v7, s[8:11], s45 offen offset:2048 sc1
MA 164,108,48
LW 4
MA 104,232,52
    s_waitcnt vmcnt(45)
    s_barrier
TR 32,200,16384
MA 108,236,52
TR 34,200,24576
MA 168,104,52
    buffer_load_dwordx4 a[188:191], v7, s[8:11], s45 offen offset:3072 sc1
MA 172,108,52
LW 4
MA 112,232,56
TR 36,201,16384
MA 116,236,56
TR 38,201,24576
MA 176,104,56
    buffer_load_dwordx4 a[56:59], v8, s[8:11], s45 offen offset:2048 sc1
MA 180,108,56
LW 4
MA 120,232,60
TR 40,202,16384
MA 124,236,60
TR 42,202,24576
MA 184,104,60
    buffer_load_dwordx4 a[60:63], v8, s[8:11], s45 offen offset:3072 sc1
MA 188,108,60
LW 4
MA 64,240,32
TR 44,203,16384
    s_add_u32 m0, s38, 0
MA 68,244,32
TR 46,203,24576
    s_mov_b32 s44, 9175040
MA 128,112,32
    buffer_load_dwordx4 v9, s[4:7], s44 offen offset:0 lds
MA 132,116,32
LW 4
MA 72,240,36
TR 48,204,16384
MA 76,244,36
TR 50,204,24576
MA 136,112,36
    buffer_load_dwordx4 v10, s[4:7], s44 offen offset:1024 lds
MA 140,116,36
LW 4
MA 80,240,40
TR 52,205,16384
MA 84,244,40
TR 54,205,24576
MA 144,112,40
    buffer_load_dwordx4 v11, s[4:7], s44 offen offset:2048 lds
MA 148,116,40
LW 4
MA 88,240,44
TR 56,206,16384
MA 92,244,44
TR 58,206,24576
MA 152,112,44
    buffer_load_dwordx4 v12, s[4:7], s44 offen offset:3072 lds
MA 156,116,44
LW 4
MA 96,240,48
TR 60,207,16384
    s_add_u32 m0, s38, 16384
MA 100,244,48
TR 62,207,24576
    s_mov_b32 s44, 9633792
MA 160,112,48
    buffer_load_dwordx4 v9, s[4:7], s44 offen offset:0 lds
MA 164,116,48
LW 4
MA 104,240,52
TR 32,200,20480
MA 108,244,52
TR 34,200,28672
MA 168,112,52
    buffer_load_dwordx4 v10, s[4:7], s44 offen offset:1024 lds
MA 172,116,52
LW 4
MA 112,240,56
TR 36,201,20480
MA 116,244,56
TR 38,201,28672
MA 176,112,56
    buffer_load_dwordx4 v11, s[4:7], s44 offen offset:2048 lds
MA 180,116,56
LW 4
MA 120,240,60
TR 40,202,20480
MA 124,244,60
TR 42,202,28672
MA 184,112,60
    buffer_load_dwordx4 v12, s[4:7], s44 offen offset:3072 lds
MA 188,116,60
LW 4
MA 64,248,32
TR 44,203,20480
    s_mov_b32 s45, 81920
MA 68,252,32
TR 46,203,28672
MA 128,120,32
    buffer_load_dwordx4 a[64:67], v8, s[8:11], s45 offen offset:0 sc1
MA 132,124,32
LW 4
MA 72,248,36
TR 48,204,20480
MA 76,252,36
TR 50,204,28672
MA 136,120,36
    buffer_load_dwordx4 a[68:71], v8, s[8:11], s45 offen offset:1024 sc1
MA 140,124,36
LW 4
MA 80,248,40
TR 52,205,20480
MA 84,252,40
TR 54,205,28672
MA 144,120,40
    buffer_load_dwordx4 a[72:75], v8, s[8:11], s45 offen offset:2048 sc1
MA 148,124,40
LW 4
MA 88,248,44
TR 56,206,20480
MA 92,252,44
TR 58,206,28672
MA 152,120,44
    buffer_load_dwordx4 a[76:79], v8, s[8:11], s45 offen offset:3072 sc1
MA 156,124,44
LW 4
MA 96,248,48
TR 60,207,20480
    s_mov_b32 s45, 86016
MA 100,252,48
TR 62,207,28672
MA 160,120,48
    buffer_load_dwordx4 a[80:83], v8, s[8:11], s45 offen offset:0 sc1
MA 164,124,48
LW 4
MA 104,248,52
    s_waitcnt vmcnt(45)
    s_barrier
TR 32,200,32768
MA 108,252,52
TR 34,200,40960
MA 168,120,52
    buffer_load_dwordx4 a[84:87], v8, s[8:11], s45 offen offset:1024 sc1
MA 172,124,52
LW 4
MA 112,248,56
TR 36,201,32768
MA 116,252,56
TR 38,201,40960
MA 176,120,56
    buffer_load_dwordx4 a[88:91], v8, s[8:11], s45 offen offset:2048 sc1
MA 180,124,56
LW 4
MA 120,248,60
TR 40,202,32768
MA 124,252,60
TR 42,202,40960
MA 184,120,60
    buffer_load_dwordx4 a[92:95], v8, s[8:11], s45 offen offset:3072 sc1
MA 188,124,60
LW 4
MA 64,128,32
TR 44,203,32768
    s_add_u32 m0, s38, 32768
MA 68,132,32
TR 46,203,40960
    s_mov_b32 s44, 11010048
MA 128,0,32
    buffer_load_dwordx4 v9, s[4:7], s44 offen offset:0 lds
MA 132,4,32
LW 4
MA 72,128,36
TR 48,204,32768
MA 76,132,36
TR 50,204,40960
MA 136,0,36
    buffer_load_dwordx4 v10, s[4:7], s44 offen offset:1024 lds
MA 140,4,36
LW 4
MA 80,128,40
TR 52,205,32768
MA 84,132,40
TR 54,205,40960
MA 144,0,40
    buffer_load_dwordx4 v11, s[4:7], s44 offen offset:2048 lds
MA 148,4,40
LW 4
MA 88,128,44
TR 56,206,32768
MA 92,132,44
TR 58,206,40960
MA 152,0,44
    buffer_load_dwordx4 v12, s[4:7], s44 offen offset:3072 lds
MA 156,4,44
LW 4
MA 96,128,48
TR 60,207,32768
    s_add_u32 m0, s38, 49152
MA 100,132,48
TR 62,207,40960
    s_mov_b32 s44, 11468800
MA 160,0,48
    buffer_load_dwordx4 v9, s[4:7], s44 offen offset:0 lds
MA 164,4,48
LW 4
MA 104,128,52
TR 32,200,36864
MA 108,132,52
TR 34,200,45056
MA 168,0,52
    buffer_load_dwordx4 v10, s[4:7], s44 offen offset:1024 lds
MA 172,4,52
LW 4
MA 112,128,56
TR 36,201,36864
MA 116,132,56
TR 38,201,45056
MA 176,0,56
    buffer_load_dwordx4 v11, s[4:7], s44 offen offset:2048 lds
MA 180,4,56
LW 4
MA 120,128,60
TR 40,202,36864
MA 124,132,60
TR 42,202,45056
MA 184,0,60
    buffer_load_dwordx4 v12, s[4:7], s44 offen offset:3072 lds
MA 188,4,60
LW 4
MA 64,136,32
TR 44,203,36864
MA 68,140,32
TR 46,203,45056
MA 128,8,32
MA 132,12,32
LW 4
MA 72,136,36
TR 48,204,36864
MA 76,140,36
TR 50,204,45056
MA 136,8,36
MA 140,12,36
LW 4
MA 80,136,40
TR 52,205,36864
MA 84,140,40
TR 54,205,45056
MA 144,8,40
MA 148,12,40
LW 4
MA 88,136,44
TR 56,206,36864
MA 92,140,44
TR 58,206,45056
MA 152,8,44
MA 156,12,44
LW 4
MA 96,136,48
TR 60,207,36864
MA 100,140,48
TR 62,207,45056
MA 160,8,48
MA 164,12,48
LW 4
MA 104,136,52
    s_waitcnt vmcnt(48)
    s_barrier
TR 32,200,49152
MA 108,140,52
TR 34,200,57344
MA 168,8,52
MA 172,12,52
LW 4
MA 112,136,56
TR 36,201,49152
MA 116,140,56
TR 38,201,57344
MA 176,8,56
MA 180,12,56
LW 4
MA 120,136,60
TR 40,202,49152
MA 124,140,60
TR 42,202,57344
MA 184,8,60
MA 188,12,60
LW 4
MA 64,144,32
TR 44,203,49152
MA 68,148,32
TR 46,203,57344
MA 128,16,32
MA 132,20,32
LW 4
MA 72,144,36
TR 48,204,49152
MA 76,148,36
TR 50,204,57344
MA 136,16,36
MA 140,20,36
LW 4
MA 80,144,40
TR 52,205,49152
MA 84,148,40
TR 54,205,57344
MA 144,16,40
MA 148,20,40
LW 4
MA 88,144,44
TR 56,206,49152
MA 92,148,44
TR 58,206,57344
MA 152,16,44
MA 156,20,44
LW 4
MA 96,144,48
TR 60,207,49152
    s_mov_b32 s45, 98304
MA 100,148,48
TR 62,207,57344
MA 160,16,48
    buffer_load_dwordx4 a[96:99], v8, s[8:11], s45 offen offset:0 sc1
MA 164,20,48
LW 4
MA 104,144,52
TR 32,200,53248
MA 108,148,52
TR 34,200,61440
MA 168,16,52
    buffer_load_dwordx4 a[100:103], v8, s[8:11], s45 offen offset:1024 sc1
MA 172,20,52
LW 4
MA 112,144,56
TR 36,201,53248
MA 116,148,56
TR 38,201,61440
MA 176,16,56
    buffer_load_dwordx4 a[104:107], v8, s[8:11], s45 offen offset:2048 sc1
MA 180,20,56
LW 4
MA 120,144,60
TR 40,202,53248
MA 124,148,60
TR 42,202,61440
MA 184,16,60
    buffer_load_dwordx4 a[108:111], v8, s[8:11], s45 offen offset:3072 sc1
MA 188,20,60
LW 4
MA 64,152,32
TR 44,203,53248
    s_mov_b32 s45, 102400
MA 68,156,32
TR 46,203,61440
MA 128,24,32
    buffer_load_dwordx4 a[112:115], v8, s[8:11], s45 offen offset:0 sc1
MA 132,28,32
LW 4
MA 72,152,36
TR 48,204,53248
MA 76,156,36
TR 50,204,61440
MA 136,24,36
    buffer_load_dwordx4 a[116:119], v8, s[8:11], s45 offen offset:1024 sc1
MA 140,28,36
LW 4
MA 80,152,40
TR 52,205,53248
MA 84,156,40
TR 54,205,61440
MA 144,24,40
    buffer_load_dwordx4 a[120:123], v8, s[8:11], s45 offen offset:2048 sc1
MA 148,28,40
LW 4
MA 88,152,44
TR 56,206,53248
MA 92,156,44
TR 58,206,61440
MA 152,24,44
    buffer_load_dwordx4 a[124:127], v8, s[8:11], s45 offen offset:3072 sc1
MA 156,28,44
LW 4
MA 96,152,48
TR 60,207,53248
    s_add_u32 m0, s38, 65536
MA 100,156,48
TR 62,207,61440
    s_mov_b32 s44, 10092544
MA 160,24,48
    buffer_load_dwordx4 v9, s[4:7], s44 offen offset:0 lds
MA 164,28,48
LW 4
MA 104,152,52
    s_waitcnt vmcnt(41)
    s_barrier
TR 32,208,0
MA 108,156,52
TR 34,208,8192
MA 168,24,52
    buffer_load_dwordx4 v10, s[4:7], s44 offen offset:1024 lds
MA 172,28,52
LW 4
MA 112,152,56
TR 36,209,0
MA 116,156,56
TR 38,209,8192
MA 176,24,56
    buffer_load_dwordx4 v11, s[4:7], s44 offen offset:2048 lds
MA 180,28,56
LW 4
MA 120,152,60
TR 40,210,0
MA 124,156,60
TR 42,210,8192
MA 184,24,60
    buffer_load_dwordx4 v12, s[4:7], s44 offen offset:3072 lds
MA 188,28,60
LW 4
MA 64,160,32
TR 44,211,0
    s_add_u32 m0, s38, 81920
MA 68,164,32
TR 46,211,8192
    s_mov_b32 s44, 10551296
MA 128,32,32
    buffer_load_dwordx4 v9, s[4:7], s44 offen offset:0 lds
MA 132,36,32
LW 4
MA 72,160,36
TR 48,212,0
MA 76,164,36
TR 50,212,8192
MA 136,32,36
    buffer_load_dwordx4 v10, s[4:7], s44 offen offset:1024 lds
MA 140,36,36
LW 4
MA 80,160,40
TR 52,213,0
MA 84,164,40
TR 54,213,8192
MA 144,32,40
    buffer_load_dwordx4 v11, s[4:7], s44 offen offset:2048 lds
MA 148,36,40
LW 4
MA 88,160,44
TR 56,214,0
MA 92,164,44
TR 58,214,8192
MA 152,32,44
    buffer_load_dwordx4 v12, s[4:7], s44 offen offset:3072 lds
MA 156,36,44
LW 4
MA 96,160,48
TR 60,215,0
    s_mov_b32 s45, 90112
MA 100,164,48
TR 62,215,8192
MA 160,32,48
    buffer_load_dwordx4 a[0:3], v8, s[8:11], s45 offen offset:0 sc1
MA 164,36,48
LW 4
MA 104,160,52
TR 32,208,4096
MA 108,164,52
TR 34,208,12288
MA 168,32,52
    buffer_load_dwordx4 a[4:7], v8, s[8:11], s45 offen offset:1024 sc1
MA 172,36,52
LW 4
MA 112,160,56
TR 36,209,4096
MA 116,164,56
TR 38,209,12288
MA 176,32,56
    buffer_load_dwordx4 a[8:11], v8, s[8:11], s45 offen offset:2048 sc1
MA 180,36,56
LW 4
MA 120,160,60
TR 40,210,4096
MA 124,164,60
TR 42,210,12288
MA 184,32,60
    buffer_load_dwordx4 a[12:15], v8, s[8:11], s45 offen offset:3072 sc1
MA 188,36,60
LW 4
MA 64,168,32
TR 44,211,4096
    s_mov_b32 s45, 94208
MA 68,172,32
TR 46,211,12288
MA 128,40,32
    buffer_load_dwordx4 a[16:19], v8, s[8:11], s45 offen offset:0 sc1
MA 132,44,32
LW 4
MA 72,168,36
TR 48,212,4096
MA 76,172,36
TR 50,212,12288
MA 136,40,36
    buffer_load_dwordx4 a[20:23], v8, s[8:11], s45 offen offset:1024 sc1
MA 140,44,36
LW 4
MA 80,168,40
TR 52,213,4096
MA 84,172,40
TR 54,213,12288
MA 144,40,40
    buffer_load_dwordx4 a[24:27], v8, s[8:11], s45 offen offset:2048 sc1
MA 148,44,40
LW 4
MA 88,168,44
TR 56,214,4096
MA 92,172,44
TR 58,214,12288
MA 152,40,44
    buffer_load_dwordx4 a[28:31], v8, s[8:11], s45 offen offset:3072 sc1
MA 156,44,44
LW 4
MA 96,168,48
TR 60,215,4096
    s_add_u32 m0, s38, 98304
MA 100,172,48
TR 62,215,12288
    s_mov_b32 s44, 11927552
MA 160,40,48
    buffer_load_dwordx4 v9, s[4:7], s44 offen offset:0 lds
MA 164,44,48
LW 4
MA 104,168,52
    s_waitcnt vmcnt(49)
    s_barrier
TR 32,208,16384
MA 108,172,52
TR 34,208,24576
MA 168,40,52
    buffer_load_dwordx4 v10, s[4:7], s44 offen offset:1024 lds
MA 172,44,52
LW 4
MA 112,168,56
TR 36,209,16384
MA 116,172,56
TR 38,209,24576
MA 176,40,56
    buffer_load_dwordx4 v11, s[4:7], s44 offen offset:2048 lds
MA 180,44,56
LW 4
MA 120,168,60
TR 40,210,16384
MA 124,172,60
TR 42,210,24576
MA 184,40,60
    buffer_load_dwordx4 v12, s[4:7], s44 offen offset:3072 lds
MA 188,44,60
LW 4
MA 64,176,32
TR 44,211,16384
    s_add_u32 m0, s38, 114688
MA 68,180,32
TR 46,211,24576
    s_mov_b32 s44, 12386304
MA 128,48,32
    buffer_load_dwordx4 v9, s[4:7], s44 offen offset:0 lds
MA 132,52,32
    s_mov_b32 s46, 81920
LW 4
MA 72,176,36
TR 48,212,16384
MA 76,180,36
TR 50,212,24576
MA 136,48,36
    buffer_load_dwordx4 v10, s[4:7], s44 offen offset:1024 lds
MA 140,52,36
    s_mov_b32 s47, 98304
LW 4
MA 80,176,40
TR 52,213,16384
MA 84,180,40
TR 54,213,24576
MA 144,48,40
    buffer_load_dwordx4 v11, s[4:7], s44 offen offset:2048 lds
MA 148,52,40
    s_mov_b32 s48, 90112
LW 4
MA 88,176,44
TR 56,214,16384
MA 92,180,44
TR 58,214,24576
MA 152,48,44
    buffer_load_dwordx4 v12, s[4:7], s44 offen offset:3072 lds
MA 156,52,44
    s_mov_b32 s49, 106496
LW 4
MA 96,176,48
TR 60,215,16384
    s_mov_b32 s45, 106496
MA 100,180,48
TR 62,215,24576
MA 160,48,48
    buffer_load_dwordx4 a[32:35], v8, s[8:11], s45 offen offset:0 sc1
MA 164,52,48
LW 4
MA 104,176,52
TR 32,208,20480
MA 108,180,52
TR 34,208,28672
MA 168,48,52
    buffer_load_dwordx4 a[36:39], v8, s[8:11], s45 offen offset:1024 sc1
MA 172,52,52
LW 4
MA 112,176,56
TR 36,209,20480
MA 116,180,56
TR 38,209,28672
MA 176,48,56
    buffer_load_dwordx4 a[40:43], v8, s[8:11], s45 offen offset:2048 sc1
MA 180,52,56
LW 4
MA 120,176,60
TR 40,210,20480
MA 124,180,60
TR 42,210,28672
MA 184,48,60
    buffer_load_dwordx4 a[44:47], v8, s[8:11], s45 offen offset:3072 sc1
MA 188,52,60
LW 4
MA 64,184,32
TR 44,211,20480
MA 68,188,32
TR 46,211,28672
MA 128,56,32
MA 132,60,32
LW 4
MA 72,184,36
TR 48,212,20480
MA 76,188,36
TR 50,212,28672
MA 136,56,36
MA 140,60,36
LW 4
MA 80,184,40
TR 52,213,20480
MA 84,188,40
TR 54,213,28672
MA 144,56,40
MA 148,60,40
LW 4
MA 88,184,44
TR 56,214,20480
MA 92,188,44
TR 58,214,28672
MA 152,56,44
MA 156,60,44
LW 4
MA 96,184,48
TR 60,215,20480
MA 100,188,48
TR 62,215,28672
MA 160,56,48
MA 164,60,48
LW 4
MA 104,184,52
    s_waitcnt vmcnt(28)
    s_barrier
TR 32,192,0
MA 108,188,52
TR 34,192,8192
MA 168,56,52
MA 172,60,52
LW 4
MA 112,184,56
TR 36,193,0
MA 116,188,56
TR 38,193,8192
MA 176,56,56
MA 180,60,56
LW 4
MA 120,184,60
TR 40,192,4096
MA 124,188,60
TR 42,192,12288
MA 184,56,60
TR 44,193,4096
MA 188,60,60
TR 46,193,12288
    s_branch L_pass
L_miss10:
    s_mov_b32 s39, 4194304
    s_branch L_pld12
L_poll12:
    s_sub_u32 s39, s39, 1
    s_cbranch_scc1 L_exit0
    s_sleep 1
L_pld12:
    buffer_load_dwordx2 v[26:27], v22, s[8:11], 0 offen offset:128 sc1
    s_waitcnt vmcnt(0)
L_pchk12:
    v_cmp_ne_u64 vcc, s[56:57], v[26:27]
    s_nop 1
    s_cmp_lg_u64 vcc, 0
    s_cbranch_scc1 L_poll12
    s_branch L_back10
L_miss11:
    s_mov_b32 s39, 4194304
    s_branch L_pld13
L_poll13:
    s_sub_u32 s39, s39, 1
    s_cbranch_scc1 L_exit0
    s_sleep 1
L_pld13:
    buffer_load_dwordx2 v[26:27], v22, s[8:11], 0 offen offset:256 sc1
    s_waitcnt vmcnt(0)
L_pchk13:
    v_cmp_ne_u64 vcc, s[56:57], v[26:27]
    s_nop 1
    s_cmp_lg_u64 vcc, 0
    s_cbranch_scc1 L_poll13
    s_branch L_back11
L_var1:
    buffer_store_dwordx2 v[24:25], v29, s[8:11], s43 offen sc1
    s_cmp_eq_u32 s100, 0
    s_cbranch_scc1 L_noz14
    buffer_store_dwordx2 v[24:25], v30, s[8:11], s63 offen sc1
L_noz14:
    s_waitcnt vmcnt(9)
    s_barrier
    s_cmp_eq_u32 s100, 0
    s_cbranch_scc1 L_nof15
    s_mov_b64 exec, 0xffff
    buffer_store_dwordx2 v[4:5], v29, s[8:11], s54 offen offset:256 sc1
    s_mov_b64 exec, -1
L_nof15:
TR 32,192,0
TR 34,192,8192
TR 36,193,0
TR 38,193,8192
TR 40,194,0
TR 42,194,8192
LW 4
MA 64,128,32
TR 44,195,0
    s_add_u32 m0, s38, 32768
MA 68,132,32
TR 46,195,8192
    s_mov_b32 s44, 0
MA 128,0,32
    buffer_load_dwordx4 v9, s[4:7], s44 offen offset:0 lds
MA 132,4,32
LW 4
MA 72,128,36
TR 48,196,0
MA 76,132,36
TR 50,196,8192
MA 136,0,36
    buffer_load_dwordx4 v10, s[4:7], s44 offen offset:1024 lds
MA 140,4,36
LW 4
MA 80,128,40
TR 52,197,0
MA 84,132,40
TR 54,197,8192
MA 144,0,40
    buffer_load_dwordx4 v11, s[4:7], s44 offen offset:2048 lds
MA 148,4,40
LW 4
MA 88,128,44
TR 56,198,0
MA 92,132,44
TR 58,198,8192
MA 152,0,44
    buffer_load_dwordx4 v12, s[4:7], s44 offen offset:3072 lds
MA 156,4,44
LW 4
MA 96,128,48
TR 60,199,0
    s_add_u32 m0, s38, 49152
MA 100,132,48
TR 62,199,8192
    s_mov_b32 s44, 458752
MA 160,0,48
    buffer_load_dwordx4 v9, s[4:7], s44 offen offset:0 lds
MA 164,4,48
LW 4
MA 104,128,52
TR 32,192,4096
MA 108,132,52
TR 34,192,12288
MA 168,0,52
    buffer_load_dwordx4 v10, s[4:7], s44 offen offset:1024 lds
MA 172,4,52
LW 4
MA 112,128,56
TR 36,193,4096
MA 116,132,56
TR 38,193,12288
MA 176,0,56
    buffer_load_dwordx4 v11, s[4:7], s44 offen offset:2048 lds
MA 180,4,56
LW 4
MA 120,128,60
TR 40,194,4096
MA 124,132,60
TR 42,194,12288
MA 184,0,60
    buffer_load_dwordx4 v12, s[4:7], s44 offen offset:3072 lds
MA 188,4,60
LW 4
MA 64,136,32
TR 44,195,4096
    s_mov_b32 s45, 0
MA 68,140,32
TR 46,195,12288
MA 128,8,32
    buffer_load_dwordx4 a[160:163], v7, s[8:11], s45 offen offset:0 sc1
MA 132,12,32
LW 4
MA 72,136,36
TR 48,196,4096
MA 76,140,36
TR 50,196,12288
MA 136,8,36
    buffer_load_dwordx4 a[164:167], v7, s[8:11], s45 offen offset:1024 sc1
MA 140,12,36
LW 4
MA 80,136,40
TR 52,197,4096
MA 84,140,40
TR 54,197,12288
MA 144,8,40
    buffer_load_dwordx4 a[32:35], v8, s[8:11], s45 offen offset:0 sc1
MA 148,12,40
LW 4
MA 88,136,44
TR 56,198,4096
MA 92,140,44
TR 58,198,12288
MA 152,8,44
    buffer_load_dwordx4 a[36:39], v8, s[8:11], s45 offen offset:1024 sc1
MA 156,12,44
LW 4
MA 96,136,48
TR 60,199,4096
MA 100,140,48
TR 62,199,12288
MA 160,8,48
    buffer_load_dwordx4 a[168:171], v7, s[8:11], s45 offen offset:2048 sc1
MA 164,12,48
LW 4
MA 104,136,52
    s_waitcnt vmcnt(14)
    s_barrier
TR 32,192,16384
MA 108,140,52
TR 34,192,24576
MA 168,8,52
    buffer_load_dwordx4 a[172:175], v7, s[8:11], s45 offen offset:3072 sc1
MA 172,12,52
LW 4
MA 112,136,56
TR 36,193,16384
MA 116,140,56
TR 38,193,24576
MA 176,8,56
    buffer_load_dwordx4 a[40:43], v8, s[8:11], s45 offen offset:2048 sc1
MA 180,12,56
LW 4
MA 120,136,60
TR 40,194,16384
MA 124,140,60
TR 42,194,24576
MA 184,8,60
    buffer_load_dwordx4 a[44:47], v8, s[8:11], s45 offen offset:3072 sc1
MA 188,12,60
LW 4
MA 64,144,32
TR 44,195,16384
    s_mov_b32 s45, 4096
MA 68,148,32
TR 46,195,24576
MA 128,16,32
    buffer_load_dwordx4 a[176:179], v7, s[8:11], s45 offen offset:0 sc1
MA 132,20,32
LW 4
MA 72,144,36
TR 48,196,16384
MA 76,148,36
TR 50,196,24576
MA 136,16,36
    buffer_load_dwordx4 a[180:183], v7, s[8:11], s45 offen offset:1024 sc1
MA 140,20,36
LW 4
MA 80,144,40
TR 52,197,16384
MA 84,148,40
TR 54,197,24576
MA 144,16,40
    buffer_load_dwordx4 a[48:51], v8, s[8:11], s45 offen offset:0 sc1
MA 148,20,40
LW 4
MA 88,144,44
TR 56,198,16384
MA 92,148,44
TR 58,198,24576
MA 152,16,44
    buffer_load_dwordx4 a[52:55], v8, s[8:11], s45 offen offset:1024 sc1
MA 156,20,44
LW 4
MA 96,144,48
TR 60,199,16384
MA 100,148,48
TR 62,199,24576
MA 160,16,48
    buffer_load_dwordx4 a[184:187], v7, s[8:11], s45 offen offset:2048 sc1
MA 164,20,48
LW 4
MA 104,144,52
TR 32,192,20480
MA 108,148,52
TR 34,192,28672
MA 168,16,52
    buffer_load_dwordx4 a[188:191], v7, s[8:11], s45 offen offset:3072 sc1
MA 172,20,52
LW 4
MA 112,144,56
TR 36,193,20480
MA 116,148,56
TR 38,193,28672
MA 176,16,56
    buffer_load_dwordx4 a[56:59], v8, s[8:11], s45 offen offset:2048 sc1
MA 180,20,56
LW 4
MA 120,144,60
TR 40,194,20480
MA 124,148,60
TR 42,194,28672
MA 184,16,60
    buffer_load_dwordx4 a[60:63], v8, s[8:11], s45 offen offset:3072 sc1
MA 188,20,60
LW 4
MA 64,152,32
TR 44,195,20480
    s_add_u32 m0, s38, 65536
MA 68,156,32
TR 46,195,28672
    s_mov_b32 s44, 1835008
MA 128,24,32
    buffer_load_dwordx4 v9, s[4:7], s44 offen offset:0 lds
MA 132,28,32
LW 4
MA 72,152,36
TR 48,196,20480
MA 76,156,36
TR 50,196,28672
MA 136,24,36
    buffer_load_dwordx4 v10, s[4:7], s44 offen offset:1024 lds
MA 140,28,36
LW 4
MA 80,152,40
TR 52,197,20480
MA 84,156,40
TR 54,197,28672
MA 144,24,40
    buffer_load_dwordx4 v11, s[4:7], s44 offen offset:2048 lds
MA 148,28,40
LW 4
MA 88,152,44
TR 56,198,20480
MA 92,156,44
TR 58,198,28672
MA 152,24,44
    buffer_load_dwordx4 v12, s[4:7], s44 offen offset:3072 lds
MA 156,28,44
LW 4
MA 96,152,48
TR 60,199,20480
    s_add_u32 m0, s38, 81920
MA 100,156,48
TR 62,199,28672
    s_mov_b32 s44, 2293760
MA 160,24,48
    buffer_load_dwordx4 v9, s[4:7], s44 offen offset:0 lds
MA 164,28,48
LW 4
MA 104,152,52
    s_waitcnt vmcnt(13)
    s_barrier
TR 32,192,32768
MA 108,156,52
TR 34,192,40960
MA 168,24,52
    buffer_load_dwordx4 v10, s[4:7], s44 offen offset:1024 lds
MA 172,28,52
LW 4
MA 112,152,56
TR 36,193,32768
MA 116,156,56
TR 38,193,40960
MA 176,24,56
    buffer_load_dwordx4 v11, s[4:7], s44 offen offset:2048 lds
MA 180,28,56
LW 4
MA 120,152,60
TR 40,194,32768
MA 124,156,60
TR 42,194,40960
MA 184,24,60
    buffer_load_dwordx4 v12, s[4:7], s44 offen offset:3072 lds
MA 188,28,60
LW 4
MA 64,160,32
TR 44,195,32768
    s_mov_b32 s45, 16384
MA 68,164,32
TR 46,195,40960
MA 128,32,32
    buffer_load_dwordx4 a[192:195], v7, s[8:11], s45 offen offset:0 sc1
MA 132,36,32
LW 4
MA 72,160,36
TR 48,196,32768
MA 76,164,36
TR 50,196,40960
MA 136,32,36
    buffer_load_dwordx4 a[196:199], v7, s[8:11], s45 offen offset:1024 sc1
MA 140,36,36
LW 4
MA 80,160,40
TR 52,197,32768
MA 84,164,40
TR 54,197,40960
MA 144,32,40
    buffer_load_dwordx4 a[64:67], v8, s[8:11], s45 offen offset:0 sc1
MA 148,36,40
LW 4
MA 88,160,44
TR 56,198,32768
MA 92,164,44
TR 58,198,40960
MA 152,32,44
    buffer_load_dwordx4 a[68:71], v8, s[8:11], s45 offen offset:1024 sc1
MA 156,36,44
LW 4
MA 96,160,48
TR 60,199,32768
MA 100,164,48
TR 62,199,40960
MA 160,32,48
    buffer_load_dwordx4 a[200:203], v7, s[8:11], s45 offen offset:2048 sc1
MA 164,36,48
LW 4
MA 104,160,52
TR 32,192,36864
MA 108,164,52
TR 34,192,45056
MA 168,32,52
    buffer_load_dwordx4 a[204:207], v7, s[8:11], s45 offen offset:3072 sc1
MA 172,36,52
LW 4
MA 112,160,56
TR 36,193,36864
MA 116,164,56
TR 38,193,45056
MA 176,32,56
    buffer_load_dwordx4 a[72:75], v8, s[8:11], s45 offen offset:2048 sc1
MA 180,36,56
LW 4
MA 120,160,60
TR 40,194,36864
MA 124,164,60
TR 42,194,45056
MA 184,32,60
    buffer_load_dwordx4 a[76:79], v8, s[8:11], s45 offen offset:3072 sc1
MA 188,36,60
LW 4
MA 64,168,32
TR 44,195,36864
    s_mov_b32 s45, 20480
MA 68,172,32
TR 46,195,45056
MA 128,40,32
    buffer_load_dwordx4 a[208:211], v7, s[8:11], s45 offen offset:0 sc1
MA 132,44,32
LW 4
MA 72,168,36
TR 48,196,36864
MA 76,172,36
TR 50,196,45056
MA 136,40,36
    buffer_load_dwordx4 a[212:215], v7, s[8:11], s45 offen offset:1024 sc1
MA 140,44,36
    buffer_load_dwordx2 v[26:27], v22, s[8:11], 0 offen offset:128 sc1
LW 4
MA 80,168,40
TR 52,197,36864
MA 84,172,40
TR 54,197,45056
MA 144,40,40
    buffer_load_dwordx4 a[80:83], v8, s[8:11], s45 offen offset:0 sc1
MA 148,44,40
LW 4
MA 88,168,44
TR 56,198,36864
MA 92,172,44
TR 58,198,45056
MA 152,40,44
    buffer_load_dwordx4 a[84:87], v8, s[8:11], s45 offen offset:1024 sc1
MA 156,44,44
LW 4
MA 96,168,48
TR 60,199,36864
MA 100,172,48
TR 62,199,45056
MA 160,40,48
    buffer_load_dwordx4 a[216:219], v7, s[8:11], s45 offen offset:2048 sc1
MA 164,44,48
LW 4
MA 104,168,52
    s_waitcnt vmcnt(22)
    s_barrier
TR 32,192,49152
MA 108,172,52
TR 34,192,57344
MA 168,40,52
    buffer_load_dwordx4 a[220:223], v7, s[8:11], s45 offen offset:3072 sc1
MA 172,44,52
LW 4
MA 112,168,56
TR 36,193,49152
MA 116,172,56
TR 38,193,57344
MA 176,40,56
    buffer_load_dwordx4 a[88:91], v8, s[8:11], s45 offen offset:2048 sc1
MA 180,44,56
LW 4
MA 120,168,60
TR 40,194,49152
MA 124,172,60
TR 42,194,57344
MA 184,40,60
    buffer_load_dwordx4 a[92:95], v8, s[8:11], s45 offen offset:3072 sc1
MA 188,44,60
LW 4
MA 64,176,32
TR 44,195,49152
    s_add_u32 m0, s38, 98304
MA 68,180,32
TR 46,195,57344
    s_mov_b32 s44, 2752512
MA 128,48,32
    buffer_load_dwordx4 v9, s[4:7], s44 offen offset:0 lds
MA 132,52,32
LW 4
MA 72,176,36
TR 48,196,49152
MA 76,180,36
TR 50,196,57344
MA 136,48,36
    buffer_load_dwordx4 v10, s[4:7], s44 offen offset:1024 lds
MA 140,52,36
LW 4
MA 80,176,40
TR 52,197,49152
MA 84,180,40
TR 54,197,57344
MA 144,48,40
    buffer_load_dwordx4 v11, s[4:7], s44 offen offset:2048 lds
MA 148,52,40
LW 4
MA 88,176,44
TR 56,198,49152
MA 92,180,44
TR 58,198,57344
MA 152,48,44
    buffer_load_dwordx4 v12, s[4:7], s44 offen offset:3072 lds
MA 156,52,44
LW 4
MA 96,176,48
TR 60,199,49152
    s_add_u32 m0, s38, 114688
MA 100,180,48
TR 62,199,57344
    s_mov_b32 s44, 3211264
MA 160,48,48
    buffer_load_dwordx4 v9, s[4:7], s44 offen offset:0 lds
MA 164,52,48
LW 4
MA 104,176,52
TR 32,192,53248
MA 108,180,52
TR 34,192,61440
MA 168,48,52
    buffer_load_dwordx4 v10, s[4:7], s44 offen offset:1024 lds
MA 172,52,52
LW 4
MA 112,176,56
TR 36,193,53248
MA 116,180,56
TR 38,193,61440
MA 176,48,56
    buffer_load_dwordx4 v11, s[4:7], s44 offen offset:2048 lds
MA 180,52,56
LW 4
MA 120,176,60
TR 40,194,53248
MA 124,180,60
TR 42,194,61440
MA 184,48,60
    buffer_load_dwordx4 v12, s[4:7], s44 offen offset:3072 lds
MA 188,52,60
    s_waitcnt vmcnt(14)
    v_cmp_ne_u64 vcc, s[56:57], v[26:27]
    s_nop 1
    s_cmp_lg_u64 vcc, 0
    s_cbranch_scc1 L_miss16
L_back16:
LW 4
MA 64,184,32
TR 44,195,53248
    s_mov_b32 s45, 24576
MA 68,188,32
TR 46,195,61440
MA 128,56,32
    buffer_load_dwordx4 a[224:227], v7, s[8:11], s45 offen offset:0 sc1
MA 132,60,32
LW 4
MA 72,184,36
TR 48,196,53248
MA 76,188,36
TR 50,196,61440
MA 136,56,36
    buffer_load_dwordx4 a[228:231], v7, s[8:11], s45 offen offset:1024 sc1
MA 140,60,36
LW 4
MA 80,184,40
TR 52,197,53248
MA 84,188,40
TR 54,197,61440
MA 144,56,40
    buffer_load_dwordx4 a[96:99], v8, s[8:11], s45 offen offset:0 sc1
MA 148,60,40
LW 4
MA 88,184,44
TR 56,198,53248
MA 92,188,44
TR 58,198,61440
MA 152,56,44
    buffer_load_dwordx4 a[100:103], v8, s[8:11], s45 offen offset:1024 sc1
MA 156,60,44
LW 4
MA 96,184,48
TR 60,199,53248
MA 100,188,48
TR 62,199,61440
MA 160,56,48
    buffer_load_dwordx4 a[232:235], v7, s[8:11], s45 offen offset:2048 sc1
MA 164,60,48
LW 4
MA 104,184,52
    s_barrier
TR 32,200,0
MA 108,188,52
TR 34,200,8192
MA 168,56,52
    buffer_load_dwordx4 a[236:239], v7, s[8:11], s45 offen offset:3072 sc1
MA 172,60,52
LW 4
MA 112,184,56
TR 36,201,0
MA 116,188,56
TR 38,201,8192
MA 176,56,56
    buffer_load_dwordx4 a[104:107], v8, s[8:11], s45 offen offset:2048 sc1
MA 180,60,56
LW 4
MA 120,184,60
TR 40,202,0
MA 124,188,60
TR 42,202,8192
MA 184,56,60
    buffer_load_dwordx4 a[108:111], v8, s[8:11], s45 offen offset:3072 sc1
MA 188,60,60
LW 4
MA 64,192,32
TR 44,203,0
    s_mov_b32 s45, 28672
MA 68,196,32
TR 46,203,8192
MA 128,64,32
    buffer_load_dwordx4 a[240:243], v7, s[8:11], s45 offen offset:0 sc1
MA 132,68,32
LW 4
MA 72,192,36
TR 48,204,0
MA 76,196,36
TR 50,204,8192
MA 136,64,36
    buffer_load_dwordx4 a[244:247], v7, s[8:11], s45 offen offset:1024 sc1
MA 140,68,36
LW 4
MA 80,192,40
TR 52,205,0
MA 84,196,40
TR 54,205,8192
MA 144,64,40
    buffer_load_dwordx4 a[112:115], v8, s[8:11], s45 offen offset:0 sc1
MA 148,68,40
LW 4
MA 88,192,44
TR 56,206,0
MA 92,196,44
TR 58,206,8192
MA 152,64,44
    buffer_load_dwordx4 a[116:119], v8, s[8:11], s45 offen offset:1024 sc1
MA 156,68,44
LW 4
MA 96,192,48
TR 60,207,0
MA 100,196,48
TR 62,207,8192
MA 160,64,48
    buffer_load_dwordx4 a[248:251], v7, s[8:11], s45 offen offset:2048 sc1
MA 164,68,48
LW 4
MA 104,192,52
TR 32,200,4096
MA 108,196,52
TR 34,200,12288
MA 168,64,52
    buffer_load_dwordx4 a[252:255], v7, s[8:11], s45 offen offset:3072 sc1
MA 172,68,52
LW 4
MA 112,192,56
TR 36,201,4096
MA 116,196,56
TR 38,201,12288
MA 176,64,56
    buffer_load_dwordx4 a[120:123], v8, s[8:11], s45 offen offset:2048 sc1
MA 180,68,56
LW 4
MA 120,192,60
TR 40,202,4096
MA 124,196,60
TR 42,202,12288
MA 184,64,60
    buffer_load_dwordx4 a[124:127], v8, s[8:11], s45 offen offset:3072 sc1
MA 188,68,60
LW 4
MA 64,200,32
TR 44,203,4096
    s_add_u32 m0, s38, 131072
MA 68,204,32
TR 46,203,12288
    s_mov_b32 s44, 4587520
MA 128,72,32
    buffer_load_dwordx4 v9, s[4:7], s44 offen offset:0 lds
MA 132,76,32
LW 4
MA 72,200,36
TR 48,204,4096
MA 76,204,36
TR 50,204,12288
MA 136,72,36
    buffer_load_dwordx4 v10, s[4:7], s44 offen offset:1024 lds
MA 140,76,36
LW 4
MA 80,200,40
TR 52,205,4096
MA 84,204,40
TR 54,205,12288
MA 144,72,40
    buffer_load_dwordx4 v11, s[4:7], s44 offen offset:2048 lds
MA 148,76,40
LW 4
MA 88,200,44
TR 56,206,4096
MA 92,204,44
TR 58,206,12288
MA 152,72,44
    buffer_load_dwordx4 v12, s[4:7], s44 offen offset:3072 lds
MA 156,76,44
LW 4
MA 96,200,48
TR 60,207,4096
    s_add_u32 m0, s38, 147456
MA 100,204,48
TR 62,207,12288
    s_mov_b32 s44, 5046272
MA 160,72,48
    buffer_load_dwordx4 v9, s[4:7], s44 offen offset:0 lds
MA 164,76,48
LW 4
MA 104,200,52
    s_waitcnt vmcnt(29)
    s_barrier
TR 32,200,16384
MA 108,204,52
TR 34,200,24576
MA 168,72,52
    buffer_load_dwordx4 v10, s[4:7], s44 offen offset:1024 lds
MA 172,76,52
LW 4
MA 112,200,56
TR 36,201,16384
MA 116,204,56
TR 38,201,24576
MA 176,72,56
    buffer_load_dwordx4 v11, s[4:7], s44 offen offset:2048 lds
MA 180,76,56
LW 4
MA 120,200,60
TR 40,202,16384
MA 124,204,60
TR 42,202,24576
MA 184,72,60
    buffer_load_dwordx4 v12, s[4:7], s44 offen offset:3072 lds
    s_sub_u32 s39, s32, 2
    s_cmp_ge_u32 s39, 2
    s_cbranch_scc1 L_nog17
    buffer_load_dword v15, v15, s[12:15], 0 offen
L_nog17:
MA 188,76,60
LW 4
MA 64,208,32
TR 44,203,16384
MA 68,212,32
TR 46,203,24576
MA 128,80,32
MA 132,84,32
LW 4
MA 72,208,36
TR 48,204,16384
MA 76,212,36
TR 50,204,24576
MA 136,80,36
MA 140,84,36
LW 4
MA 80,208,40
TR 52,205,16384
MA 84,212,40
TR 54,205,24576
MA 144,80,40
MA 148,84,40
LW 4
MA 88,208,44
TR 56,206,16384
MA 92,212,44
TR 58,206,24576
MA 152,80,44
MA 156,84,44
LW 4
MA 96,208,48
TR 60,207,16384
MA 100,212,48
TR 62,207,24576
MA 160,80,48
MA 164,84,48
LW 4
MA 104,208,52
TR 32,200,20480
MA 108,212,52
TR 34,200,28672
MA 168,80,52
MA 172,84,52
LW 4
MA 112,208,56
TR 36,201,20480
MA 116,212,56
TR 38,201,28672
MA 176,80,56
MA 180,84,56
LW 4
MA 120,208,60
TR 40,202,20480
MA 124,212,60
TR 42,202,28672
MA 184,80,60
MA 188,84,60
LW 4
MA 64,216,32
TR 44,203,20480
MA 68,220,32
TR 46,203,28672
MA 128,88,32
MA 132,92,32
LW 4
MA 72,216,36
TR 48,204,20480
MA 76,220,36
TR 50,204,28672
MA 136,88,36
MA 140,92,36
LW 4
MA 80,216,40
TR 52,205,20480
MA 84,220,40
TR 54,205,28672
MA 144,88,40
MA 148,92,40
LW 4
MA 88,216,44
TR 56,206,20480
MA 92,220,44
TR 58,206,28672
MA 152,88,44
MA 156,92,44
LW 4
MA 96,216,48
TR 60,207,20480
    s_mov_b32 s45, 40960
MA 100,220,48
TR 62,207,28672
MA 160,88,48
    buffer_load_dwordx4 a[128:131], v7, s[8:11], s45 offen offset:0 sc1
MA 164,92,48
LW 4
MA 104,216,52
    s_waitcnt vmcnt(17)
    s_barrier
TR 32,200,32768
MA 108,220,52
TR 34,200,40960
MA 168,88,52
    buffer_load_dwordx4 a[132:135], v7, s[8:11], s45 offen offset:1024 sc1
MA 172,92,52
LW 4
MA 112,216,56
TR 36,201,32768
MA 116,220,56
TR 38,201,40960
MA 176,88,56
    buffer_load_dwordx4 a[0:3], v8, s[8:11], s45 offen offset:0 sc1
MA 180,92,56
LW 4
MA 120,216,60
TR 40,202,32768
MA 124,220,60
TR 42,202,40960
MA 184,88,60
    buffer_load_dwordx4 a[4:7], v8, s[8:11], s45 offen offset:1024 sc1
MA 188,92,60
LW 4
MA 64,224,32
TR 44,203,32768
MA 68,228,32
TR 46,203,40960
MA 128,96,32
    buffer_load_dwordx4 a[136:139], v7, s[8:11], s45 offen offset:2048 sc1
MA 132,100,32
LW 4
MA 72,224,36
TR 48,204,32768
MA 76,228,36
TR 50,204,40960
MA 136,96,36
    buffer_load_dwordx4 a[140:143], v7, s[8:11], s45 offen offset:3072 sc1
MA 140,100,36
LW 4
MA 80,224,40
TR 52,205,32768
MA 84,228,40
TR 54,205,40960
MA 144,96,40
    buffer_load_dwordx4 a[8:11], v8, s[8:11], s45 offen offset:2048 sc1
MA 148,100,40
LW 4
MA 88,224,44
TR 56,206,32768
MA 92,228,44
TR 58,206,40960
MA 152,96,44
    buffer_load_dwordx4 a[12:15], v8, s[8:11], s45 offen offset:3072 sc1
MA 156,100,44
LW 4
MA 96,224,48
TR 60,207,32768
    s_mov_b32 s45, 45056
MA 100,228,48
TR 62,207,40960
MA 160,96,48
    buffer_load_dwordx4 a[144:147], v7, s[8:11], s45 offen offset:0 sc1
MA 164,100,48
LW 4
MA 104,224,52
TR 32,200,36864
MA 108,228,52
TR 34,200,45056
MA 168,96,52
    buffer_load_dwordx4 a[148:151], v7, s[8:11], s45 offen offset:1024 sc1
MA 172,100,52
LW 4
MA 112,224,56
TR 36,201,36864
MA 116,228,56
TR 38,201,45056
MA 176,96,56
    buffer_load_dwordx4 a[16:19], v8, s[8:11], s45 offen offset:0 sc1
MA 180,100,56
LW 4
MA 120,224,60
TR 40,202,36864
MA 124,228,60
TR 42,202,45056
MA 184,96,60
    buffer_load_dwordx4 a[20:23], v8, s[8:11], s45 offen offset:1024 sc1
MA 188,100,60
LW 4
MA 64,232,32
TR 44,203,36864
MA 68,236,32
TR 46,203,45056
MA 128,104,32
    buffer_load_dwordx4 a[152:155], v7, s[8:11], s45 offen offset:2048 sc1
MA 132,108,32
LW 4
MA 72,232,36
TR 48,204,36864
MA 76,236,36
TR 50,204,45056
MA 136,104,36
    buffer_load_dwordx4 a[156:159], v7, s[8:11], s45 offen offset:3072 sc1
MA 140,108,36
LW 4
MA 80,232,40
TR 52,205,36864
MA 84,236,40
TR 54,205,45056
MA 144,104,40
    buffer_load_dwordx4 a[24:27], v8, s[8:11], s45 offen offset:2048 sc1
MA 148,108,40
LW 4
MA 88,232,44
TR 56,206,36864
MA 92,236,44
TR 58,206,45056
MA 152,104,44
    buffer_load_dwordx4 a[28:31], v8, s[8:11], s45 offen offset:3072 sc1
MA 156,108,44
LW 4
MA 96,232,48
TR 60,207,36864
    s_add_u32 m0, s38, 0
MA 100,236,48
TR 62,207,45056
    s_mov_b32 s44, 3670016
MA 160,104,48
    buffer_load_dwordx4 v9, s[4:7], s44 offen offset:0 lds
MA 164,108,48
LW 4
MA 104,232,52
    s_waitcnt vmcnt(25)
    s_barrier
TR 32,200,49152
MA 108,236,52
TR 34,200,57344
MA 168,104,52
    buffer_load_dwordx4 v10, s[4:7], s44 offen offset:1024 lds
MA 172,108,52
LW 4
MA 112,232,56
TR 36,201,49152
MA 116,236,56
TR 38,201,57344
MA 176,104,56
    buffer_load_dwordx4 v11, s[4:7], s44 offen offset:2048 lds
MA 180,108,56
LW 4
MA 120,232,60
TR 40,202,49152
MA 124,236,60
TR 42,202,57344
MA 184,104,60
    buffer_load_dwordx4 v12, s[4:7], s44 offen offset:3072 lds
MA 188,108,60
LW 4
MA 64,240,32
TR 44,203,49152
    s_add_u32 m0, s38, 16384
MA 68,244,32
TR 46,203,57344
    s_mov_b32 s44, 4128768
MA 128,112,32
    buffer_load_dwordx4 v9, s[4:7], s44 offen offset:0 lds
MA 132,116,32
LW 4
MA 72,240,36
TR 48,204,49152
MA 76,244,36
TR 50,204,57344
MA 136,112,36
    buffer_load_dwordx4 v10, s[4:7], s44 offen offset:1024 lds
MA 140,116,36
LW 4
MA 80,240,40
TR 52,205,49152
MA 84,244,40
TR 54,205,57344
MA 144,112,40
    buffer_load_dwordx4 v11, s[4:7], s44 offen offset:2048 lds
MA 148,116,40
LW 4
MA 88,240,44
TR 56,206,49152
MA 92,244,44
TR 58,206,57344
MA 152,112,44
    buffer_load_dwordx4 v12, s[4:7], s44 offen offset:3072 lds
MA 156,116,44
LW 4
MA 96,240,48
TR 60,207,49152
    s_mov_b32 s45, 32768
MA 100,244,48
TR 62,207,57344
MA 160,112,48
    buffer_load_dwordx4 a[160:163], v7, s[8:11], s45 offen offset:0 sc1
MA 164,116,48
LW 4
MA 104,240,52
TR 32,200,53248
MA 108,244,52
TR 34,200,61440
MA 168,112,52
    buffer_load_dwordx4 a[164:167], v7, s[8:11], s45 offen offset:1024 sc1
MA 172,116,52
LW 4
MA 112,240,56
TR 36,201,53248
MA 116,244,56
TR 38,201,61440
MA 176,112,56
    buffer_load_dwordx4 a[32:35], v8, s[8:11], s45 offen offset:0 sc1
MA 180,116,56
LW 4
MA 120,240,60
TR 40,202,53248
MA 124,244,60
TR 42,202,61440
MA 184,112,60
    buffer_load_dwordx4 a[36:39], v8, s[8:11], s45 offen offset:1024 sc1
MA 188,116,60
LW 4
MA 64,248,32
TR 44,203,53248
MA 68,252,32
TR 46,203,61440
MA 128,120,32
    buffer_load_dwordx4 a[168:171], v7, s[8:11], s45 offen offset:2048 sc1
MA 132,124,32
LW 4
MA 72,248,36
TR 48,204,53248
MA 76,252,36
TR 50,204,61440
MA 136,120,36
    buffer_load_dwordx4 a[172:175], v7, s[8:11], s45 offen offset:3072 sc1
MA 140,124,36
LW 4
MA 80,248,40
TR 52,205,53248
MA 84,252,40
TR 54,205,61440
MA 144,120,40
    buffer_load_dwordx4 a[40:43], v8, s[8:11], s45 offen offset:2048 sc1
MA 148,124,40
LW 4
MA 88,248,44
TR 56,206,53248
MA 92,252,44
TR 58,206,61440
MA 152,120,44
    buffer_load_dwordx4 a[44:47], v8, s[8:11], s45 offen offset:3072 sc1
MA 156,124,44
LW 4
MA 96,248,48
TR 60,207,53248
    s_mov_b32 s45, 36864
MA 100,252,48
TR 62,207,61440
MA 160,120,48
    buffer_load_dwordx4 a[176:179], v7, s[8:11], s45 offen offset:0 sc1
MA 164,124,48
LW 4
MA 104,248,52
    s_waitcnt vmcnt(25)
    s_barrier
TR 32,208,0
MA 108,252,52
TR 34,208,8192
MA 168,120,52
    buffer_load_dwordx4 a[180:183], v7, s[8:11], s45 offen offset:1024 sc1
MA 172,124,52
LW 4
MA 112,248,56
TR 36,209,0
MA 116,252,56
TR 38,209,8192
MA 176,120,56
    buffer_load_dwordx4 a[48:51], v8, s[8:11], s45 offen offset:0 sc1
MA 180,124,56
LW 4
MA 120,248,60
TR 40,210,0
MA 124,252,60
TR 42,210,8192
MA 184,120,60
    buffer_load_dwordx4 a[52:55], v8, s[8:11], s45 offen offset:1024 sc1
MA 188,124,60
LW 4
MA 64,128,32
TR 44,211,0
MA 68,132,32
TR 46,211,8192
MA 128,0,32
    buffer_load_dwordx4 a[184:187], v7, s[8:11], s45 offen offset:2048 sc1
MA 132,4,32
LW 4
MA 72,128,36
TR 48,212,0
MA 76,132,36
TR 50,212,8192
MA 136,0,36
    buffer_load_dwordx4 a[188:191], v7, s[8:11], s45 offen offset:3072 sc1
MA 140,4,36
LW 4
MA 80,128,40
TR 52,213,0
MA 84,132,40
TR 54,213,8192
MA 144,0,40
    buffer_load_dwordx4 a[56:59], v8, s[8:11], s45 offen offset:2048 sc1
MA 148,4,40
LW 4
MA 88,128,44
TR 56,214,0
MA 92,132,44
TR 58,214,8192
MA 152,0,44
    buffer_load_dwordx4 a[60:63], v8, s[8:11], s45 offen offset:3072 sc1
MA 156,4,44
LW 4
MA 96,128,48
TR 60,215,0
    s_add_u32 m0, s38, 32768
MA 100,132,48
TR 62,215,8192
    s_mov_b32 s44, 5505024
MA 160,0,48
    buffer_load_dwordx4 v9, s[4:7], s44 offen offset:0 lds
MA 164,4,48
LW 4
MA 104,128,52
TR 32,208,4096
MA 108,132,52
TR 34,208,12288
MA 168,0,52
    buffer_load_dwordx4 v10, s[4:7], s44 offen offset:1024 lds
MA 172,4,52
LW 4
MA 112,128,56
TR 36,209,4096
MA 116,132,56
TR 38,209,12288
MA 176,0,56
    buffer_load_dwordx4 v11, s[4:7], s44 offen offset:2048 lds
MA 180,4,56
LW 4
MA 120,128,60
TR 40,210,4096
MA 124,132,60
TR 42,210,12288
MA 184,0,60
    buffer_load_dwordx4 v12, s[4:7], s44 offen offset:3072 lds
MA 188,4,60
LW 4
MA 64,136,32
TR 44,211,4096
    s_add_u32 m0, s38, 49152
MA 68,140,32
TR 46,211,12288
    s_mov_b32 s44, 5963776
MA 128,8,32
    buffer_load_dwordx4 v9, s[4:7], s44 offen offset:0 lds
MA 132,12,32
LW 4
MA 72,136,36
TR 48,212,4096
MA 76,140,36
TR 50,212,12288
MA 136,8,36
    buffer_load_dwordx4 v10, s[4:7], s44 offen offset:1024 lds
MA 140,12,36
LW 4
MA 80,136,40
TR 52,213,4096
MA 84,140,40
TR 54,213,12288
MA 144,8,40
    buffer_load_dwordx4 v11, s[4:7], s44 offen offset:2048 lds
MA 148,12,40
LW 4
MA 88,136,44
TR 56,214,4096
MA 92,140,44
TR 58,214,12288
MA 152,8,44
    buffer_load_dwordx4 v12, s[4:7], s44 offen offset:3072 lds
MA 156,12,44
LW 4
MA 96,136,48
TR 60,215,4096
    s_mov_b32 s45, 49152
MA 100,140,48
TR 62,215,12288
MA 160,8,48
    buffer_load_dwordx4 a[192:195], v7, s[8:11], s45 offen offset:0 sc1
MA 164,12,48
LW 4
MA 104,136,52
    s_waitcnt vmcnt(33)
    s_barrier
TR 32,208,16384
MA 108,140,52
TR 34,208,24576
MA 168,8,52
    buffer_load_dwordx4 a[196:199], v7, s[8:11], s45 offen offset:1024 sc1
MA 172,12,52
LW 4
MA 112,136,56
TR 36,209,16384
MA 116,140,56
TR 38,209,24576
MA 176,8,56
    buffer_load_dwordx4 a[64:67], v8, s[8:11], s45 offen offset:0 sc1
MA 180,12,56
LW 4
MA 120,136,60
TR 40,210,16384
MA 124,140,60
TR 42,210,24576
MA 184,8,60
    buffer_load_dwordx4 a[68:71], v8, s[8:11], s45 offen offset:1024 sc1
MA 188,12,60
LW 4
MA 64,144,32
TR 44,211,16384
MA 68,148,32
TR 46,211,24576
MA 128,16,32
    buffer_load_dwordx4 a[200:203], v7, s[8:11], s45 offen offset:2048 sc1
MA 132,20,32
LW 4
MA 72,144,36
TR 48,212,16384
MA 76,148,36
TR 50,212,24576
MA 136,16,36
    buffer_load_dwordx4 a[204:207], v7, s[8:11], s45 offen offset:3072 sc1
MA 140,20,36
LW 4
MA 80,144,40
TR 52,213,16384
MA 84,148,40
TR 54,213,24576
MA 144,16,40
    buffer_load_dwordx4 a[72:75], v8, s[8:11], s45 offen offset:2048 sc1
MA 148,20,40
LW 4
MA 88,144,44
TR 56,214,16384
MA 92,148,44
TR 58,214,24576
MA 152,16,44
    buffer_load_dwordx4 a[76:79], v8, s[8:11], s45 offen offset:3072 sc1
MA 156,20,44
LW 4
MA 96,144,48
TR 60,215,16384
    s_mov_b32 s45, 53248
MA 100,148,48
TR 62,215,24576
MA 160,16,48
    buffer_load_dwordx4 a[208:211], v7, s[8:11], s45 offen offset:0 sc1
MA 164,20,48
LW 4
MA 104,144,52
TR 32,208,20480
MA 108,148,52
TR 34,208,28672
MA 168,16,52
    buffer_load_dwordx4 a[212:215], v7, s[8:11], s45 offen offset:1024 sc1
MA 172,20,52
    buffer_load_dwordx2 v[26:27], v22, s[8:11], 0 offen offset:256 sc1
LW 4
MA 112,144,56
TR 36,209,20480
MA 116,148,56
TR 38,209,28672
MA 176,16,56
    buffer_load_dwordx4 a[80:83], v8, s[8:11], s45 offen offset:0 sc1
MA 180,20,56
LW 4
MA 120,144,60
TR 40,210,20480
MA 124,148,60
TR 42,210,28672
MA 184,16,60
    buffer_load_dwordx4 a[84:87], v8, s[8:11], s45 offen offset:1024 sc1
MA 188,20,60
LW 4
MA 64,152,32
TR 44,211,20480
MA 68,156,32
TR 46,211,28672
MA 128,24,32
    buffer_load_dwordx4 a[216:219], v7, s[8:11], s45 offen offset:2048 sc1
MA 132,28,32
LW 4
MA 72,152,36
TR 48,212,20480
MA 76,156,36
TR 50,212,28672
MA 136,24,36
    buffer_load_dwordx4 a[220:223], v7, s[8:11], s45 offen offset:3072 sc1
MA 140,28,36
LW 4
MA 80,152,40
TR 52,213,20480
MA 84,156,40
TR 54,213,28672
MA 144,24,40
    buffer_load_dwordx4 a[88:91], v8, s[8:11], s45 offen offset:2048 sc1
MA 148,28,40
LW 4
MA 88,152,44
TR 56,214,20480
MA 92,156,44
TR 58,214,28672
MA 152,24,44
    buffer_load_dwordx4 a[92:95], v8, s[8:11], s45 offen offset:3072 sc1
MA 156,28,44
LW 4
MA 96,152,48
TR 60,215,20480
    s_add_u32 m0, s38, 65536
MA 100,156,48
TR 62,215,28672
    s_mov_b32 s44, 6422528
MA 160,24,48
    buffer_load_dwordx4 v9, s[4:7], s44 offen offset:0 lds
MA 164,28,48
LW 4
MA 104,152,52
    s_waitcnt vmcnt(34)
    s_barrier
TR 32,192,0
MA 108,156,52
TR 34,192,8192
MA 168,24,52
    buffer_load_dwordx4 v10, s[4:7], s44 offen offset:1024 lds
MA 172,28,52
LW 4
MA 112,152,56
TR 36,193,0
MA 116,156,56
TR 38,193,8192
MA 176,24,56
    buffer_load_dwordx4 v11, s[4:7], s44 offen offset:2048 lds
MA 180,28,56
LW 4
MA 120,152,60
TR 40,194,0
MA 124,156,60
TR 42,194,8192
MA 184,24,60
    buffer_load_dwordx4 v12, s[4:7], s44 offen offset:3072 lds
MA 188,28,60
LW 4
MA 64,160,32
TR 44,195,0
    s_add_u32 m0, s38, 81920
MA 68,164,32
TR 46,195,8192
    s_mov_b32 s44, 6881280
MA 128,32,32
    buffer_load_dwordx4 v9, s[4:7], s44 offen offset:0 lds
MA 132,36,32
LW 4
MA 72,160,36
TR 48,196,0
MA 76,164,36
TR 50,196,8192
MA 136,32,36
    buffer_load_dwordx4 v10, s[4:7], s44 offen offset:1024 lds
MA 140,36,36
LW 4
MA 80,160,40
TR 52,197,0
MA 84,164,40
TR 54,197,8192
MA 144,32,40
    buffer_load_dwordx4 v11, s[4:7], s44 offen offset:2048 lds
MA 148,36,40
LW 4
MA 88,160,44
TR 56,198,0
MA 92,164,44
TR 58,198,8192
MA 152,32,44
    buffer_load_dwordx4 v12, s[4:7], s44 offen offset:3072 lds
MA 156,36,44
    s_waitcnt vmcnt(14)
    v_cmp_ne_u64 vcc, s[56:57], v[26:27]
    s_nop 1
    s_cmp_lg_u64 vcc, 0
    s_cbranch_scc1 L_miss18
L_back18:
LW 4
MA 96,160,48
TR 60,199,0
    s_mov_b32 s45, 57344
MA 100,164,48
TR 62,199,8192
MA 160,32,48
    buffer_load_dwordx4 a[224:227], v7, s[8:11], s45 offen offset:0 sc1
MA 164,36,48
LW 4
MA 104,160,52
TR 32,192,4096
MA 108,164,52
TR 34,192,12288
MA 168,32,52
    buffer_load_dwordx4 a[228:231], v7, s[8:11], s45 offen offset:1024 sc1
MA 172,36,52
LW 4
MA 112,160,56
TR 36,193,4096
MA 116,164,56
TR 38,193,12288
MA 176,32,56
    buffer_load_dwordx4 a[96:99], v8, s[8:11], s45 offen offset:0 sc1
MA 180,36,56
LW 4
MA 120,160,60
TR 40,194,4096
MA 124,164,60
TR 42,194,12288
MA 184,32,60
    buffer_load_dwordx4 a[100:103], v8, s[8:11], s45 offen offset:1024 sc1
MA 188,36,60
LW 4
MA 64,168,32
TR 44,195,4096
MA 68,172,32
TR 46,195,12288
MA 128,40,32
    buffer_load_dwordx4 a[232:235], v7, s[8:11], s45 offen offset:2048 sc1
MA 132,44,32
LW 4
MA 72,168,36
TR 48,196,4096
MA 76,172,36
TR 50,196,12288
MA 136,40,36
    buffer_load_dwordx4 a[236:239], v7, s[8:11], s45 offen offset:3072 sc1
MA 140,44,36
LW 4
MA 80,168,40
TR 52,197,4096
MA 84,172,40
TR 54,197,12288
MA 144,40,40
    buffer_load_dwordx4 a[104:107], v8, s[8:11], s45 offen offset:2048 sc1
MA 148,44,40
LW 4
MA 88,168,44
TR 56,198,4096
MA 92,172,44
TR 58,198,12288
MA 152,40,44
    buffer_load_dwordx4 a[108:111], v8, s[8:11], s45 offen offset:3072 sc1
MA 156,44,44
LW 4
MA 96,168,48
TR 60,199,4096
    s_mov_b32 s45, 61440
MA 100,172,48
TR 62,199,12288
MA 160,40,48
    buffer_load_dwordx4 a[240:243], v7, s[8:11], s45 offen offset:0 sc1
MA 164,44,48
LW 4
MA 104,168,52
    s_barrier
TR 32,192,16384
MA 108,172,52
TR 34,192,24576
MA 168,40,52
    buffer_load_dwordx4 a[244:247], v7, s[8:11], s45 offen offset:1024 sc1
MA 172,44,52
LW 4
MA 112,168,56
TR 36,193,16384
MA 116,172,56
TR 38,193,24576
MA 176,40,56
    buffer_load_dwordx4 a[112:115], v8, s[8:11], s45 offen offset:0 sc1
MA 180,44,56
LW 4
MA 120,168,60
TR 40,194,16384
MA 124,172,60
TR 42,194,24576
MA 184,40,60
    buffer_load_dwordx4 a[116:119], v8, s[8:11], s45 offen offset:1024 sc1
MA 188,44,60
LW 4
MA 64,176,32
TR 44,195,16384
MA 68,180,32
TR 46,195,24576
MA 128,48,32
    buffer_load_dwordx4 a[248:251], v7, s[8:11], s45 offen offset:2048 sc1
MA 132,52,32
LW 4
MA 72,176,36
TR 48,196,16384
MA 76,180,36
TR 50,196,24576
MA 136,48,36
    buffer_load_dwordx4 a[252:255], v7, s[8:11], s45 offen offset:3072 sc1
MA 140,52,36
LW 4
MA 80,176,40
TR 52,197,16384
MA 84,180,40
TR 54,197,24576
MA 144,48,40
    buffer_load_dwordx4 a[120:123], v8, s[8:11], s45 offen offset:2048 sc1
MA 148,52,40
LW 4
MA 88,176,44
TR 56,198,16384
MA 92,180,44
TR 58,198,24576
MA 152,48,44
    buffer_load_dwordx4 a[124:127], v8, s[8:11], s45 offen offset:3072 sc1
MA 156,52,44
LW 4
MA 96,176,48
TR 60,199,16384
    s_add_u32 m0, s38, 98304
MA 100,180,48
TR 62,199,24576
    s_mov_b32 s44, 8257536
MA 160,48,48
    buffer_load_dwordx4 v9, s[4:7], s44 offen offset:0 lds
MA 164,52,48
LW 4
MA 104,176,52
TR 32,192,20480
MA 108,180,52
TR 34,192,28672
MA 168,48,52
    buffer_load_dwordx4 v10, s[4:7], s44 offen offset:1024 lds
MA 172,52,52
LW 4
MA 112,176,56
TR 36,193,20480
MA 116,180,56
TR 38,193,28672
MA 176,48,56
    buffer_load_dwordx4 v11, s[4:7], s44 offen offset:2048 lds
MA 180,52,56
LW 4
MA 120,176,60
TR 40,194,20480
MA 124,180,60
TR 42,194,28672
MA 184,48,60
    buffer_load_dwordx4 v12, s[4:7], s44 offen offset:3072 lds
MA 188,52,60
LW 4
MA 64,184,32
TR 44,195,20480
    s_add_u32 m0, s38, 114688
MA 68,188,32
TR 46,195,28672
    s_mov_b32 s44, 8716288
MA 128,56,32
    buffer_load_dwordx4 v9, s[4:7], s44 offen offset:0 lds
MA 132,60,32
LW 4
MA 72,184,36
TR 48,196,20480
MA 76,188,36
TR 50,196,28672
MA 136,56,36
    buffer_load_dwordx4 v10, s[4:7], s44 offen offset:1024 lds
MA 140,60,36
LW 4
MA 80,184,40
TR 52,197,20480
MA 84,188,40
TR 54,197,28672
MA 144,56,40
    buffer_load_dwordx4 v11, s[4:7], s44 offen offset:2048 lds
MA 148,60,40
LW 4
MA 88,184,44
TR 56,198,20480
MA 92,188,44
TR 58,198,28672
MA 152,56,44
    buffer_load_dwordx4 v12, s[4:7], s44 offen offset:3072 lds
MA 156,60,44
LW 4
MA 96,184,48
TR 60,199,20480
MA 100,188,48
TR 62,199,28672
MA 160,56,48
MA 164,60,48
LW 4
MA 104,184,52
    s_barrier
TR 32,192,32768
MA 108,188,52
TR 34,192,40960
MA 168,56,52
MA 172,60,52
LW 4
MA 112,184,56
TR 36,193,32768
MA 116,188,56
TR 38,193,40960
MA 176,56,56
MA 180,60,56
LW 4
MA 120,184,60
TR 40,194,32768
MA 124,188,60
TR 42,194,40960
MA 184,56,60
MA 188,60,60
LW 4
MA 64,192,32
TR 44,195,32768
MA 68,196,32
TR 46,195,40960
MA 128,64,32
MA 132,68,32
LW 4
MA 72,192,36
TR 48,196,32768
MA 76,196,36
TR 50,196,40960
MA 136,64,36
MA 140,68,36
LW 4
MA 80,192,40
TR 52,197,32768
MA 84,196,40
TR 54,197,40960
MA 144,64,40
MA 148,68,40
LW 4
MA 88,192,44
TR 56,198,32768
MA 92,196,44
TR 58,198,40960
MA 152,64,44
MA 156,68,44
LW 4
MA 96,192,48
TR 60,199,32768
MA 100,196,48
TR 62,199,40960
MA 160,64,48
MA 164,68,48
LW 4
MA 104,192,52
TR 32,192,36864
MA 108,196,52
TR 34,192,45056
MA 168,64,52
MA 172,68,52
LW 4
MA 112,192,56
TR 36,193,36864
MA 116,196,56
TR 38,193,45056
MA 176,64,56
MA 180,68,56
LW 4
MA 120,192,60
TR 40,194,36864
MA 124,196,60
TR 42,194,45056
MA 184,64,60
MA 188,68,60
LW 4
MA 64,200,32
TR 44,195,36864
    s_mov_b32 s45, 73728
MA 68,204,32
TR 46,195,45056
MA 128,72,32
    buffer_load_dwordx4 a[128:131], v7, s[8:11], s45 offen offset:0 sc1
MA 132,76,32
LW 4
MA 72,200,36
TR 48,196,36864
MA 76,204,36
TR 50,196,45056
MA 136,72,36
    buffer_load_dwordx4 a[132:135], v7, s[8:11], s45 offen offset:1024 sc1
MA 140,76,36
LW 4
MA 80,200,40
TR 52,197,36864
MA 84,204,40
TR 54,197,45056
MA 144,72,40
    buffer_load_dwordx4 a[0:3], v8, s[8:11], s45 offen offset:0 sc1
MA 148,76,40
LW 4
MA 88,200,44
TR 56,198,36864
MA 92,204,44
TR 58,198,45056
MA 152,72,44
    buffer_load_dwordx4 a[4:7], v8, s[8:11], s45 offen offset:1024 sc1
MA 156,76,44
LW 4
MA 96,200,48
TR 60,199,36864
MA 100,204,48
TR 62,199,45056
MA 160,72,48
    buffer_load_dwordx4 a[136:139], v7, s[8:11], s45 offen offset:2048 sc1
MA 164,76,48
LW 4
MA 104,200,52
    s_waitcnt vmcnt(37)
    s_barrier
TR 32,192,49152
MA 108,204,52
TR 34,192,57344
MA 168,72,52
    buffer_load_dwordx4 a[140:143], v7, s[8:11], s45 offen offset:3072 sc1
MA 172,76,52
LW 4
MA 112,200,56
TR 36,193,49152
MA 116,204,56
TR 38,193,57344
MA 176,72,56
    buffer_load_dwordx4 a[8:11], v8, s[8:11], s45 offen offset:2048 sc1
MA 180,76,56
LW 4
MA 120,200,60
TR 40,194,49152
MA 124,204,60
TR 42,194,57344
MA 184,72,60
    buffer_load_dwordx4 a[12:15], v8, s[8:11], s45 offen offset:3072 sc1
MA 188,76,60
LW 4
MA 64,208,32
TR 44,195,49152
    s_mov_b32 s45, 77824
MA 68,212,32
TR 46,195,57344
MA 128,80,32
    buffer_load_dwordx4 a[144:147], v7, s[8:11], s45 offen offset:0 sc1
MA 132,84,32
LW 4
MA 72,208,36
TR 48,196,49152
MA 76,212,36
TR 50,196,57344
MA 136,80,36
    buffer_load_dwordx4 a[148:151], v7, s[8:11], s45 offen offset:1024 sc1
MA 140,84,36
LW 4
MA 80,208,40
TR 52,197,49152
MA 84,212,40
TR 54,197,57344
MA 144,80,40
    buffer_load_dwordx4 a[16:19], v8, s[8:11], s45 offen offset:0 sc1
MA 148,84,40
LW 4
MA 88,208,44
TR 56,198,49152
MA 92,212,44
TR 58,198,57344
MA 152,80,44
    buffer_load_dwordx4 a[20:23], v8, s[8:11], s45 offen offset:1024 sc1
MA 156,84,44
LW 4
MA 96,208,48
TR 60,199,49152
MA 100,212,48
TR 62,199,57344
MA 160,80,48
    buffer_load_dwordx4 a[152:155], v7, s[8:11], s45 offen offset:2048 sc1
MA 164,84,48
LW 4
MA 104,208,52
TR 32,192,53248
MA 108,212,52
TR 34,192,61440
MA 168,80,52
    buffer_load_dwordx4 a[156:159], v7, s[8:11], s45 offen offset:3072 sc1
MA 172,84,52
LW 4
MA 112,208,56
TR 36,193,53248
MA 116,212,56
TR 38,193,61440
MA 176,80,56
    buffer_load_dwordx4 a[24:27], v8, s[8:11], s45 offen offset:2048 sc1
MA 180,84,56
LW 4
MA 120,208,60
TR 40,194,53248
MA 124,212,60
TR 42,194,61440
MA 184,80,60
    buffer_load_dwordx4 a[28:31], v8, s[8:11], s45 offen offset:3072 sc1
MA 188,84,60
LW 4
MA 64,216,32
TR 44,195,53248
    s_add_u32 m0, s38, 131072
MA 68,220,32
TR 46,195,61440
    s_mov_b32 s44, 7340032
MA 128,88,32
    buffer_load_dwordx4 v9, s[4:7], s44 offen offset:0 lds
MA 132,92,32
LW 4
MA 72,216,36
TR 48,196,53248
MA 76,220,36
TR 50,196,61440
MA 136,88,36
    buffer_load_dwordx4 v10, s[4:7], s44 offen offset:1024 lds
MA 140,92,36
LW 4
MA 80,216,40
TR 52,197,53248
MA 84,220,40
TR 54,197,61440
MA 144,88,40
    buffer_load_dwordx4 v11, s[4:7], s44 offen offset:2048 lds
MA 148,92,40
LW 4
MA 88,216,44
TR 56,198,53248
MA 92,220,44
TR 58,198,61440
MA 152,88,44
    buffer_load_dwordx4 v12, s[4:7], s44 offen offset:3072 lds
MA 156,92,44
LW 4
MA 96,216,48
TR 60,199,53248
    s_add_u32 m0, s38, 147456
MA 100,220,48
TR 62,199,61440
    s_mov_b32 s44, 7798784
MA 160,88,48
    buffer_load_dwordx4 v9, s[4:7], s44 offen offset:0 lds
MA 164,92,48
LW 4
MA 104,216,52
    s_waitcnt vmcnt(37)
    s_barrier
TR 32,200,0
MA 108,220,52
TR 34,200,8192
MA 168,88,52
    buffer_load_dwordx4 v10, s[4:7], s44 offen offset:1024 lds
MA 172,92,52
LW 4
MA 112,216,56
TR 36,201,0
MA 116,220,56
TR 38,201,8192
MA 176,88,56
    buffer_load_dwordx4 v11, s[4:7], s44 offen offset:2048 lds
MA 180,92,56
LW 4
MA 120,216,60
TR 40,202,0
MA 124,220,60
TR 42,202,8192
MA 184,88,60
    buffer_load_dwordx4 v12, s[4:7], s44 offen offset:3072 lds
MA 188,92,60
LW 4
MA 64,224,32
TR 44,203,0
    s_mov_b32 s45, 65536
MA 68,228,32
TR 46,203,8192
MA 128,96,32
    buffer_load_dwordx4 a[160:163], v7, s[8:11], s45 offen offset:0 sc1
MA 132,100,32
LW 4
MA 72,224,36
TR 48,204,0
MA 76,228,36
TR 50,204,8192
MA 136,96,36
    buffer_load_dwordx4 a[164:167], v7, s[8:11], s45 offen offset:1024 sc1
MA 140,100,36
LW 4
MA 80,224,40
TR 52,205,0
MA 84,228,40
TR 54,205,8192
MA 144,96,40
    buffer_load_dwordx4 a[32:35], v8, s[8:11], s45 offen offset:0 sc1
MA 148,100,40
LW 4
MA 88,224,44
TR 56,206,0
MA 92,228,44
TR 58,206,8192
MA 152,96,44
    buffer_load_dwordx4 a[36:39], v8, s[8:11], s45 offen offset:1024 sc1
MA 156,100,44
LW 4
MA 96,224,48
TR 60,207,0
MA 100,228,48
TR 62,207,8192
MA 160,96,48
    buffer_load_dwordx4 a[168:171], v7, s[8:11], s45 offen offset:2048 sc1
MA 164,100,48
LW 4
MA 104,224,52
TR 32,200,4096
MA 108,228,52
TR 34,200,12288
MA 168,96,52
    buffer_load_dwordx4 a[172:175], v7, s[8:11], s45 offen offset:3072 sc1
MA 172,100,52
LW 4
MA 112,224,56
TR 36,201,4096
MA 116,228,56
TR 38,201,12288
MA 176,96,56
    buffer_load_dwordx4 a[40:43], v8, s[8:11], s45 offen offset:2048 sc1
MA 180,100,56
LW 4
MA 120,224,60
TR 40,202,4096
MA 124,228,60
TR 42,202,12288
MA 184,96,60
    buffer_load_dwordx4 a[44:47], v8, s[8:11], s45 offen offset:3072 sc1
MA 188,100,60
LW 4
MA 64,232,32
TR 44,203,4096
    s_mov_b32 s45, 69632
MA 68,236,32
TR 46,203,12288
MA 128,104,32
    buffer_load_dwordx4 a[176:179], v7, s[8:11], s45 offen offset:0 sc1
MA 132,108,32
LW 4
MA 72,232,36
TR 48,204,4096
MA 76,236,36
TR 50,204,12288
MA 136,104,36
    buffer_load_dwordx4 a[180:183], v7, s[8:11], s45 offen offset:1024 sc1
MA 140,108,36
LW 4
MA 80,232,40
TR 52,205,4096
MA 84,236,40
TR 54,205,12288
MA 144,104,40
    buffer_load_dwordx4 a[48:51], v8, s[8:11], s45 offen offset:0 sc1
MA 148,108,40
LW 4
MA 88,232,44
TR 56,206,4096
MA 92,236,44
TR 58,206,12288
MA 152,104,44
    buffer_load_dwordx4 a[52:55], v8, s[8:11], s45 offen offset:1024 sc1
MA 156,108,44
LW 4
MA 96,232,48
TR 60,207,4096
MA 100,236,48
TR 62,207,12288
MA 160,104,48
    buffer_load_dwordx4 a[184:187], v7, s[8:11], s45 offen offset:2048 sc1
MA 164,108,48
LW 4
MA 104,232,52
    s_waitcnt vmcnt(45)
    s_barrier
TR 32,200,16384
MA 108,236,52
TR 34,200,24576
MA 168,104,52
    buffer_load_dwordx4 a[188:191], v7, s[8:11], s45 offen offset:3072 sc1
MA 172,108,52
LW 4
MA 112,232,56
TR 36,201,16384
MA 116,236,56
TR 38,201,24576
MA 176,104,56
    buffer_load_dwordx4 a[56:59], v8, s[8:11], s45 offen offset:2048 sc1
MA 180,108,56
LW 4
MA 120,232,60
TR 40,202,16384
MA 124,236,60
TR 42,202,24576
MA 184,104,60
    buffer_load_dwordx4 a[60:63], v8, s[8:11], s45 offen offset:3072 sc1
MA 188,108,60
LW 4
MA 64,240,32
TR 44,203,16384
    s_add_u32 m0, s38, 0
MA 68,244,32
TR 46,203,24576
    s_mov_b32 s44, 9175040
MA 128,112,32
    buffer_load_dwordx4 v9, s[4:7], s44 offen offset:0 lds
MA 132,116,32
LW 4
MA 72,240,36
TR 48,204,16384
MA 76,244,36
TR 50,204,24576
MA 136,112,36
    buffer_load_dwordx4 v10, s[4:7], s44 offen offset:1024 lds
MA 140,116,36
LW 4
MA 80,240,40
TR 52,205,16384
MA 84,244,40
TR 54,205,24576
MA 144,112,40
    buffer_load_dwordx4 v11, s[4:7], s44 offen offset:2048 lds
MA 148,116,40
LW 4
MA 88,240,44
TR 56,206,16384
MA 92,244,44
TR 58,206,24576
MA 152,112,44
    buffer_load_dwordx4 v12, s[4:7], s44 offen offset:3072 lds
MA 156,116,44
LW 4
MA 96,240,48
TR 60,207,16384
    s_add_u32 m0, s38, 16384
MA 100,244,48
TR 62,207,24576
    s_mov_b32 s44, 9633792
MA 160,112,48
    buffer_load_dwordx4 v9, s[4:7], s44 offen offset:0 lds
MA 164,116,48
LW 4
MA 104,240,52
TR 32,200,20480
MA 108,244,52
TR 34,200,28672
MA 168,112,52
    buffer_load_dwordx4 v10, s[4:7], s44 offen offset:1024 lds
MA 172,116,52
LW 4
MA 112,240,56
TR 36,201,20480
MA 116,244,56
TR 38,201,28672
MA 176,112,56
    buffer_load_dwordx4 v11, s[4:7], s44 offen offset:2048 lds
MA 180,116,56
LW 4
MA 120,240,60
TR 40,202,20480
MA 124,244,60
TR 42,202,28672
MA 184,112,60
    buffer_load_dwordx4 v12, s[4:7], s44 offen offset:3072 lds
MA 188,116,60
LW 4
MA 64,248,32
TR 44,203,20480
    s_mov_b32 s45, 81920
MA 68,252,32
TR 46,203,28672
MA 128,120,32
    buffer_load_dwordx4 a[64:67], v8, s[8:11], s45 offen offset:0 sc1
MA 132,124,32
LW 4
MA 72,248,36
TR 48,204,20480
MA 76,252,36
TR 50,204,28672
MA 136,120,36
    buffer_load_dwordx4 a[68:71], v8, s[8:11], s45 offen offset:1024 sc1
MA 140,124,36
LW 4
MA 80,248,40
TR 52,205,20480
MA 84,252,40
TR 54,205,28672
MA 144,120,40
    buffer_load_dwordx4 a[72:75], v8, s[8:11], s45 offen offset:2048 sc1
MA 148,124,40
LW 4
MA 88,248,44
TR 56,206,20480
MA 92,252,44
TR 58,206,28672
MA 152,120,44
    buffer_load_dwordx4 a[76:79], v8, s[8:11], s45 offen offset:3072 sc1
MA 156,124,44
LW 4
MA 96,248,48
TR 60,207,20480
    s_mov_b32 s45, 86016
MA 100,252,48
TR 62,207,28672
MA 160,120,48
    buffer_load_dwordx4 a[80:83], v8, s[8:11], s45 offen offset:0 sc1
MA 164,124,48
LW 4
MA 104,248,52
    s_waitcnt vmcnt(45)
    s_barrier
TR 32,200,32768
MA 108,252,52
TR 34,200,40960
MA 168,120,52
    buffer_load_dwordx4 a[84:87], v8, s[8:11], s45 offen offset:1024 sc1
MA 172,124,52
LW 4
MA 112,248,56
TR 36,201,32768
MA 116,252,56
TR 38,201,40960
MA 176,120,56
    buffer_load_dwordx4 a[88:91], v8, s[8:11], s45 offen offset:2048 sc1
MA 180,124,56
LW 4
MA 120,248,60
TR 40,202,32768
MA 124,252,60
TR 42,202,40960
MA 184,120,60
    buffer_load_dwordx4 a[92:95], v8, s[8:11], s45 offen offset:3072 sc1
MA 188,124,60
LW 4
MA 64,128,32
TR 44,203,32768
    s_add_u32 m0, s38, 32768
MA 68,132,32
TR 46,203,40960
    s_mov_b32 s44, 10092544
MA 128,0,32
    buffer_load_dwordx4 v9, s[4:7], s44 offen offset:0 lds
MA 132,4,32
LW 4
MA 72,128,36
TR 48,204,32768
MA 76,132,36
TR 50,204,40960
MA 136,0,36
    buffer_load_dwordx4 v10, s[4:7], s44 offen offset:1024 lds
MA 140,4,36
LW 4
MA 80,128,40
TR 52,205,32768
MA 84,132,40
TR 54,205,40960
MA 144,0,40
    buffer_load_dwordx4 v11, s[4:7], s44 offen offset:2048 lds
MA 148,4,40
LW 4
MA 88,128,44
TR 56,206,32768
MA 92,132,44
TR 58,206,40960
MA 152,0,44
    buffer_load_dwordx4 v12, s[4:7], s44 offen offset:3072 lds
MA 156,4,44
LW 4
MA 96,128,48
TR 60,207,32768
    s_add_u32 m0, s38, 49152
MA 100,132,48
TR 62,207,40960
    s_mov_b32 s44, 10551296
MA 160,0,48
    buffer_load_dwordx4 v9, s[4:7], s44 offen offset:0 lds
MA 164,4,48
LW 4
MA 104,128,52
TR 32,200,36864
MA 108,132,52
TR 34,200,45056
MA 168,0,52
    buffer_load_dwordx4 v10, s[4:7], s44 offen offset:1024 lds
MA 172,4,52
LW 4
MA 112,128,56
TR 36,201,36864
MA 116,132,56
TR 38,201,45056
MA 176,0,56
    buffer_load_dwordx4 v11, s[4:7], s44 offen offset:2048 lds
MA 180,4,56
LW 4
MA 120,128,60
TR 40,202,36864
MA 124,132,60
TR 42,202,45056
MA 184,0,60
    buffer_load_dwordx4 v12, s[4:7], s44 offen offset:3072 lds
MA 188,4,60
LW 4
MA 64,136,32
TR 44,203,36864
    s_mov_b32 s45, 90112
MA 68,140,32
TR 46,203,45056
MA 128,8,32
    buffer_load_dwordx4 a[96:99], v8, s[8:11], s45 offen offset:0 sc1
MA 132,12,32
LW 4
MA 72,136,36
TR 48,204,36864
MA 76,140,36
TR 50,204,45056
MA 136,8,36
    buffer_load_dwordx4 a[100:103], v8, s[8:11], s45 offen offset:1024 sc1
MA 140,12,36
LW 4
MA 80,136,40
TR 52,205,36864
MA 84,140,40
TR 54,205,45056
MA 144,8,40
    buffer_load_dwordx4 a[104:107], v8, s[8:11], s45 offen offset:2048 sc1
MA 148,12,40
LW 4
MA 88,136,44
TR 56,206,36864
MA 92,140,44
TR 58,206,45056
MA 152,8,44
    buffer_load_dwordx4 a[108:111], v8, s[8:11], s45 offen offset:3072 sc1
MA 156,12,44
LW 4
MA 96,136,48
TR 60,207,36864
    s_mov_b32 s45, 94208
MA 100,140,48
TR 62,207,45056
MA 160,8,48
    buffer_load_dwordx4 a[112:115], v8, s[8:11], s45 offen offset:0 sc1
MA 164,12,48
LW 4
MA 104,136,52
    s_waitcnt vmcnt(53)
    s_barrier
TR 32,200,49152
MA 108,140,52
TR 34,200,57344
MA 168,8,52
    buffer_load_dwordx4 a[116:119], v8, s[8:11], s45 offen offset:1024 sc1
MA 172,12,52
LW 4
MA 112,136,56
TR 36,201,49152
MA 116,140,56
TR 38,201,57344
MA 176,8,56
    buffer_load_dwordx4 a[120:123], v8, s[8:11], s45 offen offset:2048 sc1
MA 180,12,56
LW 4
MA 120,136,60
TR 40,202,49152
MA 124,140,60
TR 42,202,57344
MA 184,8,60
    buffer_load_dwordx4 a[124:127], v8, s[8:11], s45 offen offset:3072 sc1
MA 188,12,60
LW 4
MA 64,144,32
TR 44,203,49152
    s_add_u32 m0, s38, 65536
MA 68,148,32
TR 46,203,57344
    s_mov_b32 s44, 11927552
MA 128,16,32
    buffer_load_dwordx4 v9, s[4:7], s44 offen offset:0 lds
MA 132,20,32
LW 4
MA 72,144,36
TR 48,204,49152
MA 76,148,36
TR 50,204,57344
MA 136,16,36
    buffer_load_dwordx4 v10, s[4:7], s44 offen offset:1024 lds
MA 140,20,36
LW 4
MA 80,144,40
TR 52,205,49152
MA 84,148,40
TR 54,205,57344
MA 144,16,40
    buffer_load_dwordx4 v11, s[4:7], s44 offen offset:2048 lds
MA 148,20,40
LW 4
MA 88,144,44
TR 56,206,49152
MA 92,148,44
TR 58,206,57344
MA 152,16,44
    buffer_load_dwordx4 v12, s[4:7], s44 offen offset:3072 lds
MA 156,20,44
LW 4
MA 96,144,48
TR 60,207,49152
    s_add_u32 m0, s38, 81920
MA 100,148,48
TR 62,207,57344
    s_mov_b32 s44, 12386304
MA 160,16,48
    buffer_load_dwordx4 v9, s[4:7], s44 offen offset:0 lds
MA 164,20,48
LW 4
MA 104,144,52
TR 32,200,53248
MA 108,148,52
TR 34,200,61440
MA 168,16,52
    buffer_load_dwordx4 v10, s[4:7], s44 offen offset:1024 lds
MA 172,20,52
LW 4
MA 112,144,56
TR 36,201,53248
MA 116,148,56
TR 38,201,61440
MA 176,16,56
    buffer_load_dwordx4 v11, s[4:7], s44 offen offset:2048 lds
MA 180,20,56
LW 4
MA 120,144,60
TR 40,202,53248
MA 124,148,60
TR 42,202,61440
MA 184,16,60
    buffer_load_dwordx4 v12, s[4:7], s44 offen offset:3072 lds
MA 188,20,60
LW 4
MA 64,152,32
TR 44,203,53248
MA 68,156,32
TR 46,203,61440
MA 128,24,32
MA 132,28,32
LW 4
MA 72,152,36
TR 48,204,53248
MA 76,156,36
TR 50,204,61440
MA 136,24,36
MA 140,28,36
LW 4
MA 80,152,40
TR 52,205,53248
MA 84,156,40
TR 54,205,61440
MA 144,24,40
MA 148,28,40
LW 4
MA 88,152,44
TR 56,206,53248
MA 92,156,44
TR 58,206,61440
MA 152,24,44
MA 156,28,44
LW 4
MA 96,152,48
TR 60,207,53248
MA 100,156,48
TR 62,207,61440
MA 160,24,48
MA 164,28,48
LW 4
MA 104,152,52
    s_waitcnt vmcnt(48)
    s_barrier
TR 32,208,0
MA 108,156,52
TR 34,208,8192
MA 168,24,52
MA 172,28,52
LW 4
MA 112,152,56
TR 36,209,0
MA 116,156,56
TR 38,209,8192
MA 176,24,56
MA 180,28,56
LW 4
MA 120,152,60
TR 40,210,0
MA 124,156,60
TR 42,210,8192
MA 184,24,60
MA 188,28,60
LW 4
MA 64,160,32
TR 44,211,0
MA 68,164,32
TR 46,211,8192
MA 128,32,32
MA 132,36,32
LW 4
MA 72,160,36
TR 48,212,0
MA 76,164,36
TR 50,212,8192
MA 136,32,36
MA 140,36,36
LW 4
MA 80,160,40
TR 52,213,0
MA 84,164,40
TR 54,213,8192
MA 144,32,40
MA 148,36,40
LW 4
MA 88,160,44
TR 56,214,0
MA 92,164,44
TR 58,214,8192
MA 152,32,44
MA 156,36,44
LW 4
MA 96,160,48
TR 60,215,0
    s_mov_b32 s45, 106496
MA 100,164,48
TR 62,215,8192
MA 160,32,48
    buffer_load_dwordx4 a[0:3], v8, s[8:11], s45 offen offset:0 sc1
MA 164,36,48
LW 4
MA 104,160,52
TR 32,208,4096
MA 108,164,52
TR 34,208,12288
MA 168,32,52
    buffer_load_dwordx4 a[4:7], v8, s[8:11], s45 offen offset:1024 sc1
MA 172,36,52
LW 4
MA 112,160,56
TR 36,209,4096
MA 116,164,56
TR 38,209,12288
MA 176,32,56
    buffer_load_dwordx4 a[8:11], v8, s[8:11], s45 offen offset:2048 sc1
MA 180,36,56
LW 4
MA 120,160,60
TR 40,210,4096
MA 124,164,60
TR 42,210,12288
MA 184,32,60
    buffer_load_dwordx4 a[12:15], v8, s[8:11], s45 offen offset:3072 sc1
MA 188,36,60
LW 4
MA 64,168,32
TR 44,211,4096
    s_mov_b32 s45, 110592
MA 68,172,32
TR 46,211,12288
MA 128,40,32
    buffer_load_dwordx4 a[16:19], v8, s[8:11], s45 offen offset:0 sc1
MA 132,44,32
LW 4
MA 72,168,36
TR 48,212,4096
MA 76,172,36
TR 50,212,12288
MA 136,40,36
    buffer_load_dwordx4 a[20:23], v8, s[8:11], s45 offen offset:1024 sc1
MA 140,44,36
LW 4
MA 80,168,40
TR 52,213,4096
MA 84,172,40
TR 54,213,12288
MA 144,40,40
    buffer_load_dwordx4 a[24:27], v8, s[8:11], s45 offen offset:2048 sc1
MA 148,44,40
LW 4
MA 88,168,44
TR 56,214,4096
MA 92,172,44
TR 58,214,12288
MA 152,40,44
    buffer_load_dwordx4 a[28:31], v8, s[8:11], s45 offen offset:3072 sc1
MA 156,44,44
LW 4
MA 96,168,48
TR 60,215,4096
    s_add_u32 m0, s38, 98304
MA 100,172,48
TR 62,215,12288
    s_mov_b32 s44, 11010048
MA 160,40,48
    buffer_load_dwordx4 v9, s[4:7], s44 offen offset:0 lds
MA 164,44,48
LW 4
MA 104,168,52
    s_waitcnt vmcnt(49)
    s_barrier
TR 32,208,16384
MA 108,172,52
TR 34,208,24576
MA 168,40,52
    buffer_load_dwordx4 v10, s[4:7], s44 offen offset:1024 lds
MA 172,44,52
LW 4
MA 112,168,56
TR 36,209,16384
MA 116,172,56
TR 38,209,24576
MA 176,40,56
    buffer_load_dwordx4 v11, s[4:7], s44 offen offset:2048 lds
MA 180,44,56
LW 4
MA 120,168,60
TR 40,210,16384
MA 124,172,60
TR 42,210,24576
MA 184,40,60
    buffer_load_dwordx4 v12, s[4:7], s44 offen offset:3072 lds
MA 188,44,60
LW 4
MA 64,176,32
TR 44,211,16384
    s_add_u32 m0, s38, 114688
MA 68,180,32
TR 46,211,24576
    s_mov_b32 s44, 11468800
MA 128,48,32
    buffer_load_dwordx4 v9, s[4:7], s44 offen offset:0 lds
MA 132,52,32
    s_mov_b32 s46, 81920
LW 4
MA 72,176,36
TR 48,212,16384
MA 76,180,36
TR 50,212,24576
MA 136,48,36
    buffer_load_dwordx4 v10, s[4:7], s44 offen offset:1024 lds
MA 140,52,36
    s_mov_b32 s47, 90112
LW 4
MA 80,176,40
TR 52,213,16384
MA 84,180,40
TR 54,213,24576
MA 144,48,40
    buffer_load_dwordx4 v11, s[4:7], s44 offen offset:2048 lds
MA 148,52,40
    s_mov_b32 s48, 106496
LW 4
MA 88,176,44
TR 56,214,16384
MA 92,180,44
TR 58,214,24576
MA 152,48,44
    buffer_load_dwordx4 v12, s[4:7], s44 offen offset:3072 lds
MA 156,52,44
    s_mov_b32 s49, 98304
LW 4
MA 96,176,48
TR 60,215,16384
    s_mov_b32 s45, 98304
MA 100,180,48
TR 62,215,24576
MA 160,48,48
    buffer_load_dwordx4 a[32:35], v8, s[8:11], s45 offen offset:0 sc1
MA 164,52,48
LW 4
MA 104,176,52
TR 32,208,20480
MA 108,180,52
TR 34,208,28672
MA 168,48,52
    buffer_load_dwordx4 a[36:39], v8, s[8:11], s45 offen offset:1024 sc1
MA 172,52,52
LW 4
MA 112,176,56
TR 36,209,20480
MA 116,180,56
TR 38,209,28672
MA 176,48,56
    buffer_load_dwordx4 a[40:43], v8, s[8:11], s45 offen offset:2048 sc1
MA 180,52,56
LW 4
MA 120,176,60
TR 40,210,20480
MA 124,180,60
TR 42,210,28672
MA 184,48,60
    buffer_load_dwordx4 a[44:47], v8, s[8:11], s45 offen offset:3072 sc1
MA 188,52,60
LW 4
MA 64,184,32
TR 44,211,20480
MA 68,188,32
TR 46,211,28672
MA 128,56,32
MA 132,60,32
LW 4
MA 72,184,36
TR 48,212,20480
MA 76,188,36
TR 50,212,28672
MA 136,56,36
MA 140,60,36
LW 4
MA 80,184,40
TR 52,213,20480
MA 84,188,40
TR 54,213,28672
MA 144,56,40
MA 148,60,40
LW 4
MA 88,184,44
TR 56,214,20480
MA 92,188,44
TR 58,214,28672
MA 152,56,44
MA 156,60,44
LW 4
MA 96,184,48
TR 60,215,20480
MA 100,188,48
TR 62,215,28672
MA 160,56,48
MA 164,60,48
LW 4
MA 104,184,52
    s_waitcnt vmcnt(28)
    s_barrier
TR 32,192,0
MA 108,188,52
TR 34,192,8192
MA 168,56,52
MA 172,60,52
LW 4
MA 112,184,56
TR 36,193,0
MA 116,188,56
TR 38,193,8192
MA 176,56,56
MA 180,60,56
LW 4
MA 120,184,60
TR 40,192,4096
MA 124,188,60
TR 42,192,12288
MA 184,56,60
TR 44,193,4096
MA 188,60,60
TR 46,193,12288
    s_branch L_pass
L_miss16:
    s_mov_b32 s39, 4194304
    s_branch L_pld19
L_poll19:
    s_sub_u32 s39, s39, 1
    s_cbranch_scc1 L_exit0
    s_sleep 1
L_pld19:
    buffer_load_dwordx2 v[26:27], v22, s[8:11], 0 offen offset:128 sc1
    s_waitcnt vmcnt(0)
L_pchk19:
    v_cmp_ne_u64 vcc, s[56:57], v[26:27]
    s_nop 1
    s_cmp_lg_u64 vcc, 0
    s_cbranch_scc1 L_poll19
    s_branch L_back16
L_miss18:
    s_mov_b32 s39, 4194304
    s_branch L_pld20
L_poll20:
    s_sub_u32 s39, s39, 1
    s_cbranch_scc1 L_exit0
    s_sleep 1
L_pld20:
    buffer_load_dwordx2 v[26:27], v22, s[8:11], 0 offen offset:256 sc1
    s_waitcnt vmcnt(0)
L_pchk20:
    v_cmp_ne_u64 vcc, s[56:57], v[26:27]
    s_nop 1
    s_cmp_lg_u64 vcc, 0
    s_cbranch_scc1 L_poll20
    s_branch L_back18
L_var2:
    buffer_store_dwordx2 v[24:25], v29, s[8:11], s43 offen sc1
    s_cmp_eq_u32 s100, 0
    s_cbranch_scc1 L_noz21
    buffer_store_dwordx2 v[24:25], v30, s[8:11], s63 offen sc1
L_noz21:
    s_waitcnt vmcnt(9)
    s_barrier
    s_cmp_eq_u32 s100, 0
    s_cbranch_scc1 L_nof22
    s_mov_b64 exec, 0xffff
    buffer_store_dwordx2 v[4:5], v29, s[8:11], s54 offen offset:256 sc1
    s_mov_b64 exec, -1
L_nof22:
TR 32,192,0
TR 34,192,8192
TR 36,193,0
TR 38,193,8192
TR 40,194,0
TR 42,194,8192
LW 4
MA 64,128,32
TR 44,195,0
    s_add_u32 m0, s38, 32768
MA 68,132,32
TR 46,195,8192
    s_mov_b32 s44, 1835008
MA 128,0,32
    buffer_load_dwordx4 v9, s[4:7], s44 offen offset:0 lds
MA 132,4,32
LW 4
MA 72,128,36
TR 48,196,0
MA 76,132,36
TR 50,196,8192
MA 136,0,36
    buffer_load_dwordx4 v10, s[4:7], s44 offen offset:1024 lds
MA 140,4,36
LW 4
MA 80,128,40
TR 52,197,0
MA 84,132,40
TR 54,197,8192
MA 144,0,40
    buffer_load_dwordx4 v11, s[4:7], s44 offen offset:2048 lds
MA 148,4,40
LW 4
MA 88,128,44
TR 56,198,0
MA 92,132,44
TR 58,198,8192
MA 152,0,44
    buffer_load_dwordx4 v12, s[4:7], s44 offen offset:3072 lds
MA 156,4,44
LW 4
MA 96,128,48
TR 60,199,0
    s_add_u32 m0, s38, 49152
MA 100,132,48
TR 62,199,8192
    s_mov_b32 s44, 2293760
MA 160,0,48
    buffer_load_dwordx4 v9, s[4:7], s44 offen offset:0 lds
MA 164,4,48
LW 4
MA 104,128,52
TR 32,192,4096
MA 108,132,52
TR 34,192,12288
MA 168,0,52
    buffer_load_dwordx4 v10, s[4:7], s44 offen offset:1024 lds
MA 172,4,52
LW 4
MA 112,128,56
TR 36,193,4096
MA 116,132,56
TR 38,193,12288
MA 176,0,56
    buffer_load_dwordx4 v11, s[4:7], s44 offen offset:2048 lds
MA 180,4,56
LW 4
MA 120,128,60
TR 40,194,4096
MA 124,132,60
TR 42,194,12288
MA 184,0,60
    buffer_load_dwordx4 v12, s[4:7], s44 offen offset:3072 lds
    s_sub_u32 s39, s32, 2
    s_cmp_ge_u32 s39, 2
    s_cbranch_scc1 L_nog23
    buffer_load_dword v15, v15, s[12:15], 0 offen
L_nog23:
MA 188,4,60
LW 4
MA 64,136,32
TR 44,195,4096
MA 68,140,32
TR 46,195,12288
MA 128,8,32
MA 132,12,32
LW 4
MA 72,136,36
TR 48,196,4096
MA 76,140,36
TR 50,196,12288
MA 136,8,36
MA 140,12,36
LW 4
MA 80,136,40
TR 52,197,4096
MA 84,140,40
TR 54,197,12288
MA 144,8,40
MA 148,12,40
LW 4
MA 88,136,44
TR 56,198,4096
MA 92,140,44
TR 58,198,12288
MA 152,8,44
MA 156,12,44
LW 4
MA 96,136,48
TR 60,199,4096
    s_mov_b32 s45, 16384
MA 100,140,48
TR 62,199,12288
MA 160,8,48
    buffer_load_dwordx4 a[160:163], v7, s[8:11], s45 offen offset:0 sc1
MA 164,12,48
LW 4
MA 104,136,52
    s_waitcnt vmcnt(10)
    s_barrier
TR 32,192,16384
MA 108,140,52
TR 34,192,24576
MA 168,8,52
    buffer_load_dwordx4 a[164:167], v7, s[8:11], s45 offen offset:1024 sc1
MA 172,12,52
LW 4
MA 112,136,56
TR 36,193,16384
MA 116,140,56
TR 38,193,24576
MA 176,8,56
    buffer_load_dwordx4 a[32:35], v8, s[8:11], s45 offen offset:0 sc1
MA 180,12,56
LW 4
MA 120,136,60
TR 40,194,16384
MA 124,140,60
TR 42,194,24576
MA 184,8,60
    buffer_load_dwordx4 a[36:39], v8, s[8:11], s45 offen offset:1024 sc1
MA 188,12,60
LW 4
MA 64,144,32
TR 44,195,16384
MA 68,148,32
TR 46,195,24576
MA 128,16,32
    buffer_load_dwordx4 a[168:171], v7, s[8:11], s45 offen offset:2048 sc1
MA 132,20,32
LW 4
MA 72,144,36
TR 48,196,16384
MA 76,148,36
TR 50,196,24576
MA 136,16,36
    buffer_load_dwordx4 a[172:175], v7, s[8:11], s45 offen offset:3072 sc1
MA 140,20,36
LW 4
MA 80,144,40
TR 52,197,16384
MA 84,148,40
TR 54,197,24576
MA 144,16,40
    buffer_load_dwordx4 a[40:43], v8, s[8:11], s45 offen offset:2048 sc1
MA 148,20,40
LW 4
MA 88,144,44
TR 56,198,16384
MA 92,148,44
TR 58,198,24576
MA 152,16,44
    buffer_load_dwordx4 a[44:47], v8, s[8:11], s45 offen offset:3072 sc1
MA 156,20,44
LW 4
MA 96,144,48
TR 60,199,16384
    s_mov_b32 s45, 20480
MA 100,148,48
TR 62,199,24576
MA 160,16,48
    buffer_load_dwordx4 a[176:179], v7, s[8:11], s45 offen offset:0 sc1
MA 164,20,48
LW 4
MA 104,144,52
TR 32,192,20480
MA 108,148,52
TR 34,192,28672
MA 168,16,52
    buffer_load_dwordx4 a[180:183], v7, s[8:11], s45 offen offset:1024 sc1
MA 172,20,52
LW 4
MA 112,144,56
TR 36,193,20480
MA 116,148,56
TR 38,193,28672
MA 176,16,56
    buffer_load_dwordx4 a[48:51], v8, s[8:11], s45 offen offset:0 sc1
MA 180,20,56
LW 4
MA 120,144,60
TR 40,194,20480
MA 124,148,60
TR 42,194,28672
MA 184,16,60
    buffer_load_dwordx4 a[52:55], v8, s[8:11], s45 offen offset:1024 sc1
MA 188,20,60
LW 4
MA 64,152,32
TR 44,195,20480
MA 68,156,32
TR 46,195,28672
MA 128,24,32
    buffer_load_dwordx4 a[184:187], v7, s[8:11], s45 offen offset:2048 sc1
MA 132,28,32
LW 4
MA 72,152,36
TR 48,196,20480
MA 76,156,36
TR 50,196,28672
MA 136,24,36
    buffer_load_dwordx4 a[188:191], v7, s[8:11], s45 offen offset:3072 sc1
MA 140,28,36
LW 4
MA 80,152,40
TR 52,197,20480
MA 84,156,40
TR 54,197,28672
MA 144,24,40
    buffer_load_dwordx4 a[56:59], v8, s[8:11], s45 offen offset:2048 sc1
MA 148,28,40
LW 4
MA 88,152,44
TR 56,198,20480
MA 92,156,44
TR 58,198,28672
MA 152,24,44
    buffer_load_dwordx4 a[60:63], v8, s[8:11], s45 offen offset:3072 sc1
MA 156,28,44
LW 4
MA 96,152,48
TR 60,199,20480
    s_add_u32 m0, s38, 65536
MA 100,156,48
TR 62,199,28672
    s_mov_b32 s44, 917504
MA 160,24,48
    buffer_load_dwordx4 v9, s[4:7], s44 offen offset:0 lds
MA 164,28,48
LW 4
MA 104,152,52
    s_waitcnt vmcnt(9)
    s_barrier
TR 32,192,32768
MA 108,156,52
TR 34,192,40960
MA 168,24,52
    buffer_load_dwordx4 v10, s[4:7], s44 offen offset:1024 lds
MA 172,28,52
LW 4
MA 112,152,56
TR 36,193,32768
MA 116,156,56
TR 38,193,40960
MA 176,24,56
    buffer_load_dwordx4 v11, s[4:7], s44 offen offset:2048 lds
MA 180,28,56
LW 4
MA 120,152,60
TR 40,194,32768
MA 124,156,60
TR 42,194,40960
MA 184,24,60
    buffer_load_dwordx4 v12, s[4:7], s44 offen offset:3072 lds
MA 188,28,60
LW 4
MA 64,160,32
TR 44,195,32768
    s_add_u32 m0, s38, 81920
MA 68,164,32
TR 46,195,40960
    s_mov_b32 s44, 1376256
MA 128,32,32
    buffer_load_dwordx4 v9, s[4:7], s44 offen offset:0 lds
MA 132,36,32
LW 4
MA 72,160,36
TR 48,196,32768
MA 76,164,36
TR 50,196,40960
MA 136,32,36
    buffer_load_dwordx4 v10, s[4:7], s44 offen offset:1024 lds
MA 140,36,36
LW 4
MA 80,160,40
TR 52,197,32768
MA 84,164,40
TR 54,197,40960
MA 144,32,40
    buffer_load_dwordx4 v11, s[4:7], s44 offen offset:2048 lds
MA 148,36,40
LW 4
MA 88,160,44
TR 56,198,32768
MA 92,164,44
TR 58,198,40960
MA 152,32,44
    buffer_load_dwordx4 v12, s[4:7], s44 offen offset:3072 lds
MA 156,36,44
LW 4
MA 96,160,48
TR 60,199,32768
    s_mov_b32 s45, 8192
MA 100,164,48
TR 62,199,40960
MA 160,32,48
    buffer_load_dwordx4 a[192:195], v7, s[8:11], s45 offen offset:0 sc1
MA 164,36,48
LW 4
MA 104,160,52
TR 32,192,36864
MA 108,164,52
TR 34,192,45056
MA 168,32,52
    buffer_load_dwordx4 a[196:199], v7, s[8:11], s45 offen offset:1024 sc1
MA 172,36,52
LW 4
MA 112,160,56
TR 36,193,36864
MA 116,164,56
TR 38,193,45056
MA 176,32,56
    buffer_load_dwordx4 a[64:67], v8, s[8:11], s45 offen offset:0 sc1
MA 180,36,56
LW 4
MA 120,160,60
TR 40,194,36864
MA 124,164,60
TR 42,194,45056
MA 184,32,60
    buffer_load_dwordx4 a[68:71], v8, s[8:11], s45 offen offset:1024 sc1
MA 188,36,60
LW 4
MA 64,168,32
TR 44,195,36864
MA 68,172,32
TR 46,195,45056
MA 128,40,32
    buffer_load_dwordx4 a[200:203], v7, s[8:11], s45 offen offset:2048 sc1
MA 132,44,32
LW 4
MA 72,168,36
TR 48,196,36864
MA 76,172,36
TR 50,196,45056
MA 136,40,36
    buffer_load_dwordx4 a[204:207], v7, s[8:11], s45 offen offset:3072 sc1
MA 140,44,36
LW 4
MA 80,168,40
TR 52,197,36864
MA 84,172,40
TR 54,197,45056
MA 144,40,40
    buffer_load_dwordx4 a[72:75], v8, s[8:11], s45 offen offset:2048 sc1
MA 148,44,40
LW 4
MA 88,168,44
TR 56,198,36864
MA 92,172,44
TR 58,198,45056
MA 152,40,44
    buffer_load_dwordx4 a[76:79], v8, s[8:11], s45 offen offset:3072 sc1
MA 156,44,44
LW 4
MA 96,168,48
TR 60,199,36864
    s_mov_b32 s45, 12288
MA 100,172,48
TR 62,199,45056
MA 160,40,48
    buffer_load_dwordx4 a[208:211], v7, s[8:11], s45 offen offset:0 sc1
MA 164,44,48
LW 4
MA 104,168,52
    s_waitcnt vmcnt(17)
    s_barrier
TR 32,192,49152
MA 108,172,52
TR 34,192,57344
MA 168,40,52
    buffer_load_dwordx4 a[212:215], v7, s[8:11], s45 offen offset:1024 sc1
MA 172,44,52
    buffer_load_dwordx2 v[26:27], v22, s[8:11], 0 offen offset:128 sc1
LW 4
MA 112,168,56
TR 36,193,49152
MA 116,172,56
TR 38,193,57344
MA 176,40,56
    buffer_load_dwordx4 a[80:83], v8, s[8:11], s45 offen offset:0 sc1
MA 180,44,56
LW 4
MA 120,168,60
TR 40,194,49152
MA 124,172,60
TR 42,194,57344
MA 184,40,60
    buffer_load_dwordx4 a[84:87], v8, s[8:11], s45 offen offset:1024 sc1
MA 188,44,60
LW 4
MA 64,176,32
TR 44,195,49152
MA 68,180,32
TR 46,195,57344
MA 128,48,32
    buffer_load_dwordx4 a[216:219], v7, s[8:11], s45 offen offset:2048 sc1
MA 132,52,32
LW 4
MA 72,176,36
TR 48,196,49152
MA 76,180,36
TR 50,196,57344
MA 136,48,36
    buffer_load_dwordx4 a[220:223], v7, s[8:11], s45 offen offset:3072 sc1
MA 140,52,36
LW 4
MA 80,176,40
TR 52,197,49152
MA 84,180,40
TR 54,197,57344
MA 144,48,40
    buffer_load_dwordx4 a[88:91], v8, s[8:11], s45 offen offset:2048 sc1
MA 148,52,40
LW 4
MA 88,176,44
TR 56,198,49152
MA 92,180,44
TR 58,198,57344
MA 152,48,44
    buffer_load_dwordx4 a[92:95], v8, s[8:11], s45 offen offset:3072 sc1
MA 156,52,44
LW 4
MA 96,176,48
TR 60,199,49152
    s_add_u32 m0, s38, 98304
MA 100,180,48
TR 62,199,57344
    s_mov_b32 s44, 2752512
MA 160,48,48
    buffer_load_dwordx4 v9, s[4:7], s44 offen offset:0 lds
MA 164,52,48
LW 4
MA 104,176,52
TR 32,192,53248
MA 108,180,52
TR 34,192,61440
MA 168,48,52
    buffer_load_dwordx4 v10, s[4:7], s44 offen offset:1024 lds
MA 172,52,52
LW 4
MA 112,176,56
TR 36,193,53248
MA 116,180,56
TR 38,193,61440
MA 176,48,56
    buffer_load_dwordx4 v11, s[4:7], s44 offen offset:2048 lds
MA 180,52,56
LW 4
MA 120,176,60
TR 40,194,53248
MA 124,180,60
TR 42,194,61440
MA 184,48,60
    buffer_load_dwordx4 v12, s[4:7], s44 offen offset:3072 lds
MA 188,52,60
LW 4
MA 64,184,32
TR 44,195,53248
    s_add_u32 m0, s38, 114688
MA 68,188,32
TR 46,195,61440
    s_mov_b32 s44, 3211264
MA 128,56,32
    buffer_load_dwordx4 v9, s[4:7], s44 offen offset:0 lds
MA 132,60,32
LW 4
MA 72,184,36
TR 48,196,53248
MA 76,188,36
TR 50,196,61440
MA 136,56,36
    buffer_load_dwordx4 v10, s[4:7], s44 offen offset:1024 lds
MA 140,60,36
LW 4
MA 80,184,40
TR 52,197,53248
MA 84,188,40
TR 54,197,61440
MA 144,56,40
    buffer_load_dwordx4 v11, s[4:7], s44 offen offset:2048 lds
MA 148,60,40
LW 4
MA 88,184,44
TR 56,198,53248
MA 92,188,44
TR 58,198,61440
MA 152,56,44
    buffer_load_dwordx4 v12, s[4:7], s44 offen offset:3072 lds
MA 156,60,44
    s_waitcnt vmcnt(14)
    v_cmp_ne_u64 vcc, s[56:57], v[26:27]
    s_nop 1
    s_cmp_lg_u64 vcc, 0
    s_cbranch_scc1 L_miss24
L_back24:
LW 4
MA 96,184,48
TR 60,199,53248
    s_mov_b32 s45, 24576
MA 100,188,48
TR 62,199,61440
MA 160,56,48
    buffer_load_dwordx4 a[224:227], v7, s[8:11], s45 offen offset:0 sc1
MA 164,60,48
LW 4
MA 104,184,52
    s_barrier
TR 32,200,0
MA 108,188,52
TR 34,200,8192
MA 168,56,52
    buffer_load_dwordx4 a[228:231], v7, s[8:11], s45 offen offset:1024 sc1
MA 172,60,52
LW 4
MA 112,184,56
TR 36,201,0
MA 116,188,56
TR 38,201,8192
MA 176,56,56
    buffer_load_dwordx4 a[96:99], v8, s[8:11], s45 offen offset:0 sc1
MA 180,60,56
LW 4
MA 120,184,60
TR 40,202,0
MA 124,188,60
TR 42,202,8192
MA 184,56,60
    buffer_load_dwordx4 a[100:103], v8, s[8:11], s45 offen offset:1024 sc1
MA 188,60,60
LW 4
MA 64,192,32
TR 44,203,0
MA 68,196,32
TR 46,203,8192
MA 128,64,32
    buffer_load_dwordx4 a[232:235], v7, s[8:11], s45 offen offset:2048 sc1
MA 132,68,32
LW 4
MA 72,192,36
TR 48,204,0
MA 76,196,36
TR 50,204,8192
MA 136,64,36
    buffer_load_dwordx4 a[236:239], v7, s[8:11], s45 offen offset:3072 sc1
MA 140,68,36
LW 4
MA 80,192,40
TR 52,205,0
MA 84,196,40
TR 54,205,8192
MA 144,64,40
    buffer_load_dwordx4 a[104:107], v8, s[8:11], s45 offen offset:2048 sc1
MA 148,68,40
LW 4
MA 88,192,44
TR 56,206,0
MA 92,196,44
TR 58,206,8192
MA 152,64,44
    buffer_load_dwordx4 a[108:111], v8, s[8:11], s45 offen offset:3072 sc1
MA 156,68,44
LW 4
MA 96,192,48
TR 60,207,0
    s_mov_b32 s45, 28672
MA 100,196,48
TR 62,207,8192
MA 160,64,48
    buffer_load_dwordx4 a[240:243], v7, s[8:11], s45 offen offset:0 sc1
MA 164,68,48
LW 4
MA 104,192,52
TR 32,200,4096
MA 108,196,52
TR 34,200,12288
MA 168,64,52
    buffer_load_dwordx4 a[244:247], v7, s[8:11], s45 offen offset:1024 sc1
MA 172,68,52
LW 4
MA 112,192,56
TR 36,201,4096
MA 116,196,56
TR 38,201,12288
MA 176,64,56
    buffer_load_dwordx4 a[112:115], v8, s[8:11], s45 offen offset:0 sc1
MA 180,68,56
LW 4
MA 120,192,60
TR 40,202,4096
MA 124,196,60
TR 42,202,12288
MA 184,64,60
    buffer_load_dwordx4 a[116:119], v8, s[8:11], s45 offen offset:1024 sc1
MA 188,68,60
LW 4
MA 64,200,32
TR 44,203,4096
MA 68,204,32
TR 46,203,12288
MA 128,72,32
    buffer_load_dwordx4 a[248:251], v7, s[8:11], s45 offen offset:2048 sc1
MA 132,76,32
LW 4
MA 72,200,36
TR 48,204,4096
MA 76,204,36
TR 50,204,12288
MA 136,72,36
    buffer_load_dwordx4 a[252:255], v7, s[8:11], s45 offen offset:3072 sc1
MA 140,76,36
LW 4
MA 80,200,40
TR 52,205,4096
MA 84,204,40
TR 54,205,12288
MA 144,72,40
    buffer_load_dwordx4 a[120:123], v8, s[8:11], s45 offen offset:2048 sc1
MA 148,76,40
LW 4
MA 88,200,44
TR 56,206,4096
MA 92,204,44
TR 58,206,12288
MA 152,72,44
    buffer_load_dwordx4 a[124:127], v8, s[8:11], s45 offen offset:3072 sc1
MA 156,76,44
LW 4
MA 96,200,48
TR 60,207,4096
    s_add_u32 m0, s38, 131072
MA 100,204,48
TR 62,207,12288
    s_mov_b32 s44, 3670016
MA 160,72,48
    buffer_load_dwordx4 v9, s[4:7], s44 offen offset:0 lds
MA 164,76,48
LW 4
MA 104,200,52
    s_waitcnt vmcnt(25)
    s_barrier
TR 32,200,16384
MA 108,204,52
TR 34,200,24576
MA 168,72,52
    buffer_load_dwordx4 v10, s[4:7], s44 offen offset:1024 lds
MA 172,76,52
LW 4
MA 112,200,56
TR 36,201,16384
MA 116,204,56
TR 38,201,24576
MA 176,72,56
    buffer_load_dwordx4 v11, s[4:7], s44 offen offset:2048 lds
MA 180,76,56
LW 4
MA 120,200,60
TR 40,202,16384
MA 124,204,60
TR 42,202,24576
MA 184,72,60
    buffer_load_dwordx4 v12, s[4:7], s44 offen offset:3072 lds
MA 188,76,60
LW 4
MA 64,208,32
TR 44,203,16384
    s_add_u32 m0, s38, 147456
MA 68,212,32
TR 46,203,24576
    s_mov_b32 s44, 4128768
MA 128,80,32
    buffer_load_dwordx4 v9, s[4:7], s44 offen offset:0 lds
MA 132,84,32
LW 4
MA 72,208,36
TR 48,204,16384
MA 76,212,36
TR 50,204,24576
MA 136,80,36
    buffer_load_dwordx4 v10, s[4:7], s44 offen offset:1024 lds
MA 140,84,36
LW 4
MA 80,208,40
TR 52,205,16384
MA 84,212,40
TR 54,205,24576
MA 144,80,40
    buffer_load_dwordx4 v11, s[4:7], s44 offen offset:2048 lds
MA 148,84,40
LW 4
MA 88,208,44
TR 56,206,16384
MA 92,212,44
TR 58,206,24576
MA 152,80,44
    buffer_load_dwordx4 v12, s[4:7], s44 offen offset:3072 lds
MA 156,84,44
LW 4
MA 96,208,48
TR 60,207,16384
    s_mov_b32 s45, 32768
MA 100,212,48
TR 62,207,24576
MA 160,80,48
    buffer_load_dwordx4 a[128:131], v7, s[8:11], s45 offen offset:0 sc1
MA 164,84,48
LW 4
MA 104,208,52
TR 32,200,20480
MA 108,212,52
TR 34,200,28672
MA 168,80,52
    buffer_load_dwordx4 a[132:135], v7, s[8:11], s45 offen offset:1024 sc1
MA 172,84,52
LW 4
MA 112,208,56
TR 36,201,20480
MA 116,212,56
TR 38,201,28672
MA 176,80,56
    buffer_load_dwordx4 a[0:3], v8, s[8:11], s45 offen offset:0 sc1
MA 180,84,56
LW 4
MA 120,208,60
TR 40,202,20480
MA 124,212,60
TR 42,202,28672
MA 184,80,60
    buffer_load_dwordx4 a[4:7], v8, s[8:11], s45 offen offset:1024 sc1
MA 188,84,60
LW 4
MA 64,216,32
TR 44,203,20480
MA 68,220,32
TR 46,203,28672
MA 128,88,32
    buffer_load_dwordx4 a[136:139], v7, s[8:11], s45 offen offset:2048 sc1
MA 132,92,32
LW 4
MA 72,216,36
TR 48,204,20480
MA 76,220,36
TR 50,204,28672
MA 136,88,36
    buffer_load_dwordx4 a[140:143], v7, s[8:11], s45 offen offset:3072 sc1
MA 140,92,36
LW 4
MA 80,216,40
TR 52,205,20480
MA 84,220,40
TR 54,205,28672
MA 144,88,40
    buffer_load_dwordx4 a[8:11], v8, s[8:11], s45 offen offset:2048 sc1
MA 148,92,40
LW 4
MA 88,216,44
TR 56,206,20480
MA 92,220,44
TR 58,206,28672
MA 152,88,44
    buffer_load_dwordx4 a[12:15], v8, s[8:11], s45 offen offset:3072 sc1
MA 156,92,44
LW 4
MA 96,216,48
TR 60,207,20480
    s_mov_b32 s45, 36864
MA 100,220,48
TR 62,207,28672
MA 160,88,48
    buffer_load_dwordx4 a[144:147], v7, s[8:11], s45 offen offset:0 sc1
MA 164,92,48
LW 4
MA 104,216,52
    s_waitcnt vmcnt(25)
    s_barrier
TR 32,200,32768
MA 108,220,52
TR 34,200,40960
MA 168,88,52
    buffer_load_dwordx4 a[148:151], v7, s[8:11], s45 offen offset:1024 sc1
MA 172,92,52
LW 4
MA 112,216,56
TR 36,201,32768
MA 116,220,56
TR 38,201,40960
MA 176,88,56
    buffer_load_dwordx4 a[16:19], v8, s[8:11], s45 offen offset:0 sc1
MA 180,92,56
LW 4
MA 120,216,60
TR 40,202,32768
MA 124,220,60
TR 42,202,40960
MA 184,88,60
    buffer_load_dwordx4 a[20:23], v8, s[8:11], s45 offen offset:1024 sc1
MA 188,92,60
LW 4
MA 64,224,32
TR 44,203,32768
MA 68,228,32
TR 46,203,40960
MA 128,96,32
    buffer_load_dwordx4 a[152:155], v7, s[8:11], s45 offen offset:2048 sc1
MA 132,100,32
LW 4
MA 72,224,36
TR 48,204,32768
MA 76,228,36
TR 50,204,40960
MA 136,96,36
    buffer_load_dwordx4 a[156:159], v7, s[8:11], s45 offen offset:3072 sc1
MA 140,100,36
LW 4
MA 80,224,40
TR 52,205,32768
MA 84,228,40
TR 54,205,40960
MA 144,96,40
    buffer_load_dwordx4 a[24:27], v8, s[8:11], s45 offen offset:2048 sc1
MA 148,100,40
LW 4
MA 88,224,44
TR 56,206,32768
MA 92,228,44
TR 58,206,40960
MA 152,96,44
    buffer_load_dwordx4 a[28:31], v8, s[8:11], s45 offen offset:3072 sc1
MA 156,100,44
LW 4
MA 96,224,48
TR 60,207,32768
    s_add_u32 m0, s38, 0
MA 100,228,48
TR 62,207,40960
    s_mov_b32 s44, 5505024
MA 160,96,48
    buffer_load_dwordx4 v9, s[4:7], s44 offen offset:0 lds
MA 164,100,48
LW 4
MA 104,224,52
TR 32,200,36864
MA 108,228,52
TR 34,200,45056
MA 168,96,52
    buffer_load_dwordx4 v10, s[4:7], s44 offen offset:1024 lds
MA 172,100,52
LW 4
MA 112,224,56
TR 36,201,36864
MA 116,228,56
TR 38,201,45056
MA 176,96,56
    buffer_load_dwordx4 v11, s[4:7], s44 offen offset:2048 lds
MA 180,100,56
LW 4
MA 120,224,60
TR 40,202,36864
MA 124,228,60
TR 42,202,45056
MA 184,96,60
    buffer_load_dwordx4 v12, s[4:7], s44 offen offset:3072 lds
MA 188,100,60
LW 4
MA 64,232,32
TR 44,203,36864
    s_add_u32 m0, s38, 16384
MA 68,236,32
TR 46,203,45056
    s_mov_b32 s44, 5963776
MA 128,104,32
    buffer_load_dwordx4 v9, s[4:7], s44 offen offset:0 lds
MA 132,108,32
LW 4
MA 72,232,36
TR 48,204,36864
MA 76,236,36
TR 50,204,45056
MA 136,104,36
    buffer_load_dwordx4 v10, s[4:7], s44 offen offset:1024 lds
MA 140,108,36
LW 4
MA 80,232,40
TR 52,205,36864
MA 84,236,40
TR 54,205,45056
MA 144,104,40
    buffer_load_dwordx4 v11, s[4:7], s44 offen offset:2048 lds
MA 148,108,40
LW 4
MA 88,232,44
TR 56,206,36864
MA 92,236,44
TR 58,206,45056
MA 152,104,44
    buffer_load_dwordx4 v12, s[4:7], s44 offen offset:3072 lds
MA 156,108,44
LW 4
MA 96,232,48
TR 60,207,36864
MA 100,236,48
TR 62,207,45056
MA 160,104,48
MA 164,108,48
LW 4
MA 104,232,52
    s_waitcnt vmcnt(32)
    s_barrier
TR 32,200,49152
MA 108,236,52
TR 34,200,57344
MA 168,104,52
MA 172,108,52
LW 4
MA 112,232,56
TR 36,201,49152
MA 116,236,56
TR 38,201,57344
MA 176,104,56
MA 180,108,56
LW 4
MA 120,232,60
TR 40,202,49152
MA 124,236,60
TR 42,202,57344
MA 184,104,60
MA 188,108,60
LW 4
MA 64,240,32
TR 44,203,49152
MA 68,244,32
TR 46,203,57344
MA 128,112,32
MA 132,116,32
LW 4
MA 72,240,36
TR 48,204,49152
MA 76,244,36
TR 50,204,57344
MA 136,112,36
MA 140,116,36
LW 4
MA 80,240,40
TR 52,205,49152
MA 84,244,40
TR 54,205,57344
MA 144,112,40
MA 148,116,40
LW 4
MA 88,240,44
TR 56,206,49152
MA 92,244,44
TR 58,206,57344
MA 152,112,44
MA 156,116,44
LW 4
MA 96,240,48
TR 60,207,49152
MA 100,244,48
TR 62,207,57344
MA 160,112,48
MA 164,116,48
LW 4
MA 104,240,52
TR 32,200,53248
MA 108,244,52
TR 34,200,61440
MA 168,112,52
MA 172,116,52
LW 4
MA 112,240,56
TR 36,201,53248
MA 116,244,56
TR 38,201,61440
MA 176,112,56
MA 180,116,56
LW 4
MA 120,240,60
TR 40,202,53248
MA 124,244,60
TR 42,202,61440
MA 184,112,60
MA 188,116,60
LW 4
MA 64,248,32
TR 44,203,53248
    s_mov_b32 s45, 49152
MA 68,252,32
TR 46,203,61440
MA 128,120,32
    buffer_load_dwordx4 a[160:163], v7, s[8:11], s45 offen offset:0 sc1
MA 132,124,32
LW 4
MA 72,248,36
TR 48,204,53248
MA 76,252,36
TR 50,204,61440
MA 136,120,36
    buffer_load_dwordx4 a[164:167], v7, s[8:11], s45 offen offset:1024 sc1
MA 140,124,36
LW 4
MA 80,248,40
TR 52,205,53248
MA 84,252,40
TR 54,205,61440
MA 144,120,40
    buffer_load_dwordx4 a[32:35], v8, s[8:11], s45 offen offset:0 sc1
MA 148,124,40
LW 4
MA 88,248,44
TR 56,206,53248
MA 92,252,44
TR 58,206,61440
MA 152,120,44
    buffer_load_dwordx4 a[36:39], v8, s[8:11], s45 offen offset:1024 sc1
MA 156,124,44
LW 4
MA 96,248,48
TR 60,207,53248
MA 100,252,48
TR 62,207,61440
MA 160,120,48
    buffer_load_dwordx4 a[168:171], v7, s[8:11], s45 offen offset:2048 sc1
MA 164,124,48
LW 4
MA 104,248,52
    s_waitcnt vmcnt(21)
    s_barrier
TR 32,208,0
MA 108,252,52
TR 34,208,8192
MA 168,120,52
    buffer_load_dwordx4 a[172:175], v7, s[8:11], s45 offen offset:3072 sc1
MA 172,124,52
LW 4
MA 112,248,56
TR 36,209,0
MA 116,252,56
TR 38,209,8192
MA 176,120,56
    buffer_load_dwordx4 a[40:43], v8, s[8:11], s45 offen offset:2048 sc1
MA 180,124,56
LW 4
MA 120,248,60
TR 40,210,0
MA 124,252,60
TR 42,210,8192
MA 184,120,60
    buffer_load_dwordx4 a[44:47], v8, s[8:11], s45 offen offset:3072 sc1
MA 188,124,60
LW 4
MA 64,128,32
TR 44,211,0
    s_mov_b32 s45, 53248
MA 68,132,32
TR 46,211,8192
MA 128,0,32
    buffer_load_dwordx4 a[176:179], v7, s[8:11], s45 offen offset:0 sc1
MA 132,4,32
LW 4
MA 72,128,36
TR 48,212,0
MA 76,132,36
TR 50,212,8192
MA 136,0,36
    buffer_load_dwordx4 a[180:183], v7, s[8:11], s45 offen offset:1024 sc1
MA 140,4,36
LW 4
MA 80,128,40
TR 52,213,0
MA 84,132,40
TR 54,213,8192
MA 144,0,40
    buffer_load_dwordx4 a[48:51], v8, s[8:11], s45 offen offset:0 sc1
MA 148,4,40
LW 4
MA 88,128,44
TR 56,214,0
MA 92,132,44
TR 58,214,8192
MA 152,0,44
    buffer_load_dwordx4 a[52:55], v8, s[8:11], s45 offen offset:1024 sc1
MA 156,4,44
LW 4
MA 96,128,48
TR 60,215,0
MA 100,132,48
TR 62,215,8192
MA 160,0,48
    buffer_load_dwordx4 a[184:187], v7, s[8:11], s45 offen offset:2048 sc1
MA 164,4,48
LW 4
MA 104,128,52
TR 32,208,4096
MA 108,132,52
TR 34,208,12288
MA 168,0,52
    buffer_load_dwordx4 a[188:191], v7, s[8:11], s45 offen offset:3072 sc1
MA 172,4,52
LW 4
MA 112,128,56
TR 36,209,4096
MA 116,132,56
TR 38,209,12288
MA 176,0,56
    buffer_load_dwordx4 a[56:59], v8, s[8:11], s45 offen offset:2048 sc1
MA 180,4,56
LW 4
MA 120,128,60
TR 40,210,4096
MA 124,132,60
TR 42,210,12288
MA 184,0,60
    buffer_load_dwordx4 a[60:63], v8, s[8:11], s45 offen offset:3072 sc1
MA 188,4,60
LW 4
MA 64,136,32
TR 44,211,4096
    s_add_u32 m0, s38, 32768
MA 68,140,32
TR 46,211,12288
    s_mov_b32 s44, 4587520
MA 128,8,32
    buffer_load_dwordx4 v9, s[4:7], s44 offen offset:0 lds
MA 132,12,32
LW 4
MA 72,136,36
TR 48,212,4096
MA 76,140,36
TR 50,212,12288
MA 136,8,36
    buffer_load_dwordx4 v10, s[4:7], s44 offen offset:1024 lds
MA 140,12,36
LW 4
MA 80,136,40
TR 52,213,4096
MA 84,140,40
TR 54,213,12288
MA 144,8,40
    buffer_load_dwordx4 v11, s[4:7], s44 offen offset:2048 lds
MA 148,12,40
LW 4
MA 88,136,44
TR 56,214,4096
MA 92,140,44
TR 58,214,12288
MA 152,8,44
    buffer_load_dwordx4 v12, s[4:7], s44 offen offset:3072 lds
MA 156,12,44
LW 4
MA 96,136,48
TR 60,215,4096
    s_add_u32 m0, s38, 49152
MA 100,140,48
TR 62,215,12288
    s_mov_b32 s44, 5046272
MA 160,8,48
    buffer_load_dwordx4 v9, s[4:7], s44 offen offset:0 lds
MA 164,12,48
LW 4
MA 104,136,52
    s_waitcnt vmcnt(29)
    s_barrier
TR 32,208,16384
MA 108,140,52
TR 34,208,24576
MA 168,8,52
    buffer_load_dwordx4 v10, s[4:7], s44 offen offset:1024 lds
MA 172,12,52
LW 4
MA 112,136,56
TR 36,209,16384
MA 116,140,56
TR 38,209,24576
MA 176,8,56
    buffer_load_dwordx4 v11, s[4:7], s44 offen offset:2048 lds
MA 180,12,56
LW 4
MA 120,136,60
TR 40,210,16384
MA 124,140,60
TR 42,210,24576
MA 184,8,60
    buffer_load_dwordx4 v12, s[4:7], s44 offen offset:3072 lds
MA 188,12,60
LW 4
MA 64,144,32
TR 44,211,16384
    s_mov_b32 s45, 40960
MA 68,148,32
TR 46,211,24576
MA 128,16,32
    buffer_load_dwordx4 a[192:195], v7, s[8:11], s45 offen offset:0 sc1
MA 132,20,32
LW 4
MA 72,144,36
TR 48,212,16384
MA 76,148,36
TR 50,212,24576
MA 136,16,36
    buffer_load_dwordx4 a[196:199], v7, s[8:11], s45 offen offset:1024 sc1
MA 140,20,36
LW 4
MA 80,144,40
TR 52,213,16384
MA 84,148,40
TR 54,213,24576
MA 144,16,40
    buffer_load_dwordx4 a[64:67], v8, s[8:11], s45 offen offset:0 sc1
MA 148,20,40
LW 4
MA 88,144,44
TR 56,214,16384
MA 92,148,44
TR 58,214,24576
MA 152,16,44
    buffer_load_dwordx4 a[68:71], v8, s[8:11], s45 offen offset:1024 sc1
MA 156,20,44
LW 4
MA 96,144,48
TR 60,215,16384
MA 100,148,48
TR 62,215,24576
MA 160,16,48
    buffer_load_dwordx4 a[200:203], v7, s[8:11], s45 offen offset:2048 sc1
MA 164,20,48
LW 4
MA 104,144,52
TR 32,208,20480
MA 108,148,52
TR 34,208,28672
MA 168,16,52
    buffer_load_dwordx4 a[204:207], v7, s[8:11], s45 offen offset:3072 sc1
MA 172,20,52
LW 4
MA 112,144,56
TR 36,209,20480
MA 116,148,56
TR 38,209,28672
MA 176,16,56
    buffer_load_dwordx4 a[72:75], v8, s[8:11], s45 offen offset:2048 sc1
MA 180,20,56
LW 4
MA 120,144,60
TR 40,210,20480
MA 124,148,60
TR 42,210,28672
MA 184,16,60
    buffer_load_dwordx4 a[76:79], v8, s[8:11], s45 offen offset:3072 sc1
MA 188,20,60
LW 4
MA 64,152,32
TR 44,211,20480
    s_mov_b32 s45, 45056
MA 68,156,32
TR 46,211,28672
MA 128,24,32
    buffer_load_dwordx4 a[208:211], v7, s[8:11], s45 offen offset:0 sc1
MA 132,28,32
LW 4
MA 72,152,36
TR 48,212,20480
MA 76,156,36
TR 50,212,28672
MA 136,24,36
    buffer_load_dwordx4 a[212:215], v7, s[8:11], s45 offen offset:1024 sc1
MA 140,28,36
    buffer_load_dwordx2 v[26:27], v22, s[8:11], 0 offen offset:256 sc1
LW 4
MA 80,152,40
TR 52,213,20480
MA 84,156,40
TR 54,213,28672
MA 144,24,40
    buffer_load_dwordx4 a[80:83], v8, s[8:11], s45 offen offset:0 sc1
MA 148,28,40
LW 4
MA 88,152,44
TR 56,214,20480
MA 92,156,44
TR 58,214,28672
MA 152,24,44
    buffer_load_dwordx4 a[84:87], v8, s[8:11], s45 offen offset:1024 sc1
MA 156,28,44
LW 4
MA 96,152,48
TR 60,215,20480
MA 100,156,48
TR 62,215,28672
MA 160,24,48
    buffer_load_dwordx4 a[216:219], v7, s[8:11], s45 offen offset:2048 sc1
MA 164,28,48
LW 4
MA 104,152,52
    s_waitcnt vmcnt(30)
    s_barrier
TR 32,192,0
MA 108,156,52
TR 34,192,8192
MA 168,24,52
    buffer_load_dwordx4 a[220:223], v7, s[8:11], s45 offen offset:3072 sc1
MA 172,28,52
LW 4
MA 112,152,56
TR 36,193,0
MA 116,156,56
TR 38,193,8192
MA 176,24,56
    buffer_load_dwordx4 a[88:91], v8, s[8:11], s45 offen offset:2048 sc1
MA 180,28,56
LW 4
MA 120,152,60
TR 40,194,0
MA 124,156,60
TR 42,194,8192
MA 184,24,60
    buffer_load_dwordx4 a[92:95], v8, s[8:11], s45 offen offset:3072 sc1
MA 188,28,60
LW 4
MA 64,160,32
TR 44,195,0
    s_add_u32 m0, s38, 65536
MA 68,164,32
TR 46,195,8192
    s_mov_b32 s44, 6422528
MA 128,32,32
    buffer_load_dwordx4 v9, s[4:7], s44 offen offset:0 lds
MA 132,36,32
LW 4
MA 72,160,36
TR 48,196,0
MA 76,164,36
TR 50,196,8192
MA 136,32,36
    buffer_load_dwordx4 v10, s[4:7], s44 offen offset:1024 lds
MA 140,36,36
LW 4
MA 80,160,40
TR 52,197,0
MA 84,164,40
TR 54,197,8192
MA 144,32,40
    buffer_load_dwordx4 v11, s[4:7], s44 offen offset:2048 lds
MA 148,36,40
LW 4
MA 88,160,44
TR 56,198,0
MA 92,164,44
TR 58,198,8192
MA 152,32,44
    buffer_load_dwordx4 v12, s[4:7], s44 offen offset:3072 lds
MA 156,36,44
LW 4
MA 96,160,48
TR 60,199,0
    s_add_u32 m0, s38, 81920
MA 100,164,48
TR 62,199,8192
    s_mov_b32 s44, 6881280
MA 160,32,48
    buffer_load_dwordx4 v9, s[4:7], s44 offen offset:0 lds
MA 164,36,48
LW 4
MA 104,160,52
TR 32,192,4096
MA 108,164,52
TR 34,192,12288
MA 168,32,52
    buffer_load_dwordx4 v10, s[4:7], s44 offen offset:1024 lds
MA 172,36,52
LW 4
MA 112,160,56
TR 36,193,4096
MA 116,164,56
TR 38,193,12288
MA 176,32,56
    buffer_load_dwordx4 v11, s[4:7], s44 offen offset:2048 lds
MA 180,36,56
LW 4
MA 120,160,60
TR 40,194,4096
MA 124,164,60
TR 42,194,12288
MA 184,32,60
    buffer_load_dwordx4 v12, s[4:7], s44 offen offset:3072 lds
MA 188,36,60
    s_waitcnt vmcnt(14)
    v_cmp_ne_u64 vcc, s[56:57], v[26:27]
    s_nop 1
    s_cmp_lg_u64 vcc, 0
    s_cbranch_scc1 L_miss25
L_back25:
LW 4
MA 64,168,32
TR 44,195,4096
    s_mov_b32 s45, 57344
MA 68,172,32
TR 46,195,12288
MA 128,40,32
    buffer_load_dwordx4 a[224:227], v7, s[8:11], s45 offen offset:0 sc1
MA 132,44,32
LW 4
MA 72,168,36
TR 48,196,4096
MA 76,172,36
TR 50,196,12288
MA 136,40,36
    buffer_load_dwordx4 a[228:231], v7, s[8:11], s45 offen offset:1024 sc1
MA 140,44,36
LW 4
MA 80,168,40
TR 52,197,4096
MA 84,172,40
TR 54,197,12288
MA 144,40,40
    buffer_load_dwordx4 a[96:99], v8, s[8:11], s45 offen offset:0 sc1
MA 148,44,40
LW 4
MA 88,168,44
TR 56,198,4096
MA 92,172,44
TR 58,198,12288
MA 152,40,44
    buffer_load_dwordx4 a[100:103], v8, s[8:11], s45 offen offset:1024 sc1
MA 156,44,44
LW 4
MA 96,168,48
TR 60,199,4096
MA 100,172,48
TR 62,199,12288
MA 160,40,48
    buffer_load_dwordx4 a[232:235], v7, s[8:11], s45 offen offset:2048 sc1
MA 164,44,48
LW 4
MA 104,168,52
    s_barrier
TR 32,192,16384
MA 108,172,52
TR 34,192,24576
MA 168,40,52
    buffer_load_dwordx4 a[236:239], v7, s[8:11], s45 offen offset:3072 sc1
MA 172,44,52
LW 4
MA 112,168,56
TR 36,193,16384
MA 116,172,56
TR 38,193,24576
MA 176,40,56
    buffer_load_dwordx4 a[104:107], v8, s[8:11], s45 offen offset:2048 sc1
MA 180,44,56
LW 4
MA 120,168,60
TR 40,194,16384
MA 124,172,60
TR 42,194,24576
MA 184,40,60
    buffer_load_dwordx4 a[108:111], v8, s[8:11], s45 offen offset:3072 sc1
MA 188,44,60
LW 4
MA 64,176,32
TR 44,195,16384
    s_mov_b32 s45, 61440
MA 68,180,32
TR 46,195,24576
MA 128,48,32
    buffer_load_dwordx4 a[240:243], v7, s[8:11], s45 offen offset:0 sc1
MA 132,52,32
LW 4
MA 72,176,36
TR 48,196,16384
MA 76,180,36
TR 50,196,24576
MA 136,48,36
    buffer_load_dwordx4 a[244:247], v7, s[8:11], s45 offen offset:1024 sc1
MA 140,52,36
LW 4
MA 80,176,40
TR 52,197,16384
MA 84,180,40
TR 54,197,24576
MA 144,48,40
    buffer_load_dwordx4 a[112:115], v8, s[8:11], s45 offen offset:0 sc1
MA 148,52,40
LW 4
MA 88,176,44
TR 56,198,16384
MA 92,180,44
TR 58,198,24576
MA 152,48,44
    buffer_load_dwordx4 a[116:119], v8, s[8:11], s45 offen offset:1024 sc1
MA 156,52,44
LW 4
MA 96,176,48
TR 60,199,16384
MA 100,180,48
TR 62,199,24576
MA 160,48,48
    buffer_load_dwordx4 a[248:251], v7, s[8:11], s45 offen offset:2048 sc1
MA 164,52,48
LW 4
MA 104,176,52
TR 32,192,20480
MA 108,180,52
TR 34,192,28672
MA 168,48,52
    buffer_load_dwordx4 a[252:255], v7, s[8:11], s45 offen offset:3072 sc1
MA 172,52,52
LW 4
MA 112,176,56
TR 36,193,20480
MA 116,180,56
TR 38,193,28672
MA 176,48,56
    buffer_load_dwordx4 a[120:123], v8, s[8:11], s45 offen offset:2048 sc1
MA 180,52,56
LW 4
MA 120,176,60
TR 40,194,20480
MA 124,180,60
TR 42,194,28672
MA 184,48,60
    buffer_load_dwordx4 a[124:127], v8, s[8:11], s45 offen offset:3072 sc1
MA 188,52,60
LW 4
MA 64,184,32
TR 44,195,20480
    s_add_u32 m0, s38, 98304
MA 68,188,32
TR 46,195,28672
    s_mov_b32 s44, 7340032
MA 128,56,32
    buffer_load_dwordx4 v9, s[4:7], s44 offen offset:0 lds
MA 132,60,32
LW 4
MA 72,184,36
TR 48,196,20480
MA 76,188,36
TR 50,196,28672
MA 136,56,36
    buffer_load_dwordx4 v10, s[4:7], s44 offen offset:1024 lds
MA 140,60,36
LW 4
MA 80,184,40
TR 52,197,20480
MA 84,188,40
TR 54,197,28672
MA 144,56,40
    buffer_load_dwordx4 v11, s[4:7], s44 offen offset:2048 lds
MA 148,60,40
LW 4
MA 88,184,44
TR 56,198,20480
MA 92,188,44
TR 58,198,28672
MA 152,56,44
    buffer_load_dwordx4 v12, s[4:7], s44 offen offset:3072 lds
MA 156,60,44
LW 4
MA 96,184,48
TR 60,199,20480
    s_add_u32 m0, s38, 114688
MA 100,188,48
TR 62,199,28672
    s_mov_b32 s44, 7798784
MA 160,56,48
    buffer_load_dwordx4 v9, s[4:7], s44 offen offset:0 lds
MA 164,60,48
LW 4
MA 104,184,52
    s_barrier
TR 32,192,32768
MA 108,188,52
TR 34,192,40960
MA 168,56,52
    buffer_load_dwordx4 v10, s[4:7], s44 offen offset:1024 lds
MA 172,60,52
LW 4
MA 112,184,56
TR 36,193,32768
MA 116,188,56
TR 38,193,40960
MA 176,56,56
    buffer_load_dwordx4 v11, s[4:7], s44 offen offset:2048 lds
MA 180,60,56
LW 4
MA 120,184,60
TR 40,194,32768
MA 124,188,60
TR 42,194,40960
MA 184,56,60
    buffer_load_dwordx4 v12, s[4:7], s44 offen offset:3072 lds
MA 188,60,60
LW 4
MA 64,192,32
TR 44,195,32768
    s_mov_b32 s45, 65536
MA 68,196,32
TR 46,195,40960
MA 128,64,32
    buffer_load_dwordx4 a[128:131], v7, s[8:11], s45 offen offset:0 sc1
MA 132,68,32
LW 4
MA 72,192,36
TR 48,196,32768
MA 76,196,36
TR 50,196,40960
MA 136,64,36
    buffer_load_dwordx4 a[132:135], v7, s[8:11], s45 offen offset:1024 sc1
MA 140,68,36
LW 4
MA 80,192,40
TR 52,197,32768
MA 84,196,40
TR 54,197,40960
MA 144,64,40
    buffer_load_dwordx4 a[0:3], v8, s[8:11], s45 offen offset:0 sc1
MA 148,68,40
LW 4
MA 88,192,44
TR 56,198,32768
MA 92,196,44
TR 58,198,40960
MA 152,64,44
    buffer_load_dwordx4 a[4:7], v8, s[8:11], s45 offen offset:1024 sc1
MA 156,68,44
LW 4
MA 96,192,48
TR 60,199,32768
MA 100,196,48
TR 62,199,40960
MA 160,64,48
    buffer_load_dwordx4 a[136:139], v7, s[8:11], s45 offen offset:2048 sc1
MA 164,68,48
LW 4
MA 104,192,52
TR 32,192,36864
MA 108,196,52
TR 34,192,45056
MA 168,64,52
    buffer_load_dwordx4 a[140:143], v7, s[8:11], s45 offen offset:3072 sc1
MA 172,68,52
LW 4
MA 112,192,56
TR 36,193,36864
MA 116,196,56
TR 38,193,45056
MA 176,64,56
    buffer_load_dwordx4 a[8:11], v8, s[8:11], s45 offen offset:2048 sc1
MA 180,68,56
LW 4
MA 120,192,60
TR 40,194,36864
MA 124,196,60
TR 42,194,45056
MA 184,64,60
    buffer_load_dwordx4 a[12:15], v8, s[8:11], s45 offen offset:3072 sc1
MA 188,68,60
LW 4
MA 64,200,32
TR 44,195,36864
    s_mov_b32 s45, 69632
MA 68,204,32
TR 46,195,45056
MA 128,72,32
    buffer_load_dwordx4 a[144:147], v7, s[8:11], s45 offen offset:0 sc1
MA 132,76,32
LW 4
MA 72,200,36
TR 48,196,36864
MA 76,204,36
TR 50,196,45056
MA 136,72,36
    buffer_load_dwordx4 a[148:151], v7, s[8:11], s45 offen offset:1024 sc1
MA 140,76,36
LW 4
MA 80,200,40
TR 52,197,36864
MA 84,204,40
TR 54,197,45056
MA 144,72,40
    buffer_load_dwordx4 a[16:19], v8, s[8:11], s45 offen offset:0 sc1
MA 148,76,40
LW 4
MA 88,200,44
TR 56,198,36864
MA 92,204,44
TR 58,198,45056
MA 152,72,44
    buffer_load_dwordx4 a[20:23], v8, s[8:11], s45 offen offset:1024 sc1
MA 156,76,44
LW 4
MA 96,200,48
TR 60,199,36864
MA 100,204,48
TR 62,199,45056
MA 160,72,48
    buffer_load_dwordx4 a[152:155], v7, s[8:11], s45 offen offset:2048 sc1
MA 164,76,48
LW 4
MA 104,200,52
    s_waitcnt vmcnt(45)
    s_barrier
TR 32,192,49152
MA 108,204,52
TR 34,192,57344
MA 168,72,52
    buffer_load_dwordx4 a[156:159], v7, s[8:11], s45 offen offset:3072 sc1
MA 172,76,52
LW 4
MA 112,200,56
TR 36,193,49152
MA 116,204,56
TR 38,193,57344
MA 176,72,56
    buffer_load_dwordx4 a[24:27], v8, s[8:11], s45 offen offset:2048 sc1
MA 180,76,56
LW 4
MA 120,200,60
TR 40,194,49152
MA 124,204,60
TR 42,194,57344
MA 184,72,60
    buffer_load_dwordx4 a[28:31], v8, s[8:11], s45 offen offset:3072 sc1
MA 188,76,60
LW 4
MA 64,208,32
TR 44,195,49152
    s_add_u32 m0, s38, 131072
MA 68,212,32
TR 46,195,57344
    s_mov_b32 s44, 9175040
MA 128,80,32
    buffer_load_dwordx4 v9, s[4:7], s44 offen offset:0 lds
MA 132,84,32
LW 4
MA 72,208,36
TR 48,196,49152
MA 76,212,36
TR 50,196,57344
MA 136,80,36
    buffer_load_dwordx4 v10, s[4:7], s44 offen offset:1024 lds
MA 140,84,36
LW 4
MA 80,208,40
TR 52,197,49152
MA 84,212,40
TR 54,197,57344
MA 144,80,40
    buffer_load_dwordx4 v11, s[4:7], s44 offen offset:2048 lds
MA 148,84,40
LW 4
MA 88,208,44
TR 56,198,49152
MA 92,212,44
TR 58,198,57344
MA 152,80,44
    buffer_load_dwordx4 v12, s[4:7], s44 offen offset:3072 lds
MA 156,84,44
LW 4
MA 96,208,48
TR 60,199,49152
    s_add_u32 m0, s38, 147456
MA 100,212,48
TR 62,199,57344
    s_mov_b32 s44, 9633792
MA 160,80,48
    buffer_load_dwordx4 v9, s[4:7], s44 offen offset:0 lds
MA 164,84,48
LW 4
MA 104,208,52
TR 32,192,53248
MA 108,212,52
TR 34,192,61440
MA 168,80,52
    buffer_load_dwordx4 v10, s[4:7], s44 offen offset:1024 lds
MA 172,84,52
LW 4
MA 112,208,56
TR 36,193,53248
MA 116,212,56
TR 38,193,61440
MA 176,80,56
    buffer_load_dwordx4 v11, s[4:7], s44 offen offset:2048 lds
MA 180,84,56
LW 4
MA 120,208,60
TR 40,194,53248
MA 124,212,60
TR 42,194,61440
MA 184,80,60
    buffer_load_dwordx4 v12, s[4:7], s44 offen offset:3072 lds
MA 188,84,60
LW 4
MA 64,216,32
TR 44,195,53248
MA 68,220,32
TR 46,195,61440
MA 128,88,32
MA 132,92,32
LW 4
MA 72,216,36
TR 48,196,53248
MA 76,220,36
TR 50,196,61440
MA 136,88,36
MA 140,92,36
LW 4
MA 80,216,40
TR 52,197,53248
MA 84,220,40
TR 54,197,61440
MA 144,88,40
MA 148,92,40
LW 4
MA 88,216,44
TR 56,198,53248
MA 92,220,44
TR 58,198,61440
MA 152,88,44
MA 156,92,44
LW 4
MA 96,216,48
TR 60,199,53248
MA 100,220,48
TR 62,199,61440
MA 160,88,48
MA 164,92,48
LW 4
MA 104,216,52
    s_waitcnt vmcnt(40)
    s_barrier
TR 32,200,0
MA 108,220,52
TR 34,200,8192
MA 168,88,52
MA 172,92,52
LW 4
MA 112,216,56
TR 36,201,0
MA 116,220,56
TR 38,201,8192
MA 176,88,56
MA 180,92,56
LW 4
MA 120,216,60
TR 40,202,0
MA 124,220,60
TR 42,202,8192
MA 184,88,60
MA 188,92,60
LW 4
MA 64,224,32
TR 44,203,0
MA 68,228,32
TR 46,203,8192
MA 128,96,32
MA 132,100,32
LW 4
MA 72,224,36
TR 48,204,0
MA 76,228,36
TR 50,204,8192
MA 136,96,36
MA 140,100,36
LW 4
MA 80,224,40
TR 52,205,0
MA 84,228,40
TR 54,205,8192
MA 144,96,40
MA 148,100,40
LW 4
MA 88,224,44
TR 56,206,0
MA 92,228,44
TR 58,206,8192
MA 152,96,44
MA 156,100,44
LW 4
MA 96,224,48
TR 60,207,0
    s_mov_b32 s45, 81920
MA 100,228,48
TR 62,207,8192
MA 160,96,48
    buffer_load_dwordx4 a[160:163], v7, s[8:11], s45 offen offset:0 sc1
MA 164,100,48
LW 4
MA 104,224,52
TR 32,200,4096
MA 108,228,52
TR 34,200,12288
MA 168,96,52
    buffer_load_dwordx4 a[164:167], v7, s[8:11], s45 offen offset:1024 sc1
MA 172,100,52
LW 4
MA 112,224,56
TR 36,201,4096
MA 116,228,56
TR 38,201,12288
MA 176,96,56
    buffer_load_dwordx4 a[32:35], v8, s[8:11], s45 offen offset:0 sc1
MA 180,100,56
LW 4
MA 120,224,60
TR 40,202,4096
MA 124,228,60
TR 42,202,12288
MA 184,96,60
    buffer_load_dwordx4 a[36:39], v8, s[8:11], s45 offen offset:1024 sc1
MA 188,100,60
LW 4
MA 64,232,32
TR 44,203,4096
MA 68,236,32
TR 46,203,12288
MA 128,104,32
    buffer_load_dwordx4 a[168:171], v7, s[8:11], s45 offen offset:2048 sc1
MA 132,108,32
LW 4
MA 72,232,36
TR 48,204,4096
MA 76,236,36
TR 50,204,12288
MA 136,104,36
    buffer_load_dwordx4 a[172:175], v7, s[8:11], s45 offen offset:3072 sc1
MA 140,108,36
LW 4
MA 80,232,40
TR 52,205,4096
MA 84,236,40
TR 54,205,12288
MA 144,104,40
    buffer_load_dwordx4 a[40:43], v8, s[8:11], s45 offen offset:2048 sc1
MA 148,108,40
LW 4
MA 88,232,44
TR 56,206,4096
MA 92,236,44
TR 58,206,12288
MA 152,104,44
    buffer_load_dwordx4 a[44:47], v8, s[8:11], s45 offen offset:3072 sc1
MA 156,108,44
LW 4
MA 96,232,48
TR 60,207,4096
    s_mov_b32 s45, 86016
MA 100,236,48
TR 62,207,12288
MA 160,104,48
    buffer_load_dwordx4 a[176:179], v7, s[8:11], s45 offen offset:0 sc1
MA 164,108,48
LW 4
MA 104,232,52
    s_waitcnt vmcnt(41)
    s_barrier
TR 32,200,16384
MA 108,236,52
TR 34,200,24576
MA 168,104,52
    buffer_load_dwordx4 a[180:183], v7, s[8:11], s45 offen offset:1024 sc1
MA 172,108,52
LW 4
MA 112,232,56
TR 36,201,16384
MA 116,236,56
TR 38,201,24576
MA 176,104,56
    buffer_load_dwordx4 a[48:51], v8, s[8:11], s45 offen offset:0 sc1
MA 180,108,56
LW 4
MA 120,232,60
TR 40,202,16384
MA 124,236,60
TR 42,202,24576
MA 184,104,60
    buffer_load_dwordx4 a[52:55], v8, s[8:11], s45 offen offset:1024 sc1
MA 188,108,60
LW 4
MA 64,240,32
TR 44,203,16384
MA 68,244,32
TR 46,203,24576
MA 128,112,32
    buffer_load_dwordx4 a[184:187], v7, s[8:11], s45 offen offset:2048 sc1
MA 132,116,32
LW 4
MA 72,240,36
TR 48,204,16384
MA 76,244,36
TR 50,204,24576
MA 136,112,36
    buffer_load_dwordx4 a[188:191], v7, s[8:11], s45 offen offset:3072 sc1
MA 140,116,36
LW 4
MA 80,240,40
TR 52,205,16384
MA 84,244,40
TR 54,205,24576
MA 144,112,40
    buffer_load_dwordx4 a[56:59], v8, s[8:11], s45 offen offset:2048 sc1
MA 148,116,40
LW 4
MA 88,240,44
TR 56,206,16384
MA 92,244,44
TR 58,206,24576
MA 152,112,44
    buffer_load_dwordx4 a[60:63], v8, s[8:11], s45 offen offset:3072 sc1
MA 156,116,44
LW 4
MA 96,240,48
TR 60,207,16384
    s_add_u32 m0, s38, 0
MA 100,244,48
TR 62,207,24576
    s_mov_b32 s44, 8257536
MA 160,112,48
    buffer_load_dwordx4 v9, s[4:7], s44 offen offset:0 lds
MA 164,116,48
LW 4
MA 104,240,52
TR 32,200,20480
MA 108,244,52
TR 34,200,28672
MA 168,112,52
    buffer_load_dwordx4 v10, s[4:7], s44 offen offset:1024 lds
MA 172,116,52
LW 4
MA 112,240,56
TR 36,201,20480
MA 116,244,56
TR 38,201,28672
MA 176,112,56
    buffer_load_dwordx4 v11, s[4:7], s44 offen offset:2048 lds
MA 180,116,56
LW 4
MA 120,240,60
TR 40,202,20480
MA 124,244,60
TR 42,202,28672
MA 184,112,60
    buffer_load_dwordx4 v12, s[4:7], s44 offen offset:3072 lds
MA 188,116,60
LW 4
MA 64,248,32
TR 44,203,20480
    s_add_u32 m0, s38, 16384
MA 68,252,32
TR 46,203,28672
    s_mov_b32 s44, 8716288
MA 128,120,32
    buffer_load_dwordx4 v9, s[4:7], s44 offen offset:0 lds
MA 132,124,32
LW 4
MA 72,248,36
TR 48,204,20480
MA 76,252,36
TR 50,204,28672
MA 136,120,36
    buffer_load_dwordx4 v10, s[4:7], s44 offen offset:1024 lds
MA 140,124,36
LW 4
MA 80,248,40
TR 52,205,20480
MA 84,252,40
TR 54,205,28672
MA 144,120,40
    buffer_load_dwordx4 v11, s[4:7], s44 offen offset:2048 lds
MA 148,124,40
LW 4
MA 88,248,44
TR 56,206,20480
MA 92,252,44
TR 58,206,28672
MA 152,120,44
    buffer_load_dwordx4 v12, s[4:7], s44 offen offset:3072 lds
MA 156,124,44
LW 4
MA 96,248,48
TR 60,207,20480
    s_mov_b32 s45, 73728
MA 100,252,48
TR 62,207,28672
MA 160,120,48
    buffer_load_dwordx4 a[64:67], v8, s[8:11], s45 offen offset:0 sc1
MA 164,124,48
LW 4
MA 104,248,52
    s_waitcnt vmcnt(41)
    s_barrier
TR 32,200,32768
MA 108,252,52
TR 34,200,40960
MA 168,120,52
    buffer_load_dwordx4 a[68:71], v8, s[8:11], s45 offen offset:1024 sc1
MA 172,124,52
LW 4
MA 112,248,56
TR 36,201,32768
MA 116,252,56
TR 38,201,40960
MA 176,120,56
    buffer_load_dwordx4 a[72:75], v8, s[8:11], s45 offen offset:2048 sc1
MA 180,124,56
LW 4
MA 120,248,60
TR 40,202,32768
MA 124,252,60
TR 42,202,40960
MA 184,120,60
    buffer_load_dwordx4 a[76:79], v8, s[8:11], s45 offen offset:3072 sc1
MA 188,124,60
LW 4
MA 64,128,32
TR 44,203,32768
    s_mov_b32 s45, 77824
MA 68,132,32
TR 46,203,40960
MA 128,0,32
    buffer_load_dwordx4 a[80:83], v8, s[8:11], s45 offen offset:0 sc1
MA 132,4,32
LW 4
MA 72,128,36
TR 48,204,32768
MA 76,132,36
TR 50,204,40960
MA 136,0,36
    buffer_load_dwordx4 a[84:87], v8, s[8:11], s45 offen offset:1024 sc1
MA 140,4,36
LW 4
MA 80,128,40
TR 52,205,32768
MA 84,132,40
TR 54,205,40960
MA 144,0,40
    buffer_load_dwordx4 a[88:91], v8, s[8:11], s45 offen offset:2048 sc1
MA 148,4,40
LW 4
MA 88,128,44
TR 56,206,32768
MA 92,132,44
TR 58,206,40960
MA 152,0,44
    buffer_load_dwordx4 a[92:95], v8, s[8:11], s45 offen offset:3072 sc1
MA 156,4,44
LW 4
MA 96,128,48
TR 60,207,32768
    s_add_u32 m0, s38, 32768
MA 100,132,48
TR 62,207,40960
    s_mov_b32 s44, 10092544
MA 160,0,48
    buffer_load_dwordx4 v9, s[4:7], s44 offen offset:0 lds
MA 164,4,48
LW 4
MA 104,128,52
TR 32,200,36864
MA 108,132,52
TR 34,200,45056
MA 168,0,52
    buffer_load_dwordx4 v10, s[4:7], s44 offen offset:1024 lds
MA 172,4,52
LW 4
MA 112,128,56
TR 36,201,36864
MA 116,132,56
TR 38,201,45056
MA 176,0,56
    buffer_load_dwordx4 v11, s[4:7], s44 offen offset:2048 lds
MA 180,4,56
LW 4
MA 120,128,60
TR 40,202,36864
MA 124,132,60
TR 42,202,45056
MA 184,0,60
    buffer_load_dwordx4 v12, s[4:7], s44 offen offset:3072 lds
MA 188,4,60
LW 4
MA 64,136,32
TR 44,203,36864
    s_add_u32 m0, s38, 49152
MA 68,140,32
TR 46,203,45056
    s_mov_b32 s44, 10551296
MA 128,8,32
    buffer_load_dwordx4 v9, s[4:7], s44 offen offset:0 lds
MA 132,12,32
LW 4
MA 72,136,36
TR 48,204,36864
MA 76,140,36
TR 50,204,45056
MA 136,8,36
    buffer_load_dwordx4 v10, s[4:7], s44 offen offset:1024 lds
MA 140,12,36
LW 4
MA 80,136,40
TR 52,205,36864
MA 84,140,40
TR 54,205,45056
MA 144,8,40
    buffer_load_dwordx4 v11, s[4:7], s44 offen offset:2048 lds
MA 148,12,40
LW 4
MA 88,136,44
TR 56,206,36864
MA 92,140,44
TR 58,206,45056
MA 152,8,44
    buffer_load_dwordx4 v12, s[4:7], s44 offen offset:3072 lds
MA 156,12,44
LW 4
MA 96,136,48
TR 60,207,36864
    s_mov_b32 s45, 90112
MA 100,140,48
TR 62,207,45056
MA 160,8,48
    buffer_load_dwordx4 a[96:99], v8, s[8:11], s45 offen offset:0 sc1
MA 164,12,48
LW 4
MA 104,136,52
    s_waitcnt vmcnt(49)
    s_barrier
TR 32,200,49152
MA 108,140,52
TR 34,200,57344
MA 168,8,52
    buffer_load_dwordx4 a[100:103], v8, s[8:11], s45 offen offset:1024 sc1
MA 172,12,52
LW 4
MA 112,136,56
TR 36,201,49152
MA 116,140,56
TR 38,201,57344
MA 176,8,56
    buffer_load_dwordx4 a[104:107], v8, s[8:11], s45 offen offset:2048 sc1
MA 180,12,56
LW 4
MA 120,136,60
TR 40,202,49152
MA 124,140,60
TR 42,202,57344
MA 184,8,60
    buffer_load_dwordx4 a[108:111], v8, s[8:11], s45 offen offset:3072 sc1
MA 188,12,60
LW 4
MA 64,144,32
TR 44,203,49152
    s_mov_b32 s45, 94208
MA 68,148,32
TR 46,203,57344
MA 128,16,32
    buffer_load_dwordx4 a[112:115], v8, s[8:11], s45 offen offset:0 sc1
MA 132,20,32
LW 4
MA 72,144,36
TR 48,204,49152
MA 76,148,36
TR 50,204,57344
MA 136,16,36
    buffer_load_dwordx4 a[116:119], v8, s[8:11], s45 offen offset:1024 sc1
MA 140,20,36
LW 4
MA 80,144,40
TR 52,205,49152
MA 84,148,40
TR 54,205,57344
MA 144,16,40
    buffer_load_dwordx4 a[120:123], v8, s[8:11], s45 offen offset:2048 sc1
MA 148,20,40
LW 4
MA 88,144,44
TR 56,206,49152
MA 92,148,44
TR 58,206,57344
MA 152,16,44
    buffer_load_dwordx4 a[124:127], v8, s[8:11], s45 offen offset:3072 sc1
MA 156,20,44
LW 4
MA 96,144,48
TR 60,207,49152
    s_add_u32 m0, s38, 65536
MA 100,148,48
TR 62,207,57344
    s_mov_b32 s44, 11010048
MA 160,16,48
    buffer_load_dwordx4 v9, s[4:7], s44 offen offset:0 lds
MA 164,20,48
LW 4
MA 104,144,52
TR 32,200,53248
MA 108,148,52
TR 34,200,61440
MA 168,16,52
    buffer_load_dwordx4 v10, s[4:7], s44 offen offset:1024 lds
MA 172,20,52
LW 4
MA 112,144,56
TR 36,201,53248
MA 116,148,56
TR 38,201,61440
MA 176,16,56
    buffer_load_dwordx4 v11, s[4:7], s44 offen offset:2048 lds
MA 180,20,56
LW 4
MA 120,144,60
TR 40,202,53248
MA 124,148,60
TR 42,202,61440
MA 184,16,60
    buffer_load_dwordx4 v12, s[4:7], s44 offen offset:3072 lds
MA 188,20,60
LW 4
MA 64,152,32
TR 44,203,53248
    s_add_u32 m0, s38, 81920
MA 68,156,32
TR 46,203,61440
    s_mov_b32 s44, 11468800
MA 128,24,32
    buffer_load_dwordx4 v9, s[4:7], s44 offen offset:0 lds
MA 132,28,32
LW 4
MA 72,152,36
TR 48,204,53248
MA 76,156,36
TR 50,204,61440
MA 136,24,36
    buffer_load_dwordx4 v10, s[4:7], s44 offen offset:1024 lds
MA 140,28,36
LW 4
MA 80,152,40
TR 52,205,53248
MA 84,156,40
TR 54,205,61440
MA 144,24,40
    buffer_load_dwordx4 v11, s[4:7], s44 offen offset:2048 lds
MA 148,28,40
LW 4
MA 88,152,44
TR 56,206,53248
MA 92,156,44
TR 58,206,61440
MA 152,24,44
    buffer_load_dwordx4 v12, s[4:7], s44 offen offset:3072 lds
MA 156,28,44
LW 4
MA 96,152,48
TR 60,207,53248
    s_mov_b32 s45, 98304
MA 100,156,48
TR 62,207,61440
MA 160,24,48
    buffer_load_dwordx4 a[0:3], v8, s[8:11], s45 offen offset:0 sc1
MA 164,28,48
LW 4
MA 104,152,52
    s_waitcnt vmcnt(49)
    s_barrier
TR 32,208,0
MA 108,156,52
TR 34,208,8192
MA 168,24,52
    buffer_load_dwordx4 a[4:7], v8, s[8:11], s45 offen offset:1024 sc1
MA 172,28,52
LW 4
MA 112,152,56
TR 36,209,0
MA 116,156,56
TR 38,209,8192
MA 176,24,56
    buffer_load_dwordx4 a[8:11], v8, s[8:11], s45 offen offset:2048 sc1
MA 180,28,56
LW 4
MA 120,152,60
TR 40,210,0
MA 124,156,60
TR 42,210,8192
MA 184,24,60
    buffer_load_dwordx4 a[12:15], v8, s[8:11], s45 offen offset:3072 sc1
MA 188,28,60
LW 4
MA 64,160,32
TR 44,211,0
    s_mov_b32 s45, 102400
MA 68,164,32
TR 46,211,8192
MA 128,32,32
    buffer_load_dwordx4 a[16:19], v8, s[8:11], s45 offen offset:0 sc1
MA 132,36,32
LW 4
MA 72,160,36
TR 48,212,0
MA 76,164,36
TR 50,212,8192
MA 136,32,36
    buffer_load_dwordx4 a[20:23], v8, s[8:11], s45 offen offset:1024 sc1
MA 140,36,36
LW 4
MA 80,160,40
TR 52,213,0
MA 84,164,40
TR 54,213,8192
MA 144,32,40
    buffer_load_dwordx4 a[24:27], v8, s[8:11], s45 offen offset:2048 sc1
MA 148,36,40
LW 4
MA 88,160,44
TR 56,214,0
MA 92,164,44
TR 58,214,8192
MA 152,32,44
    buffer_load_dwordx4 a[28:31], v8, s[8:11], s45 offen offset:3072 sc1
MA 156,36,44
LW 4
MA 96,160,48
TR 60,215,0
    s_add_u32 m0, s38, 98304
MA 100,164,48
TR 62,215,8192
    s_mov_b32 s44, 11927552
MA 160,32,48
    buffer_load_dwordx4 v9, s[4:7], s44 offen offset:0 lds
MA 164,36,48
LW 4
MA 104,160,52
TR 32,208,4096
MA 108,164,52
TR 34,208,12288
MA 168,32,52
    buffer_load_dwordx4 v10, s[4:7], s44 offen offset:1024 lds
MA 172,36,52
LW 4
MA 112,160,56
TR 36,209,4096
MA 116,164,56
TR 38,209,12288
MA 176,32,56
    buffer_load_dwordx4 v11, s[4:7], s44 offen offset:2048 lds
MA 180,36,56
LW 4
MA 120,160,60
TR 40,210,4096
MA 124,164,60
TR 42,210,12288
MA 184,32,60
    buffer_load_dwordx4 v12, s[4:7], s44 offen offset:3072 lds
MA 188,36,60
LW 4
MA 64,168,32
TR 44,211,4096
MA 68,172,32
TR 46,211,12288
MA 128,40,32
MA 132,44,32
LW 4
MA 72,168,36
TR 48,212,4096
MA 76,172,36
TR 50,212,12288
MA 136,40,36
MA 140,44,36
LW 4
MA 80,168,40
TR 52,213,4096
MA 84,172,40
TR 54,213,12288
MA 144,40,40
MA 148,44,40
LW 4
MA 88,168,44
TR 56,214,4096
MA 92,172,44
TR 58,214,12288
MA 152,40,44
MA 156,44,44
LW 4
MA 96,168,48
TR 60,215,4096
MA 100,172,48
TR 62,215,12288
MA 160,40,48
MA 164,44,48
LW 4
MA 104,168,52
    s_waitcnt vmcnt(52)
    s_barrier
TR 32,208,16384
MA 108,172,52
TR 34,208,24576
MA 168,40,52
MA 172,44,52
LW 4
MA 112,168,56
TR 36,209,16384
MA 116,172,56
TR 38,209,24576
MA 176,40,56
MA 180,44,56
LW 4
MA 120,168,60
TR 40,210,16384
MA 124,172,60
TR 42,210,24576
MA 184,40,60
MA 188,44,60
LW 4
MA 64,176,32
TR 44,211,16384
    s_add_u32 m0, s38, 114688
MA 68,180,32
TR 46,211,24576
    s_mov_b32 s44, 12386304
MA 128,48,32
    buffer_load_dwordx4 v9, s[4:7], s44 offen offset:0 lds
MA 132,52,32
    s_mov_b32 s46, 73728
LW 4
MA 72,176,36
TR 48,212,16384
MA 76,180,36
TR 50,212,24576
MA 136,48,36
    buffer_load_dwordx4 v10, s[4:7], s44 offen offset:1024 lds
MA 140,52,36
    s_mov_b32 s47, 90112
LW 4
MA 80,176,40
TR 52,213,16384
MA 84,180,40
TR 54,213,24576
MA 144,48,40
    buffer_load_dwordx4 v11, s[4:7], s44 offen offset:2048 lds
MA 148,52,40
    s_mov_b32 s48, 98304
LW 4
MA 88,176,44
TR 56,214,16384
MA 92,180,44
TR 58,214,24576
MA 152,48,44
    buffer_load_dwordx4 v12, s[4:7], s44 offen offset:3072 lds
MA 156,52,44
    s_mov_b32 s49, 106496
LW 4
MA 96,176,48
TR 60,215,16384
    s_mov_b32 s45, 106496
MA 100,180,48
TR 62,215,24576
MA 160,48,48
    buffer_load_dwordx4 a[32:35], v8, s[8:11], s45 offen offset:0 sc1
MA 164,52,48
LW 4
MA 104,176,52
TR 32,208,20480
MA 108,180,52
TR 34,208,28672
MA 168,48,52
    buffer_load_dwordx4 a[36:39], v8, s[8:11], s45 offen offset:1024 sc1
MA 172,52,52
LW 4
MA 112,176,56
TR 36,209,20480
MA 116,180,56
TR 38,209,28672
MA 176,48,56
    buffer_load_dwordx4 a[40:43], v8, s[8:11], s45 offen offset:2048 sc1
MA 180,52,56
LW 4
MA 120,176,60
TR 40,210,20480
MA 124,180,60
TR 42,210,28672
MA 184,48,60
    buffer_load_dwordx4 a[44:47], v8, s[8:11], s45 offen offset:3072 sc1
MA 188,52,60
LW 4
MA 64,184,32
TR 44,211,20480
MA 68,188,32
TR 46,211,28672
MA 128,56,32
MA 132,60,32
LW 4
MA 72,184,36
TR 48,212,20480
MA 76,188,36
TR 50,212,28672
MA 136,56,36
MA 140,60,36
LW 4
MA 80,184,40
TR 52,213,20480
MA 84,188,40
TR 54,213,28672
MA 144,56,40
MA 148,60,40
LW 4
MA 88,184,44
TR 56,214,20480
MA 92,188,44
TR 58,214,28672
MA 152,56,44
MA 156,60,44
LW 4
MA 96,184,48
TR 60,215,20480
MA 100,188,48
TR 62,215,28672
MA 160,56,48
MA 164,60,48
LW 4
MA 104,184,52
    s_waitcnt vmcnt(28)
    s_barrier
TR 32,192,0
MA 108,188,52
TR 34,192,8192
MA 168,56,52
MA 172,60,52
LW 4
MA 112,184,56
TR 36,193,0
MA 116,188,56
TR 38,193,8192
MA 176,56,56
MA 180,60,56
LW 4
MA 120,184,60
TR 40,192,4096
MA 124,188,60
TR 42,192,12288
MA 184,56,60
TR 44,193,4096
MA 188,60,60
TR 46,193,12288
    s_branch L_pass
L_miss24:
    s_mov_b32 s39, 4194304
    s_branch L_pld26
L_poll26:
    s_sub_u32 s39, s39, 1
    s_cbranch_scc1 L_exit0
    s_sleep 1
L_pld26:
    buffer_load_dwordx2 v[26:27], v22, s[8:11], 0 offen offset:128 sc1
    s_waitcnt vmcnt(0)
L_pchk26:
    v_cmp_ne_u64 vcc, s[56:57], v[26:27]
    s_nop 1
    s_cmp_lg_u64 vcc, 0
    s_cbranch_scc1 L_poll26
    s_branch L_back24
L_miss25:
    s_mov_b32 s39, 4194304
    s_branch L_pld27
L_poll27:
    s_sub_u32 s39, s39, 1
    s_cbranch_scc1 L_exit0
    s_sleep 1
L_pld27:
    buffer_load_dwordx2 v[26:27], v22, s[8:11], 0 offen offset:256 sc1
    s_waitcnt vmcnt(0)
L_pchk27:
    v_cmp_ne_u64 vcc, s[56:57], v[26:27]
    s_nop 1
    s_cmp_lg_u64 vcc, 0
    s_cbranch_scc1 L_poll27
    s_branch L_back25
L_var3:
    buffer_store_dwordx2 v[24:25], v29, s[8:11], s43 offen sc1
    s_cmp_eq_u32 s100, 0
    s_cbranch_scc1 L_noz28
    buffer_store_dwordx2 v[24:25], v30, s[8:11], s63 offen sc1
L_noz28:
    s_waitcnt vmcnt(9)
    s_barrier
    s_cmp_eq_u32 s100, 0
    s_cbranch_scc1 L_nof29
    s_mov_b64 exec, 0xffff
    buffer_store_dwordx2 v[4:5], v29, s[8:11], s54 offen offset:256 sc1
    s_mov_b64 exec, -1
L_nof29:
TR 32,192,0
TR 34,192,8192
TR 36,193,0
TR 38,193,8192
TR 40,194,0
TR 42,194,8192
LW 4
MA 64,128,32
TR 44,195,0
    s_add_u32 m0, s38, 32768
MA 68,132,32
TR 46,195,8192
    s_mov_b32 s44, 917504
MA 128,0,32
    buffer_load_dwordx4 v9, s[4:7], s44 offen offset:0 lds
MA 132,4,32
LW 4
MA 72,128,36
TR 48,196,0
MA 76,132,36
TR 50,196,8192
MA 136,0,36
    buffer_load_dwordx4 v10, s[4:7], s44 offen offset:1024 lds
MA 140,4,36
LW 4
MA 80,128,40
TR 52,197,0
MA 84,132,40
TR 54,197,8192
MA 144,0,40
    buffer_load_dwordx4 v11, s[4:7], s44 offen offset:2048 lds
MA 148,4,40
LW 4
MA 88,128,44
TR 56,198,0
MA 92,132,44
TR 58,198,8192
MA 152,0,44
    buffer_load_dwordx4 v12, s[4:7], s44 offen offset:3072 lds
MA 156,4,44
LW 4
MA 96,128,48
TR 60,199,0
    s_add_u32 m0, s38, 49152
MA 100,132,48
TR 62,199,8192
    s_mov_b32 s44, 1376256
MA 160,0,48
    buffer_load_dwordx4 v9, s[4:7], s44 offen offset:0 lds
MA 164,4,48
LW 4
MA 104,128,52
TR 32,192,4096
MA 108,132,52
TR 34,192,12288
MA 168,0,52
    buffer_load_dwordx4 v10, s[4:7], s44 offen offset:1024 lds
MA 172,4,52
LW 4
MA 112,128,56
TR 36,193,4096
MA 116,132,56
TR 38,193,12288
MA 176,0,56
    buffer_load_dwordx4 v11, s[4:7], s44 offen offset:2048 lds
MA 180,4,56
LW 4
MA 120,128,60
TR 40,194,4096
MA 124,132,60
TR 42,194,12288
MA 184,0,60
    buffer_load_dwordx4 v12, s[4:7], s44 offen offset:3072 lds
MA 188,4,60
LW 4
MA 64,136,32
TR 44,195,4096
    s_mov_b32 s45, 8192
MA 68,140,32
TR 46,195,12288
MA 128,8,32
    buffer_load_dwordx4 a[160:163], v7, s[8:11], s45 offen offset:0 sc1
MA 132,12,32
LW 4
MA 72,136,36
TR 48,196,4096
MA 76,140,36
TR 50,196,12288
MA 136,8,36
    buffer_load_dwordx4 a[164:167], v7, s[8:11], s45 offen offset:1024 sc1
MA 140,12,36
LW 4
MA 80,136,40
TR 52,197,4096
MA 84,140,40
TR 54,197,12288
MA 144,8,40
    buffer_load_dwordx4 a[32:35], v8, s[8:11], s45 offen offset:0 sc1
MA 148,12,40
LW 4
MA 88,136,44
TR 56,198,4096
MA 92,140,44
TR 58,198,12288
MA 152,8,44
    buffer_load_dwordx4 a[36:39], v8, s[8:11], s45 offen offset:1024 sc1
MA 156,12,44
LW 4
MA 96,136,48
TR 60,199,4096
MA 100,140,48
TR 62,199,12288
MA 160,8,48
    buffer_load_dwordx4 a[168:171], v7, s[8:11], s45 offen offset:2048 sc1
MA 164,12,48
LW 4
MA 104,136,52
    s_waitcnt vmcnt(14)
    s_barrier
TR 32,192,16384
MA 108,140,52
TR 34,192,24576
MA 168,8,52
    buffer_load_dwordx4 a[172:175], v7, s[8:11], s45 offen offset:3072 sc1
MA 172,12,52
LW 4
MA 112,136,56
TR 36,193,16384
MA 116,140,56
TR 38,193,24576
MA 176,8,56
    buffer_load_dwordx4 a[40:43], v8, s[8:11], s45 offen offset:2048 sc1
MA 180,12,56
LW 4
MA 120,136,60
TR 40,194,16384
MA 124,140,60
TR 42,194,24576
MA 184,8,60
    buffer_load_dwordx4 a[44:47], v8, s[8:11], s45 offen offset:3072 sc1
MA 188,12,60
LW 4
MA 64,144,32
TR 44,195,16384
    s_mov_b32 s45, 12288
MA 68,148,32
TR 46,195,24576
MA 128,16,32
    buffer_load_dwordx4 a[176:179], v7, s[8:11], s45 offen offset:0 sc1
MA 132,20,32
LW 4
MA 72,144,36
TR 48,196,16384
MA 76,148,36
TR 50,196,24576
MA 136,16,36
    buffer_load_dwordx4 a[180:183], v7, s[8:11], s45 offen offset:1024 sc1
MA 140,20,36
LW 4
MA 80,144,40
TR 52,197,16384
MA 84,148,40
TR 54,197,24576
MA 144,16,40
    buffer_load_dwordx4 a[48:51], v8, s[8:11], s45 offen offset:0 sc1
MA 148,20,40
LW 4
MA 88,144,44
TR 56,198,16384
MA 92,148,44
TR 58,198,24576
MA 152,16,44
    buffer_load_dwordx4 a[52:55], v8, s[8:11], s45 offen offset:1024 sc1
MA 156,20,44
LW 4
MA 96,144,48
TR 60,199,16384
MA 100,148,48
TR 62,199,24576
MA 160,16,48
    buffer_load_dwordx4 a[184:187], v7, s[8:11], s45 offen offset:2048 sc1
MA 164,20,48
LW 4
MA 104,144,52
TR 32,192,20480
MA 108,148,52
TR 34,192,28672
MA 168,16,52
    buffer_load_dwordx4 a[188:191], v7, s[8:11], s45 offen offset:3072 sc1
MA 172,20,52
    buffer_load_dwordx2 v[26:27], v22, s[8:11], 0 offen offset:128 sc1
LW 4
MA 112,144,56
TR 36,193,20480
MA 116,148,56
TR 38,193,28672
MA 176,16,56
    buffer_load_dwordx4 a[56:59], v8, s[8:11], s45 offen offset:2048 sc1
MA 180,20,56
LW 4
MA 120,144,60
TR 40,194,20480
MA 124,148,60
TR 42,194,28672
MA 184,16,60
    buffer_load_dwordx4 a[60:63], v8, s[8:11], s45 offen offset:3072 sc1
MA 188,20,60
LW 4
MA 64,152,32
TR 44,195,20480
    s_add_u32 m0, s38, 65536
MA 68,156,32
TR 46,195,28672
    s_mov_b32 s44, 2752512
MA 128,24,32
    buffer_load_dwordx4 v9, s[4:7], s44 offen offset:0 lds
MA 132,28,32
LW 4
MA 72,152,36
TR 48,196,20480
MA 76,156,36
TR 50,196,28672
MA 136,24,36
    buffer_load_dwordx4 v10, s[4:7], s44 offen offset:1024 lds
MA 140,28,36
LW 4
MA 80,152,40
TR 52,197,20480
MA 84,156,40
TR 54,197,28672
MA 144,24,40
    buffer_load_dwordx4 v11, s[4:7], s44 offen offset:2048 lds
MA 148,28,40
LW 4
MA 88,152,44
TR 56,198,20480
MA 92,156,44
TR 58,198,28672
MA 152,24,44
    buffer_load_dwordx4 v12, s[4:7], s44 offen offset:3072 lds
MA 156,28,44
LW 4
MA 96,152,48
TR 60,199,20480
    s_add_u32 m0, s38, 81920
MA 100,156,48
TR 62,199,28672
    s_mov_b32 s44, 3211264
MA 160,24,48
    buffer_load_dwordx4 v9, s[4:7], s44 offen offset:0 lds
MA 164,28,48
LW 4
MA 104,152,52
    s_waitcnt vmcnt(14)
    s_barrier
TR 32,192,32768
MA 108,156,52
TR 34,192,40960
MA 168,24,52
    buffer_load_dwordx4 v10, s[4:7], s44 offen offset:1024 lds
MA 172,28,52
LW 4
MA 112,152,56
TR 36,193,32768
MA 116,156,56
TR 38,193,40960
MA 176,24,56
    buffer_load_dwordx4 v11, s[4:7], s44 offen offset:2048 lds
MA 180,28,56
LW 4
MA 120,152,60
TR 40,194,32768
MA 124,156,60
TR 42,194,40960
MA 184,24,60
    buffer_load_dwordx4 v12, s[4:7], s44 offen offset:3072 lds
    s_sub_u32 s39, s32, 2
    s_cmp_ge_u32 s39, 2
    s_cbranch_scc1 L_nog30
    buffer_load_dword v15, v15, s[12:15], 0 offen
L_nog30:
MA 188,28,60
LW 4
MA 64,160,32
TR 44,195,32768
MA 68,164,32
TR 46,195,40960
MA 128,32,32
MA 132,36,32
LW 4
MA 72,160,36
TR 48,196,32768
MA 76,164,36
TR 50,196,40960
MA 136,32,36
MA 140,36,36
LW 4
MA 80,160,40
TR 52,197,32768
MA 84,164,40
TR 54,197,40960
MA 144,32,40
MA 148,36,40
LW 4
MA 88,160,44
TR 56,198,32768
MA 92,164,44
TR 58,198,40960
MA 152,32,44
MA 156,36,44
    s_waitcnt vmcnt(10)
    v_cmp_ne_u64 vcc, s[56:57], v[26:27]
    s_nop 1
    s_cmp_lg_u64 vcc, 0
    s_cbranch_scc1 L_miss31
L_back31:
LW 4
MA 96,160,48
TR 60,199,32768
    s_mov_b32 s45, 24576
MA 100,164,48
TR 62,199,40960
MA 160,32,48
    buffer_load_dwordx4 a[192:195], v7, s[8:11], s45 offen offset:0 sc1
MA 164,36,48
LW 4
MA 104,160,52
TR 32,192,36864
MA 108,164,52
TR 34,192,45056
MA 168,32,52
    buffer_load_dwordx4 a[196:199], v7, s[8:11], s45 offen offset:1024 sc1
MA 172,36,52
LW 4
MA 112,160,56
TR 36,193,36864
MA 116,164,56
TR 38,193,45056
MA 176,32,56
    buffer_load_dwordx4 a[64:67], v8, s[8:11], s45 offen offset:0 sc1
MA 180,36,56
LW 4
MA 120,160,60
TR 40,194,36864
MA 124,164,60
TR 42,194,45056
MA 184,32,60
    buffer_load_dwordx4 a[68:71], v8, s[8:11], s45 offen offset:1024 sc1
MA 188,36,60
LW 4
MA 64,168,32
TR 44,195,36864
MA 68,172,32
TR 46,195,45056
MA 128,40,32
    buffer_load_dwordx4 a[200:203], v7, s[8:11], s45 offen offset:2048 sc1
MA 132,44,32
LW 4
MA 72,168,36
TR 48,196,36864
MA 76,172,36
TR 50,196,45056
MA 136,40,36
    buffer_load_dwordx4 a[204:207], v7, s[8:11], s45 offen offset:3072 sc1
MA 140,44,36
LW 4
MA 80,168,40
TR 52,197,36864
MA 84,172,40
TR 54,197,45056
MA 144,40,40
    buffer_load_dwordx4 a[72:75], v8, s[8:11], s45 offen offset:2048 sc1
MA 148,44,40
LW 4
MA 88,168,44
TR 56,198,36864
MA 92,172,44
TR 58,198,45056
MA 152,40,44
    buffer_load_dwordx4 a[76:79], v8, s[8:11], s45 offen offset:3072 sc1
MA 156,44,44
LW 4
MA 96,168,48
TR 60,199,36864
    s_mov_b32 s45, 28672
MA 100,172,48
TR 62,199,45056
MA 160,40,48
    buffer_load_dwordx4 a[208:211], v7, s[8:11], s45 offen offset:0 sc1
MA 164,44,48
LW 4
MA 104,168,52
    s_waitcnt vmcnt(17)
    s_barrier
TR 32,192,49152
MA 108,172,52
TR 34,192,57344
MA 168,40,52
    buffer_load_dwordx4 a[212:215], v7, s[8:11], s45 offen offset:1024 sc1
MA 172,44,52
LW 4
MA 112,168,56
TR 36,193,49152
MA 116,172,56
TR 38,193,57344
MA 176,40,56
    buffer_load_dwordx4 a[80:83], v8, s[8:11], s45 offen offset:0 sc1
MA 180,44,56
LW 4
MA 120,168,60
TR 40,194,49152
MA 124,172,60
TR 42,194,57344
MA 184,40,60
    buffer_load_dwordx4 a[84:87], v8, s[8:11], s45 offen offset:1024 sc1
MA 188,44,60
LW 4
MA 64,176,32
TR 44,195,49152
MA 68,180,32
TR 46,195,57344
MA 128,48,32
    buffer_load_dwordx4 a[216:219], v7, s[8:11], s45 offen offset:2048 sc1
MA 132,52,32
LW 4
MA 72,176,36
TR 48,196,49152
MA 76,180,36
TR 50,196,57344
MA 136,48,36
    buffer_load_dwordx4 a[220:223], v7, s[8:11], s45 offen offset:3072 sc1
MA 140,52,36
LW 4
MA 80,176,40
TR 52,197,49152
MA 84,180,40
TR 54,197,57344
MA 144,48,40
    buffer_load_dwordx4 a[88:91], v8, s[8:11], s45 offen offset:2048 sc1
MA 148,52,40
LW 4
MA 88,176,44
TR 56,198,49152
MA 92,180,44
TR 58,198,57344
MA 152,48,44
    buffer_load_dwordx4 a[92:95], v8, s[8:11], s45 offen offset:3072 sc1
MA 156,52,44
LW 4
MA 96,176,48
TR 60,199,49152
    s_add_u32 m0, s38, 98304
MA 100,180,48
TR 62,199,57344
    s_mov_b32 s44, 1835008
MA 160,48,48
    buffer_load_dwordx4 v9, s[4:7], s44 offen offset:0 lds
MA 164,52,48
LW 4
MA 104,176,52
TR 32,192,53248
MA 108,180,52
TR 34,192,61440
MA 168,48,52
    buffer_load_dwordx4 v10, s[4:7], s44 offen offset:1024 lds
MA 172,52,52
LW 4
MA 112,176,56
TR 36,193,53248
MA 116,180,56
TR 38,193,61440
MA 176,48,56
    buffer_load_dwordx4 v11, s[4:7], s44 offen offset:2048 lds
MA 180,52,56
LW 4
MA 120,176,60
TR 40,194,53248
MA 124,180,60
TR 42,194,61440
MA 184,48,60
    buffer_load_dwordx4 v12, s[4:7], s44 offen offset:3072 lds
MA 188,52,60
LW 4
MA 64,184,32
TR 44,195,53248
    s_add_u32 m0, s38, 114688
MA 68,188,32
TR 46,195,61440
    s_mov_b32 s44, 2293760
MA 128,56,32
    buffer_load_dwordx4 v9, s[4:7], s44 offen offset:0 lds
MA 132,60,32
LW 4
MA 72,184,36
TR 48,196,53248
MA 76,188,36
TR 50,196,61440
MA 136,56,36
    buffer_load_dwordx4 v10, s[4:7], s44 offen offset:1024 lds
MA 140,60,36
LW 4
MA 80,184,40
TR 52,197,53248
MA 84,188,40
TR 54,197,61440
MA 144,56,40
    buffer_load_dwordx4 v11, s[4:7], s44 offen offset:2048 lds
MA 148,60,40
LW 4
MA 88,184,44
TR 56,198,53248
MA 92,188,44
TR 58,198,61440
MA 152,56,44
    buffer_load_dwordx4 v12, s[4:7], s44 offen offset:3072 lds
MA 156,60,44
LW 4
MA 96,184,48
TR 60,199,53248
    s_mov_b32 s45, 16384
MA 100,188,48
TR 62,199,61440
MA 160,56,48
    buffer_load_dwordx4 a[224:227], v7, s[8:11], s45 offen offset:0 sc1
MA 164,60,48
LW 4
MA 104,184,52
    s_waitcnt vmcnt(17)
    s_barrier
TR 32,200,0
MA 108,188,52
TR 34,200,8192
MA 168,56,52
    buffer_load_dwordx4 a[228:231], v7, s[8:11], s45 offen offset:1024 sc1
MA 172,60,52
LW 4
MA 112,184,56
TR 36,201,0
MA 116,188,56
TR 38,201,8192
MA 176,56,56
    buffer_load_dwordx4 a[96:99], v8, s[8:11], s45 offen offset:0 sc1
MA 180,60,56
LW 4
MA 120,184,60
TR 40,202,0
MA 124,188,60
TR 42,202,8192
MA 184,56,60
    buffer_load_dwordx4 a[100:103], v8, s[8:11], s45 offen offset:1024 sc1
MA 188,60,60
LW 4
MA 64,192,32
TR 44,203,0
MA 68,196,32
TR 46,203,8192
MA 128,64,32
    buffer_load_dwordx4 a[232:235], v7, s[8:11], s45 offen offset:2048 sc1
MA 132,68,32
LW 4
MA 72,192,36
TR 48,204,0
MA 76,196,36
TR 50,204,8192
MA 136,64,36
    buffer_load_dwordx4 a[236:239], v7, s[8:11], s45 offen offset:3072 sc1
MA 140,68,36
LW 4
MA 80,192,40
TR 52,205,0
MA 84,196,40
TR 54,205,8192
MA 144,64,40
    buffer_load_dwordx4 a[104:107], v8, s[8:11], s45 offen offset:2048 sc1
MA 148,68,40
LW 4
MA 88,192,44
TR 56,206,0
MA 92,196,44
TR 58,206,8192
MA 152,64,44
    buffer_load_dwordx4 a[108:111], v8, s[8:11], s45 offen offset:3072 sc1
MA 156,68,44
LW 4
MA 96,192,48
TR 60,207,0
    s_mov_b32 s45, 20480
MA 100,196,48
TR 62,207,8192
MA 160,64,48
    buffer_load_dwordx4 a[240:243], v7, s[8:11], s45 offen offset:0 sc1
MA 164,68,48
LW 4
MA 104,192,52
TR 32,200,4096
MA 108,196,52
TR 34,200,12288
MA 168,64,52
    buffer_load_dwordx4 a[244:247], v7, s[8:11], s45 offen offset:1024 sc1
MA 172,68,52
LW 4
MA 112,192,56
TR 36,201,4096
MA 116,196,56
TR 38,201,12288
MA 176,64,56
    buffer_load_dwordx4 a[112:115], v8, s[8:11], s45 offen offset:0 sc1
MA 180,68,56
LW 4
MA 120,192,60
TR 40,202,4096
MA 124,196,60
TR 42,202,12288
MA 184,64,60
    buffer_load_dwordx4 a[116:119], v8, s[8:11], s45 offen offset:1024 sc1
MA 188,68,60
LW 4
MA 64,200,32
TR 44,203,4096
MA 68,204,32
TR 46,203,12288
MA 128,72,32
    buffer_load_dwordx4 a[248:251], v7, s[8:11], s45 offen offset:2048 sc1
MA 132,76,32
LW 4
MA 72,200,36
TR 48,204,4096
MA 76,204,36
TR 50,204,12288
MA 136,72,36
    buffer_load_dwordx4 a[252:255], v7, s[8:11], s45 offen offset:3072 sc1
MA 140,76,36
LW 4
MA 80,200,40
TR 52,205,4096
MA 84,204,40
TR 54,205,12288
MA 144,72,40
    buffer_load_dwordx4 a[120:123], v8, s[8:11], s45 offen offset:2048 sc1
MA 148,76,40
LW 4
MA 88,200,44
TR 56,206,4096
MA 92,204,44
TR 58,206,12288
MA 152,72,44
    buffer_load_dwordx4 a[124:127], v8, s[8:11], s45 offen offset:3072 sc1
MA 156,76,44
LW 4
MA 96,200,48
TR 60,207,4096
    s_add_u32 m0, s38, 131072
MA 100,204,48
TR 62,207,12288
    s_mov_b32 s44, 3670016
MA 160,72,48
    buffer_load_dwordx4 v9, s[4:7], s44 offen offset:0 lds
MA 164,76,48
LW 4
MA 104,200,52
    s_waitcnt vmcnt(25)
    s_barrier
TR 32,200,16384
MA 108,204,52
TR 34,200,24576
MA 168,72,52
    buffer_load_dwordx4 v10, s[4:7], s44 offen offset:1024 lds
MA 172,76,52
LW 4
MA 112,200,56
TR 36,201,16384
MA 116,204,56
TR 38,201,24576
MA 176,72,56
    buffer_load_dwordx4 v11, s[4:7], s44 offen offset:2048 lds
MA 180,76,56
LW 4
MA 120,200,60
TR 40,202,16384
MA 124,204,60
TR 42,202,24576
MA 184,72,60
    buffer_load_dwordx4 v12, s[4:7], s44 offen offset:3072 lds
MA 188,76,60
LW 4
MA 64,208,32
TR 44,203,16384
    s_add_u32 m0, s38, 147456
MA 68,212,32
TR 46,203,24576
    s_mov_b32 s44, 4128768
MA 128,80,32
    buffer_load_dwordx4 v9, s[4:7], s44 offen offset:0 lds
MA 132,84,32
LW 4
MA 72,208,36
TR 48,204,16384
MA 76,212,36
TR 50,204,24576
MA 136,80,36
    buffer_load_dwordx4 v10, s[4:7], s44 offen offset:1024 lds
MA 140,84,36
LW 4
MA 80,208,40
TR 52,205,16384
MA 84,212,40
TR 54,205,24576
MA 144,80,40
    buffer_load_dwordx4 v11, s[4:7], s44 offen offset:2048 lds
MA 148,84,40
LW 4
MA 88,208,44
TR 56,206,16384
MA 92,212,44
TR 58,206,24576
MA 152,80,44
    buffer_load_dwordx4 v12, s[4:7], s44 offen offset:3072 lds
MA 156,84,44
LW 4
MA 96,208,48
TR 60,207,16384
    s_mov_b32 s45, 32768
MA 100,212,48
TR 62,207,24576
MA 160,80,48
    buffer_load_dwordx4 a[128:131], v7, s[8:11], s45 offen offset:0 sc1
MA 164,84,48
LW 4
MA 104,208,52
TR 32,200,20480
MA 108,212,52
TR 34,200,28672
MA 168,80,52
    buffer_load_dwordx4 a[132:135], v7, s[8:11], s45 offen offset:1024 sc1
MA 172,84,52
LW 4
MA 112,208,56
TR 36,201,20480
MA 116,212,56
TR 38,201,28672
MA 176,80,56
    buffer_load_dwordx4 a[0:3], v8, s[8:11], s45 offen offset:0 sc1
MA 180,84,56
LW 4
MA 120,208,60
TR 40,202,20480
MA 124,212,60
TR 42,202,28672
MA 184,80,60
    buffer_load_dwordx4 a[4:7], v8, s[8:11], s45 offen offset:1024 sc1
MA 188,84,60
LW 4
MA 64,216,32
TR 44,203,20480
MA 68,220,32
TR 46,203,28672
MA 128,88,32
    buffer_load_dwordx4 a[136:139], v7, s[8:11], s45 offen offset:2048 sc1
MA 132,92,32
LW 4
MA 72,216,36
TR 48,204,20480
MA 76,220,36
TR 50,204,28672
MA 136,88,36
    buffer_load_dwordx4 a[140:143], v7, s[8:11], s45 offen offset:3072 sc1
MA 140,92,36
LW 4
MA 80,216,40
TR 52,205,20480
MA 84,220,40
TR 54,205,28672
MA 144,88,40
    buffer_load_dwordx4 a[8:11], v8, s[8:11], s45 offen offset:2048 sc1
MA 148,92,40
LW 4
MA 88,216,44
TR 56,206,20480
MA 92,220,44
TR 58,206,28672
MA 152,88,44
    buffer_load_dwordx4 a[12:15], v8, s[8:11], s45 offen offset:3072 sc1
MA 156,92,44
LW 4
MA 96,216,48
TR 60,207,20480
    s_mov_b32 s45, 36864
MA 100,220,48
TR 62,207,28672
MA 160,88,48
    buffer_load_dwordx4 a[144:147], v7, s[8:11], s45 offen offset:0 sc1
MA 164,92,48
LW 4
MA 104,216,52
    s_waitcnt vmcnt(25)
    s_barrier
TR 32,200,32768
MA 108,220,52
TR 34,200,40960
MA 168,88,52
    buffer_load_dwordx4 a[148:151], v7, s[8:11], s45 offen offset:1024 sc1
MA 172,92,52
LW 4
MA 112,216,56
TR 36,201,32768
MA 116,220,56
TR 38,201,40960
MA 176,88,56
    buffer_load_dwordx4 a[16:19], v8, s[8:11], s45 offen offset:0 sc1
MA 180,92,56
LW 4
MA 120,216,60
TR 40,202,32768
MA 124,220,60
TR 42,202,40960
MA 184,88,60
    buffer_load_dwordx4 a[20:23], v8, s[8:11], s45 offen offset:1024 sc1
MA 188,92,60
LW 4
MA 64,224,32
TR 44,203,32768
MA 68,228,32
TR 46,203,40960
MA 128,96,32
    buffer_load_dwordx4 a[152:155], v7, s[8:11], s45 offen offset:2048 sc1
MA 132,100,32
LW 4
MA 72,224,36
TR 48,204,32768
MA 76,228,36
TR 50,204,40960
MA 136,96,36
    buffer_load_dwordx4 a[156:159], v7, s[8:11], s45 offen offset:3072 sc1
MA 140,100,36
LW 4
MA 80,224,40
TR 52,205,32768
MA 84,228,40
TR 54,205,40960
MA 144,96,40
    buffer_load_dwordx4 a[24:27], v8, s[8:11], s45 offen offset:2048 sc1
MA 148,100,40
LW 4
MA 88,224,44
TR 56,206,32768
MA 92,228,44
TR 58,206,40960
MA 152,96,44
    buffer_load_dwordx4 a[28:31], v8, s[8:11], s45 offen offset:3072 sc1
MA 156,100,44
LW 4
MA 96,224,48
TR 60,207,32768
    s_add_u32 m0, s38, 0
MA 100,228,48
TR 62,207,40960
    s_mov_b32 s44, 4587520
MA 160,96,48
    buffer_load_dwordx4 v9, s[4:7], s44 offen offset:0 lds
MA 164,100,48
LW 4
MA 104,224,52
TR 32,200,36864
MA 108,228,52
TR 34,200,45056
MA 168,96,52
    buffer_load_dwordx4 v10, s[4:7], s44 offen offset:1024 lds
MA 172,100,52
LW 4
MA 112,224,56
TR 36,201,36864
MA 116,228,56
TR 38,201,45056
MA 176,96,56
    buffer_load_dwordx4 v11, s[4:7], s44 offen offset:2048 lds
MA 180,100,56
LW 4
MA 120,224,60
TR 40,202,36864
MA 124,228,60
TR 42,202,45056
MA 184,96,60
    buffer_load_dwordx4 v12, s[4:7], s44 offen offset:3072 lds
MA 188,100,60
LW 4
MA 64,232,32
TR 44,203,36864
    s_add_u32 m0, s38, 16384
MA 68,236,32
TR 46,203,45056
    s_mov_b32 s44, 5046272
MA 128,104,32
    buffer_load_dwordx4 v9, s[4:7], s44 offen offset:0 lds
MA 132,108,32
LW 4
MA 72,232,36
TR 48,204,36864
MA 76,236,36
TR 50,204,45056
MA 136,104,36
    buffer_load_dwordx4 v10, s[4:7], s44 offen offset:1024 lds
MA 140,108,36
LW 4
MA 80,232,40
TR 52,205,36864
MA 84,236,40
TR 54,205,45056
MA 144,104,40
    buffer_load_dwordx4 v11, s[4:7], s44 offen offset:2048 lds
MA 148,108,40
LW 4
MA 88,232,44
TR 56,206,36864
MA 92,236,44
TR 58,206,45056
MA 152,104,44
    buffer_load_dwordx4 v12, s[4:7], s44 offen offset:3072 lds
MA 156,108,44
LW 4
MA 96,232,48
TR 60,207,36864
    s_mov_b32 s45, 40960
MA 100,236,48
TR 62,207,45056
MA 160,104,48
    buffer_load_dwordx4 a[160:163], v7, s[8:11], s45 offen offset:0 sc1
MA 164,108,48
LW 4
MA 104,232,52
    s_waitcnt vmcnt(33)
    s_barrier
TR 32,200,49152
MA 108,236,52
TR 34,200,57344
MA 168,104,52
    buffer_load_dwordx4 a[164:167], v7, s[8:11], s45 offen offset:1024 sc1
MA 172,108,52
LW 4
MA 112,232,56
TR 36,201,49152
MA 116,236,56
TR 38,201,57344
MA 176,104,56
    buffer_load_dwordx4 a[32:35], v8, s[8:11], s45 offen offset:0 sc1
MA 180,108,56
LW 4
MA 120,232,60
TR 40,202,49152
MA 124,236,60
TR 42,202,57344
MA 184,104,60
    buffer_load_dwordx4 a[36:39], v8, s[8:11], s45 offen offset:1024 sc1
MA 188,108,60
LW 4
MA 64,240,32
TR 44,203,49152
MA 68,244,32
TR 46,203,57344
MA 128,112,32
    buffer_load_dwordx4 a[168:171], v7, s[8:11], s45 offen offset:2048 sc1
MA 132,116,32
LW 4
MA 72,240,36
TR 48,204,49152
MA 76,244,36
TR 50,204,57344
MA 136,112,36
    buffer_load_dwordx4 a[172:175], v7, s[8:11], s45 offen offset:3072 sc1
MA 140,116,36
LW 4
MA 80,240,40
TR 52,205,49152
MA 84,244,40
TR 54,205,57344
MA 144,112,40
    buffer_load_dwordx4 a[40:43], v8, s[8:11], s45 offen offset:2048 sc1
MA 148,116,40
LW 4
MA 88,240,44
TR 56,206,49152
MA 92,244,44
TR 58,206,57344
MA 152,112,44
    buffer_load_dwordx4 a[44:47], v8, s[8:11], s45 offen offset:3072 sc1
MA 156,116,44
LW 4
MA 96,240,48
TR 60,207,49152
    s_mov_b32 s45, 45056
MA 100,244,48
TR 62,207,57344
MA 160,112,48
    buffer_load_dwordx4 a[176:179], v7, s[8:11], s45 offen offset:0 sc1
MA 164,116,48
LW 4
MA 104,240,52
TR 32,200,53248
MA 108,244,52
TR 34,200,61440
MA 168,112,52
    buffer_load_dwordx4 a[180:183], v7, s[8:11], s45 offen offset:1024 sc1
MA 172,116,52
LW 4
MA 112,240,56
TR 36,201,53248
MA 116,244,56
TR 38,201,61440
MA 176,112,56
    buffer_load_dwordx4 a[48:51], v8, s[8:11], s45 offen offset:0 sc1
MA 180,116,56
LW 4
MA 120,240,60
TR 40,202,53248
MA 124,244,60
TR 42,202,61440
MA 184,112,60
    buffer_load_dwordx4 a[52:55], v8, s[8:11], s45 offen offset:1024 sc1
MA 188,116,60
LW 4
MA 64,248,32
TR 44,203,53248
MA 68,252,32
TR 46,203,61440
MA 128,120,32
    buffer_load_dwordx4 a[184:187], v7, s[8:11], s45 offen offset:2048 sc1
MA 132,124,32
LW 4
MA 72,248,36
TR 48,204,53248
MA 76,252,36
TR 50,204,61440
MA 136,120,36
    buffer_load_dwordx4 a[188:191], v7, s[8:11], s45 offen offset:3072 sc1
MA 140,124,36
LW 4
MA 80,248,40
TR 52,205,53248
MA 84,252,40
TR 54,205,61440
MA 144,120,40
    buffer_load_dwordx4 a[56:59], v8, s[8:11], s45 offen offset:2048 sc1
MA 148,124,40
LW 4
MA 88,248,44
TR 56,206,53248
MA 92,252,44
TR 58,206,61440
MA 152,120,44
    buffer_load_dwordx4 a[60:63], v8, s[8:11], s45 offen offset:3072 sc1
MA 156,124,44
LW 4
MA 96,248,48
TR 60,207,53248
    s_add_u32 m0, s38, 32768
MA 100,252,48
TR 62,207,61440
    s_mov_b32 s44, 6422528
MA 160,120,48
    buffer_load_dwordx4 v9, s[4:7], s44 offen offset:0 lds
MA 164,124,48
LW 4
MA 104,248,52
    s_waitcnt vmcnt(33)
    s_barrier
TR 32,208,0
MA 108,252,52
TR 34,208,8192
MA 168,120,52
    buffer_load_dwordx4 v10, s[4:7], s44 offen offset:1024 lds
MA 172,124,52
LW 4
MA 112,248,56
TR 36,209,0
MA 116,252,56
TR 38,209,8192
MA 176,120,56
    buffer_load_dwordx4 v11, s[4:7], s44 offen offset:2048 lds
MA 180,124,56
LW 4
MA 120,248,60
TR 40,210,0
MA 124,252,60
TR 42,210,8192
MA 184,120,60
    buffer_load_dwordx4 v12, s[4:7], s44 offen offset:3072 lds
MA 188,124,60
LW 4
MA 64,128,32
TR 44,211,0
    s_add_u32 m0, s38, 49152
MA 68,132,32
TR 46,211,8192
    s_mov_b32 s44, 6881280
MA 128,0,32
    buffer_load_dwordx4 v9, s[4:7], s44 offen offset:0 lds
MA 132,4,32
LW 4
MA 72,128,36
TR 48,212,0
MA 76,132,36
TR 50,212,8192
MA 136,0,36
    buffer_load_dwordx4 v10, s[4:7], s44 offen offset:1024 lds
MA 140,4,36
    buffer_load_dwordx2 v[26:27], v22, s[8:11], 0 offen offset:256 sc1
LW 4
MA 80,128,40
TR 52,213,0
MA 84,132,40
TR 54,213,8192
MA 144,0,40
    buffer_load_dwordx4 v11, s[4:7], s44 offen offset:2048 lds
MA 148,4,40
LW 4
MA 88,128,44
TR 56,214,0
MA 92,132,44
TR 58,214,8192
MA 152,0,44
    buffer_load_dwordx4 v12, s[4:7], s44 offen offset:3072 lds
MA 156,4,44
LW 4
MA 96,128,48
TR 60,215,0
MA 100,132,48
TR 62,215,8192
MA 160,0,48
MA 164,4,48
LW 4
MA 104,128,52
TR 32,208,4096
MA 108,132,52
TR 34,208,12288
MA 168,0,52
MA 172,4,52
LW 4
MA 112,128,56
TR 36,209,4096
MA 116,132,56
TR 38,209,12288
MA 176,0,56
MA 180,4,56
LW 4
MA 120,128,60
TR 40,210,4096
MA 124,132,60
TR 42,210,12288
MA 184,0,60
MA 188,4,60
LW 4
MA 64,136,32
TR 44,211,4096
MA 68,140,32
TR 46,211,12288
MA 128,8,32
MA 132,12,32
LW 4
MA 72,136,36
TR 48,212,4096
MA 76,140,36
TR 50,212,12288
MA 136,8,36
MA 140,12,36
LW 4
MA 80,136,40
TR 52,213,4096
MA 84,140,40
TR 54,213,12288
MA 144,8,40
MA 148,12,40
LW 4
MA 88,136,44
TR 56,214,4096
MA 92,140,44
TR 58,214,12288
MA 152,8,44
MA 156,12,44
LW 4
MA 96,136,48
TR 60,215,4096
MA 100,140,48
TR 62,215,12288
MA 160,8,48
MA 164,12,48
LW 4
MA 104,136,52
    s_waitcnt vmcnt(33)
    s_barrier
TR 32,208,16384
MA 108,140,52
TR 34,208,24576
MA 168,8,52
MA 172,12,52
LW 4
MA 112,136,56
TR 36,209,16384
MA 116,140,56
TR 38,209,24576
MA 176,8,56
MA 180,12,56
LW 4
MA 120,136,60
TR 40,210,16384
MA 124,140,60
TR 42,210,24576
MA 184,8,60
MA 188,12,60
    s_waitcnt vmcnt(2)
    v_cmp_ne_u64 vcc, s[56:57], v[26:27]
    s_nop 1
    s_cmp_lg_u64 vcc, 0
    s_cbranch_scc1 L_miss32
L_back32:
LW 4
MA 64,144,32
TR 44,211,16384
    s_mov_b32 s45, 57344
MA 68,148,32
TR 46,211,24576
MA 128,16,32
    buffer_load_dwordx4 a[192:195], v7, s[8:11], s45 offen offset:0 sc1
MA 132,20,32
LW 4
MA 72,144,36
TR 48,212,16384
MA 76,148,36
TR 50,212,24576
MA 136,16,36
    buffer_load_dwordx4 a[196:199], v7, s[8:11], s45 offen offset:1024 sc1
MA 140,20,36
LW 4
MA 80,144,40
TR 52,213,16384
MA 84,148,40
TR 54,213,24576
MA 144,16,40
    buffer_load_dwordx4 a[64:67], v8, s[8:11], s45 offen offset:0 sc1
MA 148,20,40
LW 4
MA 88,144,44
TR 56,214,16384
MA 92,148,44
TR 58,214,24576
MA 152,16,44
    buffer_load_dwordx4 a[68:71], v8, s[8:11], s45 offen offset:1024 sc1
MA 156,20,44
LW 4
MA 96,144,48
TR 60,215,16384
MA 100,148,48
TR 62,215,24576
MA 160,16,48
    buffer_load_dwordx4 a[200:203], v7, s[8:11], s45 offen offset:2048 sc1
MA 164,20,48
LW 4
MA 104,144,52
TR 32,208,20480
MA 108,148,52
TR 34,208,28672
MA 168,16,52
    buffer_load_dwordx4 a[204:207], v7, s[8:11], s45 offen offset:3072 sc1
MA 172,20,52
LW 4
MA 112,144,56
TR 36,209,20480
MA 116,148,56
TR 38,209,28672
MA 176,16,56
    buffer_load_dwordx4 a[72:75], v8, s[8:11], s45 offen offset:2048 sc1
MA 180,20,56
LW 4
MA 120,144,60
TR 40,210,20480
MA 124,148,60
TR 42,210,28672
MA 184,16,60
    buffer_load_dwordx4 a[76:79], v8, s[8:11], s45 offen offset:3072 sc1
MA 188,20,60
LW 4
MA 64,152,32
TR 44,211,20480
    s_mov_b32 s45, 61440
MA 68,156,32
TR 46,211,28672
MA 128,24,32
    buffer_load_dwordx4 a[208:211], v7, s[8:11], s45 offen offset:0 sc1
MA 132,28,32
LW 4
MA 72,152,36
TR 48,212,20480
MA 76,156,36
TR 50,212,28672
MA 136,24,36
    buffer_load_dwordx4 a[212:215], v7, s[8:11], s45 offen offset:1024 sc1
MA 140,28,36
LW 4
MA 80,152,40
TR 52,213,20480
MA 84,156,40
TR 54,213,28672
MA 144,24,40
    buffer_load_dwordx4 a[80:83], v8, s[8:11], s45 offen offset:0 sc1
MA 148,28,40
LW 4
MA 88,152,44
TR 56,214,20480
MA 92,156,44
TR 58,214,28672
MA 152,24,44
    buffer_load_dwordx4 a[84:87], v8, s[8:11], s45 offen offset:1024 sc1
MA 156,28,44
LW 4
MA 96,152,48
TR 60,215,20480
MA 100,156,48
TR 62,215,28672
MA 160,24,48
    buffer_load_dwordx4 a[216:219], v7, s[8:11], s45 offen offset:2048 sc1
MA 164,28,48
LW 4
MA 104,152,52
    s_barrier
TR 32,192,0
MA 108,156,52
TR 34,192,8192
MA 168,24,52
    buffer_load_dwordx4 a[220:223], v7, s[8:11], s45 offen offset:3072 sc1
MA 172,28,52
LW 4
MA 112,152,56
TR 36,193,0
MA 116,156,56
TR 38,193,8192
MA 176,24,56
    buffer_load_dwordx4 a[88:91], v8, s[8:11], s45 offen offset:2048 sc1
MA 180,28,56
LW 4
MA 120,152,60
TR 40,194,0
MA 124,156,60
TR 42,194,8192
MA 184,24,60
    buffer_load_dwordx4 a[92:95], v8, s[8:11], s45 offen offset:3072 sc1
MA 188,28,60
LW 4
MA 64,160,32
TR 44,195,0
    s_add_u32 m0, s38, 65536
MA 68,164,32
TR 46,195,8192
    s_mov_b32 s44, 5505024
MA 128,32,32
    buffer_load_dwordx4 v9, s[4:7], s44 offen offset:0 lds
MA 132,36,32
LW 4
MA 72,160,36
TR 48,196,0
MA 76,164,36
TR 50,196,8192
MA 136,32,36
    buffer_load_dwordx4 v10, s[4:7], s44 offen offset:1024 lds
MA 140,36,36
LW 4
MA 80,160,40
TR 52,197,0
MA 84,164,40
TR 54,197,8192
MA 144,32,40
    buffer_load_dwordx4 v11, s[4:7], s44 offen offset:2048 lds
MA 148,36,40
LW 4
MA 88,160,44
TR 56,198,0
MA 92,164,44
TR 58,198,8192
MA 152,32,44
    buffer_load_dwordx4 v12, s[4:7], s44 offen offset:3072 lds
MA 156,36,44
LW 4
MA 96,160,48
TR 60,199,0
    s_add_u32 m0, s38, 81920
MA 100,164,48
TR 62,199,8192
    s_mov_b32 s44, 5963776
MA 160,32,48
    buffer_load_dwordx4 v9, s[4:7], s44 offen offset:0 lds
MA 164,36,48
LW 4
MA 104,160,52
TR 32,192,4096
MA 108,164,52
TR 34,192,12288
MA 168,32,52
    buffer_load_dwordx4 v10, s[4:7], s44 offen offset:1024 lds
MA 172,36,52
LW 4
MA 112,160,56
TR 36,193,4096
MA 116,164,56
TR 38,193,12288
MA 176,32,56
    buffer_load_dwordx4 v11, s[4:7], s44 offen offset:2048 lds
MA 180,36,56
LW 4
MA 120,160,60
TR 40,194,4096
MA 124,164,60
TR 42,194,12288
MA 184,32,60
    buffer_load_dwordx4 v12, s[4:7], s44 offen offset:3072 lds
MA 188,36,60
LW 4
MA 64,168,32
TR 44,195,4096
    s_mov_b32 s45, 49152
MA 68,172,32
TR 46,195,12288
MA 128,40,32
    buffer_load_dwordx4 a[224:227], v7, s[8:11], s45 offen offset:0 sc1
MA 132,44,32
LW 4
MA 72,168,36
TR 48,196,4096
MA 76,172,36
TR 50,196,12288
MA 136,40,36
    buffer_load_dwordx4 a[228:231], v7, s[8:11], s45 offen offset:1024 sc1
MA 140,44,36
LW 4
MA 80,168,40
TR 52,197,4096
MA 84,172,40
TR 54,197,12288
MA 144,40,40
    buffer_load_dwordx4 a[96:99], v8, s[8:11], s45 offen offset:0 sc1
MA 148,44,40
LW 4
MA 88,168,44
TR 56,198,4096
MA 92,172,44
TR 58,198,12288
MA 152,40,44
    buffer_load_dwordx4 a[100:103], v8, s[8:11], s45 offen offset:1024 sc1
MA 156,44,44
LW 4
MA 96,168,48
TR 60,199,4096
MA 100,172,48
TR 62,199,12288
MA 160,40,48
    buffer_load_dwordx4 a[232:235], v7, s[8:11], s45 offen offset:2048 sc1
MA 164,44,48
LW 4
MA 104,168,52
    s_barrier
TR 32,192,16384
MA 108,172,52
TR 34,192,24576
MA 168,40,52
    buffer_load_dwordx4 a[236:239], v7, s[8:11], s45 offen offset:3072 sc1
MA 172,44,52
LW 4
MA 112,168,56
TR 36,193,16384
MA 116,172,56
TR 38,193,24576
MA 176,40,56
    buffer_load_dwordx4 a[104:107], v8, s[8:11], s45 offen offset:2048 sc1
MA 180,44,56
LW 4
MA 120,168,60
TR 40,194,16384
MA 124,172,60
TR 42,194,24576
MA 184,40,60
    buffer_load_dwordx4 a[108:111], v8, s[8:11], s45 offen offset:3072 sc1
MA 188,44,60
LW 4
MA 64,176,32
TR 44,195,16384
    s_mov_b32 s45, 53248
MA 68,180,32
TR 46,195,24576
MA 128,48,32
    buffer_load_dwordx4 a[240:243], v7, s[8:11], s45 offen offset:0 sc1
MA 132,52,32
LW 4
MA 72,176,36
TR 48,196,16384
MA 76,180,36
TR 50,196,24576
MA 136,48,36
    buffer_load_dwordx4 a[244:247], v7, s[8:11], s45 offen offset:1024 sc1
MA 140,52,36
LW 4
MA 80,176,40
TR 52,197,16384
MA 84,180,40
TR 54,197,24576
MA 144,48,40
    buffer_load_dwordx4 a[112:115], v8, s[8:11], s45 offen offset:0 sc1
MA 148,52,40
LW 4
MA 88,176,44
TR 56,198,16384
MA 92,180,44
TR 58,198,24576
MA 152,48,44
    buffer_load_dwordx4 a[116:119], v8, s[8:11], s45 offen offset:1024 sc1
MA 156,52,44
LW 4
MA 96,176,48
TR 60,199,16384
MA 100,180,48
TR 62,199,24576
MA 160,48,48
    buffer_load_dwordx4 a[248:251], v7, s[8:11], s45 offen offset:2048 sc1
MA 164,52,48
LW 4
MA 104,176,52
TR 32,192,20480
MA 108,180,52
TR 34,192,28672
MA 168,48,52
    buffer_load_dwordx4 a[252:255], v7, s[8:11], s45 offen offset:3072 sc1
MA 172,52,52
LW 4
MA 112,176,56
TR 36,193,20480
MA 116,180,56
TR 38,193,28672
MA 176,48,56
    buffer_load_dwordx4 a[120:123], v8, s[8:11], s45 offen offset:2048 sc1
MA 180,52,56
LW 4
MA 120,176,60
TR 40,194,20480
MA 124,180,60
TR 42,194,28672
MA 184,48,60
    buffer_load_dwordx4 a[124:127], v8, s[8:11], s45 offen offset:3072 sc1
MA 188,52,60
LW 4
MA 64,184,32
TR 44,195,20480
    s_add_u32 m0, s38, 98304
MA 68,188,32
TR 46,195,28672
    s_mov_b32 s44, 7340032
MA 128,56,32
    buffer_load_dwordx4 v9, s[4:7], s44 offen offset:0 lds
MA 132,60,32
LW 4
MA 72,184,36
TR 48,196,20480
MA 76,188,36
TR 50,196,28672
MA 136,56,36
    buffer_load_dwordx4 v10, s[4:7], s44 offen offset:1024 lds
MA 140,60,36
LW 4
MA 80,184,40
TR 52,197,20480
MA 84,188,40
TR 54,197,28672
MA 144,56,40
    buffer_load_dwordx4 v11, s[4:7], s44 offen offset:2048 lds
MA 148,60,40
LW 4
MA 88,184,44
TR 56,198,20480
MA 92,188,44
TR 58,198,28672
MA 152,56,44
    buffer_load_dwordx4 v12, s[4:7], s44 offen offset:3072 lds
MA 156,60,44
LW 4
MA 96,184,48
TR 60,199,20480
    s_add_u32 m0, s38, 114688
MA 100,188,48
TR 62,199,28672
    s_mov_b32 s44, 7798784
MA 160,56,48
    buffer_load_dwordx4 v9, s[4:7], s44 offen offset:0 lds
MA 164,60,48
LW 4
MA 104,184,52
    s_waitcnt vmcnt(37)
    s_barrier
TR 32,192,32768
MA 108,188,52
TR 34,192,40960
MA 168,56,52
    buffer_load_dwordx4 v10, s[4:7], s44 offen offset:1024 lds
MA 172,60,52
LW 4
MA 112,184,56
TR 36,193,32768
MA 116,188,56
TR 38,193,40960
MA 176,56,56
    buffer_load_dwordx4 v11, s[4:7], s44 offen offset:2048 lds
MA 180,60,56
LW 4
MA 120,184,60
TR 40,194,32768
MA 124,188,60
TR 42,194,40960
MA 184,56,60
    buffer_load_dwordx4 v12, s[4:7], s44 offen offset:3072 lds
MA 188,60,60
LW 4
MA 64,192,32
TR 44,195,32768
    s_mov_b32 s45, 65536
MA 68,196,32
TR 46,195,40960
MA 128,64,32
    buffer_load_dwordx4 a[128:131], v7, s[8:11], s45 offen offset:0 sc1
MA 132,68,32
LW 4
MA 72,192,36
TR 48,196,32768
MA 76,196,36
TR 50,196,40960
MA 136,64,36
    buffer_load_dwordx4 a[132:135], v7, s[8:11], s45 offen offset:1024 sc1
MA 140,68,36
LW 4
MA 80,192,40
TR 52,197,32768
MA 84,196,40
TR 54,197,40960
MA 144,64,40
    buffer_load_dwordx4 a[0:3], v8, s[8:11], s45 offen offset:0 sc1
MA 148,68,40
LW 4
MA 88,192,44
TR 56,198,32768
MA 92,196,44
TR 58,198,40960
MA 152,64,44
    buffer_load_dwordx4 a[4:7], v8, s[8:11], s45 offen offset:1024 sc1
MA 156,68,44
LW 4
MA 96,192,48
TR 60,199,32768
MA 100,196,48
TR 62,199,40960
MA 160,64,48
    buffer_load_dwordx4 a[136:139], v7, s[8:11], s45 offen offset:2048 sc1
MA 164,68,48
LW 4
MA 104,192,52
TR 32,192,36864
MA 108,196,52
TR 34,192,45056
MA 168,64,52
    buffer_load_dwordx4 a[140:143], v7, s[8:11], s45 offen offset:3072 sc1
MA 172,68,52
LW 4
MA 112,192,56
TR 36,193,36864
MA 116,196,56
TR 38,193,45056
MA 176,64,56
    buffer_load_dwordx4 a[8:11], v8, s[8:11], s45 offen offset:2048 sc1
MA 180,68,56
LW 4
MA 120,192,60
TR 40,194,36864
MA 124,196,60
TR 42,194,45056
MA 184,64,60
    buffer_load_dwordx4 a[12:15], v8, s[8:11], s45 offen offset:3072 sc1
MA 188,68,60
LW 4
MA 64,200,32
TR 44,195,36864
    s_mov_b32 s45, 69632
MA 68,204,32
TR 46,195,45056
MA 128,72,32
    buffer_load_dwordx4 a[144:147], v7, s[8:11], s45 offen offset:0 sc1
MA 132,76,32
LW 4
MA 72,200,36
TR 48,196,36864
MA 76,204,36
TR 50,196,45056
MA 136,72,36
    buffer_load_dwordx4 a[148:151], v7, s[8:11], s45 offen offset:1024 sc1
MA 140,76,36
LW 4
MA 80,200,40
TR 52,197,36864
MA 84,204,40
TR 54,197,45056
MA 144,72,40
    buffer_load_dwordx4 a[16:19], v8, s[8:11], s45 offen offset:0 sc1
MA 148,76,40
LW 4
MA 88,200,44
TR 56,198,36864
MA 92,204,44
TR 58,198,45056
MA 152,72,44
    buffer_load_dwordx4 a[20:23], v8, s[8:11], s45 offen offset:1024 sc1
MA 156,76,44
LW 4
MA 96,200,48
TR 60,199,36864
MA 100,204,48
TR 62,199,45056
MA 160,72,48
    buffer_load_dwordx4 a[152:155], v7, s[8:11], s45 offen offset:2048 sc1
MA 164,76,48
LW 4
MA 104,200,52
    s_waitcnt vmcnt(45)
    s_barrier
TR 32,192,49152
MA 108,204,52
TR 34,192,57344
MA 168,72,52
    buffer_load_dwordx4 a[156:159], v7, s[8:11], s45 offen offset:3072 sc1
MA 172,76,52
LW 4
MA 112,200,56
TR 36,193,49152
MA 116,204,56
TR 38,193,57344
MA 176,72,56
    buffer_load_dwordx4 a[24:27], v8, s[8:11], s45 offen offset:2048 sc1
MA 180,76,56
LW 4
MA 120,200,60
TR 40,194,49152
MA 124,204,60
TR 42,194,57344
MA 184,72,60
    buffer_load_dwordx4 a[28:31], v8, s[8:11], s45 offen offset:3072 sc1
MA 188,76,60
LW 4
MA 64,208,32
TR 44,195,49152
    s_add_u32 m0, s38, 131072
MA 68,212,32
TR 46,195,57344
    s_mov_b32 s44, 8257536
MA 128,80,32
    buffer_load_dwordx4 v9, s[4:7], s44 offen offset:0 lds
MA 132,84,32
LW 4
MA 72,208,36
TR 48,196,49152
MA 76,212,36
TR 50,196,57344
MA 136,80,36
    buffer_load_dwordx4 v10, s[4:7], s44 offen offset:1024 lds
MA 140,84,36
LW 4
MA 80,208,40
TR 52,197,49152
MA 84,212,40
TR 54,197,57344
MA 144,80,40
    buffer_load_dwordx4 v11, s[4:7], s44 offen offset:2048 lds
MA 148,84,40
LW 4
MA 88,208,44
TR 56,198,49152
MA 92,212,44
TR 58,198,57344
MA 152,80,44
    buffer_load_dwordx4 v12, s[4:7], s44 offen offset:3072 lds
MA 156,84,44
LW 4
MA 96,208,48
TR 60,199,49152
    s_add_u32 m0, s38, 147456
MA 100,212,48
TR 62,199,57344
    s_mov_b32 s44, 8716288
MA 160,80,48
    buffer_load_dwordx4 v9, s[4:7], s44 offen offset:0 lds
MA 164,84,48
LW 4
MA 104,208,52
TR 32,192,53248
MA 108,212,52
TR 34,192,61440
MA 168,80,52
    buffer_load_dwordx4 v10, s[4:7], s44 offen offset:1024 lds
MA 172,84,52
LW 4
MA 112,208,56
TR 36,193,53248
MA 116,212,56
TR 38,193,61440
MA 176,80,56
    buffer_load_dwordx4 v11, s[4:7], s44 offen offset:2048 lds
MA 180,84,56
LW 4
MA 120,208,60
TR 40,194,53248
MA 124,212,60
TR 42,194,61440
MA 184,80,60
    buffer_load_dwordx4 v12, s[4:7], s44 offen offset:3072 lds
MA 188,84,60
LW 4
MA 64,216,32
TR 44,195,53248
    s_mov_b32 s45, 73728
MA 68,220,32
TR 46,195,61440
MA 128,88,32
    buffer_load_dwordx4 a[160:163], v7, s[8:11], s45 offen offset:0 sc1
MA 132,92,32
LW 4
MA 72,216,36
TR 48,196,53248
MA 76,220,36
TR 50,196,61440
MA 136,88,36
    buffer_load_dwordx4 a[164:167], v7, s[8:11], s45 offen offset:1024 sc1
MA 140,92,36
LW 4
MA 80,216,40
TR 52,197,53248
MA 84,220,40
TR 54,197,61440
MA 144,88,40
    buffer_load_dwordx4 a[32:35], v8, s[8:11], s45 offen offset:0 sc1
MA 148,92,40
LW 4
MA 88,216,44
TR 56,198,53248
MA 92,220,44
TR 58,198,61440
MA 152,88,44
    buffer_load_dwordx4 a[36:39], v8, s[8:11], s45 offen offset:1024 sc1
MA 156,92,44
LW 4
MA 96,216,48
TR 60,199,53248
MA 100,220,48
TR 62,199,61440
MA 160,88,48
    buffer_load_dwordx4 a[168:171], v7, s[8:11], s45 offen offset:2048 sc1
MA 164,92,48
LW 4
MA 104,216,52
    s_waitcnt vmcnt(45)
    s_barrier
TR 32,200,0
MA 108,220,52
TR 34,200,8192
MA 168,88,52
    buffer_load_dwordx4 a[172:175], v7, s[8:11], s45 offen offset:3072 sc1
MA 172,92,52
LW 4
MA 112,216,56
TR 36,201,0
MA 116,220,56
TR 38,201,8192
MA 176,88,56
    buffer_load_dwordx4 a[40:43], v8, s[8:11], s45 offen offset:2048 sc1
MA 180,92,56
LW 4
MA 120,216,60
TR 40,202,0
MA 124,220,60
TR 42,202,8192
MA 184,88,60
    buffer_load_dwordx4 a[44:47], v8, s[8:11], s45 offen offset:3072 sc1
MA 188,92,60
LW 4
MA 64,224,32
TR 44,203,0
    s_mov_b32 s45, 77824
MA 68,228,32
TR 46,203,8192
MA 128,96,32
    buffer_load_dwordx4 a[176:179], v7, s[8:11], s45 offen offset:0 sc1
MA 132,100,32
LW 4
MA 72,224,36
TR 48,204,0
MA 76,228,36
TR 50,204,8192
MA 136,96,36
    buffer_load_dwordx4 a[180:183], v7, s[8:11], s45 offen offset:1024 sc1
MA 140,100,36
LW 4
MA 80,224,40
TR 52,205,0
MA 84,228,40
TR 54,205,8192
MA 144,96,40
    buffer_load_dwordx4 a[48:51], v8, s[8:11], s45 offen offset:0 sc1
MA 148,100,40
LW 4
MA 88,224,44
TR 56,206,0
MA 92,228,44
TR 58,206,8192
MA 152,96,44
    buffer_load_dwordx4 a[52:55], v8, s[8:11], s45 offen offset:1024 sc1
MA 156,100,44
LW 4
MA 96,224,48
TR 60,207,0
MA 100,228,48
TR 62,207,8192
MA 160,96,48
    buffer_load_dwordx4 a[184:187], v7, s[8:11], s45 offen offset:2048 sc1
MA 164,100,48
LW 4
MA 104,224,52
TR 32,200,4096
MA 108,228,52
TR 34,200,12288
MA 168,96,52
    buffer_load_dwordx4 a[188:191], v7, s[8:11], s45 offen offset:3072 sc1
MA 172,100,52
LW 4
MA 112,224,56
TR 36,201,4096
MA 116,228,56
TR 38,201,12288
MA 176,96,56
    buffer_load_dwordx4 a[56:59], v8, s[8:11], s45 offen offset:2048 sc1
MA 180,100,56
LW 4
MA 120,224,60
TR 40,202,4096
MA 124,228,60
TR 42,202,12288
MA 184,96,60
    buffer_load_dwordx4 a[60:63], v8, s[8:11], s45 offen offset:3072 sc1
MA 188,100,60
LW 4
MA 64,232,32
TR 44,203,4096
    s_add_u32 m0, s38, 0
MA 68,236,32
TR 46,203,12288
    s_mov_b32 s44, 10092544
MA 128,104,32
    buffer_load_dwordx4 v9, s[4:7], s44 offen offset:0 lds
MA 132,108,32
LW 4
MA 72,232,36
TR 48,204,4096
MA 76,236,36
TR 50,204,12288
MA 136,104,36
    buffer_load_dwordx4 v10, s[4:7], s44 offen offset:1024 lds
MA 140,108,36
LW 4
MA 80,232,40
TR 52,205,4096
MA 84,236,40
TR 54,205,12288
MA 144,104,40
    buffer_load_dwordx4 v11, s[4:7], s44 offen offset:2048 lds
MA 148,108,40
LW 4
MA 88,232,44
TR 56,206,4096
MA 92,236,44
TR 58,206,12288
MA 152,104,44
    buffer_load_dwordx4 v12, s[4:7], s44 offen offset:3072 lds
MA 156,108,44
LW 4
MA 96,232,48
TR 60,207,4096
    s_add_u32 m0, s38, 16384
MA 100,236,48
TR 62,207,12288
    s_mov_b32 s44, 10551296
MA 160,104,48
    buffer_load_dwordx4 v9, s[4:7], s44 offen offset:0 lds
MA 164,108,48
LW 4
MA 104,232,52
    s_waitcnt vmcnt(53)
    s_barrier
TR 32,200,16384
MA 108,236,52
TR 34,200,24576
MA 168,104,52
    buffer_load_dwordx4 v10, s[4:7], s44 offen offset:1024 lds
MA 172,108,52
LW 4
MA 112,232,56
TR 36,201,16384
MA 116,236,56
TR 38,201,24576
MA 176,104,56
    buffer_load_dwordx4 v11, s[4:7], s44 offen offset:2048 lds
MA 180,108,56
LW 4
MA 120,232,60
TR 40,202,16384
MA 124,236,60
TR 42,202,24576
MA 184,104,60
    buffer_load_dwordx4 v12, s[4:7], s44 offen offset:3072 lds
MA 188,108,60
LW 4
MA 64,240,32
TR 44,203,16384
MA 68,244,32
TR 46,203,24576
MA 128,112,32
MA 132,116,32
LW 4
MA 72,240,36
TR 48,204,16384
MA 76,244,36
TR 50,204,24576
MA 136,112,36
MA 140,116,36
LW 4
MA 80,240,40
TR 52,205,16384
MA 84,244,40
TR 54,205,24576
MA 144,112,40
MA 148,116,40
LW 4
MA 88,240,44
TR 56,206,16384
MA 92,244,44
TR 58,206,24576
MA 152,112,44
MA 156,116,44
LW 4
MA 96,240,48
TR 60,207,16384
MA 100,244,48
TR 62,207,24576
MA 160,112,48
MA 164,116,48
LW 4
MA 104,240,52
TR 32,200,20480
MA 108,244,52
TR 34,200,28672
MA 168,112,52
MA 172,116,52
LW 4
MA 112,240,56
TR 36,201,20480
MA 116,244,56
TR 38,201,28672
MA 176,112,56
MA 180,116,56
LW 4
MA 120,240,60
TR 40,202,20480
MA 124,244,60
TR 42,202,28672
MA 184,112,60
MA 188,116,60
LW 4
MA 64,248,32
TR 44,203,20480
MA 68,252,32
TR 46,203,28672
MA 128,120,32
MA 132,124,32
LW 4
MA 72,248,36
TR 48,204,20480
MA 76,252,36
TR 50,204,28672
MA 136,120,36
MA 140,124,36
LW 4
MA 80,248,40
TR 52,205,20480
MA 84,252,40
TR 54,205,28672
MA 144,120,40
MA 148,124,40
LW 4
MA 88,248,44
TR 56,206,20480
MA 92,252,44
TR 58,206,28672
MA 152,120,44
MA 156,124,44
LW 4
MA 96,248,48
TR 60,207,20480
    s_mov_b32 s45, 90112
MA 100,252,48
TR 62,207,28672
MA 160,120,48
    buffer_load_dwordx4 a[64:67], v8, s[8:11], s45 offen offset:0 sc1
MA 164,124,48
LW 4
MA 104,248,52
    s_waitcnt vmcnt(41)
    s_barrier
TR 32,200,32768
MA 108,252,52
TR 34,200,40960
MA 168,120,52
    buffer_load_dwordx4 a[68:71], v8, s[8:11], s45 offen offset:1024 sc1
MA 172,124,52
LW 4
MA 112,248,56
TR 36,201,32768
MA 116,252,56
TR 38,201,40960
MA 176,120,56
    buffer_load_dwordx4 a[72:75], v8, s[8:11], s45 offen offset:2048 sc1
MA 180,124,56
LW 4
MA 120,248,60
TR 40,202,32768
MA 124,252,60
TR 42,202,40960
MA 184,120,60
    buffer_load_dwordx4 a[76:79], v8, s[8:11], s45 offen offset:3072 sc1
MA 188,124,60
LW 4
MA 64,128,32
TR 44,203,32768
    s_mov_b32 s45, 94208
MA 68,132,32
TR 46,203,40960
MA 128,0,32
    buffer_load_dwordx4 a[80:83], v8, s[8:11], s45 offen offset:0 sc1
MA 132,4,32
LW 4
MA 72,128,36
TR 48,204,32768
MA 76,132,36
TR 50,204,40960
MA 136,0,36
    buffer_load_dwordx4 a[84:87], v8, s[8:11], s45 offen offset:1024 sc1
MA 140,4,36
LW 4
MA 80,128,40
TR 52,205,32768
MA 84,132,40
TR 54,205,40960
MA 144,0,40
    buffer_load_dwordx4 a[88:91], v8, s[8:11], s45 offen offset:2048 sc1
MA 148,4,40
LW 4
MA 88,128,44
TR 56,206,32768
MA 92,132,44
TR 58,206,40960
MA 152,0,44
    buffer_load_dwordx4 a[92:95], v8, s[8:11], s45 offen offset:3072 sc1
MA 156,4,44
LW 4
MA 96,128,48
TR 60,207,32768
    s_add_u32 m0, s38, 32768
MA 100,132,48
TR 62,207,40960
    s_mov_b32 s44, 9175040
MA 160,0,48
    buffer_load_dwordx4 v9, s[4:7], s44 offen offset:0 lds
MA 164,4,48
LW 4
MA 104,128,52
TR 32,200,36864
MA 108,132,52
TR 34,200,45056
MA 168,0,52
    buffer_load_dwordx4 v10, s[4:7], s44 offen offset:1024 lds
MA 172,4,52
LW 4
MA 112,128,56
TR 36,201,36864
MA 116,132,56
TR 38,201,45056
MA 176,0,56
    buffer_load_dwordx4 v11, s[4:7], s44 offen offset:2048 lds
MA 180,4,56
LW 4
MA 120,128,60
TR 40,202,36864
MA 124,132,60
TR 42,202,45056
MA 184,0,60
    buffer_load_dwordx4 v12, s[4:7], s44 offen offset:3072 lds
MA 188,4,60
LW 4
MA 64,136,32
TR 44,203,36864
    s_add_u32 m0, s38, 49152
MA 68,140,32
TR 46,203,45056
    s_mov_b32 s44, 9633792
MA 128,8,32
    buffer_load_dwordx4 v9, s[4:7], s44 offen offset:0 lds
MA 132,12,32
LW 4
MA 72,136,36
TR 48,204,36864
MA 76,140,36
TR 50,204,45056
MA 136,8,36
    buffer_load_dwordx4 v10, s[4:7], s44 offen offset:1024 lds
MA 140,12,36
LW 4
MA 80,136,40
TR 52,205,36864
MA 84,140,40
TR 54,205,45056
MA 144,8,40
    buffer_load_dwordx4 v11, s[4:7], s44 offen offset:2048 lds
MA 148,12,40
LW 4
MA 88,136,44
TR 56,206,36864
MA 92,140,44
TR 58,206,45056
MA 152,8,44
    buffer_load_dwordx4 v12, s[4:7], s44 offen offset:3072 lds
MA 156,12,44
LW 4
MA 96,136,48
TR 60,207,36864
    s_mov_b32 s45, 81920
MA 100,140,48
TR 62,207,45056
MA 160,8,48
    buffer_load_dwordx4 a[96:99], v8, s[8:11], s45 offen offset:0 sc1
MA 164,12,48
LW 4
MA 104,136,52
    s_waitcnt vmcnt(49)
    s_barrier
TR 32,200,49152
MA 108,140,52
TR 34,200,57344
MA 168,8,52
    buffer_load_dwordx4 a[100:103], v8, s[8:11], s45 offen offset:1024 sc1
MA 172,12,52
LW 4
MA 112,136,56
TR 36,201,49152
MA 116,140,56
TR 38,201,57344
MA 176,8,56
    buffer_load_dwordx4 a[104:107], v8, s[8:11], s45 offen offset:2048 sc1
MA 180,12,56
LW 4
MA 120,136,60
TR 40,202,49152
MA 124,140,60
TR 42,202,57344
MA 184,8,60
    buffer_load_dwordx4 a[108:111], v8, s[8:11], s45 offen offset:3072 sc1
MA 188,12,60
LW 4
MA 64,144,32
TR 44,203,49152
    s_mov_b32 s45, 86016
MA 68,148,32
TR 46,203,57344
MA 128,16,32
    buffer_load_dwordx4 a[112:115], v8, s[8:11], s45 offen offset:0 sc1
MA 132,20,32
LW 4
MA 72,144,36
TR 48,204,49152
MA 76,148,36
TR 50,204,57344
MA 136,16,36
    buffer_load_dwordx4 a[116:119], v8, s[8:11], s45 offen offset:1024 sc1
MA 140,20,36
LW 4
MA 80,144,40
TR 52,205,49152
MA 84,148,40
TR 54,205,57344
MA 144,16,40
    buffer_load_dwordx4 a[120:123], v8, s[8:11], s45 offen offset:2048 sc1
MA 148,20,40
LW 4
MA 88,144,44
TR 56,206,49152
MA 92,148,44
TR 58,206,57344
MA 152,16,44
    buffer_load_dwordx4 a[124:127], v8, s[8:11], s45 offen offset:3072 sc1
MA 156,20,44
LW 4
MA 96,144,48
TR 60,207,49152
    s_add_u32 m0, s38, 65536
MA 100,148,48
TR 62,207,57344
    s_mov_b32 s44, 11010048
MA 160,16,48
    buffer_load_dwordx4 v9, s[4:7], s44 offen offset:0 lds
MA 164,20,48
LW 4
MA 104,144,52
TR 32,200,53248
MA 108,148,52
TR 34,200,61440
MA 168,16,52
    buffer_load_dwordx4 v10, s[4:7], s44 offen offset:1024 lds
MA 172,20,52
LW 4
MA 112,144,56
TR 36,201,53248
MA 116,148,56
TR 38,201,61440
MA 176,16,56
    buffer_load_dwordx4 v11, s[4:7], s44 offen offset:2048 lds
MA 180,20,56
LW 4
MA 120,144,60
TR 40,202,53248
MA 124,148,60
TR 42,202,61440
MA 184,16,60
    buffer_load_dwordx4 v12, s[4:7], s44 offen offset:3072 lds
MA 188,20,60
LW 4
MA 64,152,32
TR 44,203,53248
    s_add_u32 m0, s38, 81920
MA 68,156,32
TR 46,203,61440
    s_mov_b32 s44, 11468800
MA 128,24,32
    buffer_load_dwordx4 v9, s[4:7], s44 offen offset:0 lds
MA 132,28,32
LW 4
MA 72,152,36
TR 48,204,53248
MA 76,156,36
TR 50,204,61440
MA 136,24,36
    buffer_load_dwordx4 v10, s[4:7], s44 offen offset:1024 lds
MA 140,28,36
LW 4
MA 80,152,40
TR 52,205,53248
MA 84,156,40
TR 54,205,61440
MA 144,24,40
    buffer_load_dwordx4 v11, s[4:7], s44 offen offset:2048 lds
MA 148,28,40
LW 4
MA 88,152,44
TR 56,206,53248
MA 92,156,44
TR 58,206,61440
MA 152,24,44
    buffer_load_dwordx4 v12, s[4:7], s44 offen offset:3072 lds
MA 156,28,44
LW 4
MA 96,152,48
TR 60,207,53248
    s_mov_b32 s45, 98304
MA 100,156,48
TR 62,207,61440
MA 160,24,48
    buffer_load_dwordx4 a[0:3], v8, s[8:11], s45 offen offset:0 sc1
MA 164,28,48
LW 4
MA 104,152,52
    s_waitcnt vmcnt(49)
    s_barrier
TR 32,208,0
MA 108,156,52
TR 34,208,8192
MA 168,24,52
    buffer_load_dwordx4 a[4:7], v8, s[8:11], s45 offen offset:1024 sc1
MA 172,28,52
LW 4
MA 112,152,56
TR 36,209,0
MA 116,156,56
TR 38,209,8192
MA 176,24,56
    buffer_load_dwordx4 a[8:11], v8, s[8:11], s45 offen offset:2048 sc1
MA 180,28,56
LW 4
MA 120,152,60
TR 40,210,0
MA 124,156,60
TR 42,210,8192
MA 184,24,60
    buffer_load_dwordx4 a[12:15], v8, s[8:11], s45 offen offset:3072 sc1
MA 188,28,60
LW 4
MA 64,160,32
TR 44,211,0
    s_mov_b32 s45, 102400
MA 68,164,32
TR 46,211,8192
MA 128,32,32
    buffer_load_dwordx4 a[16:19], v8, s[8:11], s45 offen offset:0 sc1
MA 132,36,32
LW 4
MA 72,160,36
TR 48,212,0
MA 76,164,36
TR 50,212,8192
MA 136,32,36
    buffer_load_dwordx4 a[20:23], v8, s[8:11], s45 offen offset:1024 sc1
MA 140,36,36
LW 4
MA 80,160,40
TR 52,213,0
MA 84,164,40
TR 54,213,8192
MA 144,32,40
    buffer_load_dwordx4 a[24:27], v8, s[8:11], s45 offen offset:2048 sc1
MA 148,36,40
LW 4
MA 88,160,44
TR 56,214,0
MA 92,164,44
TR 58,214,8192
MA 152,32,44
    buffer_load_dwordx4 a[28:31], v8, s[8:11], s45 offen offset:3072 sc1
MA 156,36,44
LW 4
MA 96,160,48
TR 60,215,0
    s_add_u32 m0, s38, 98304
MA 100,164,48
TR 62,215,8192
    s_mov_b32 s44, 11927552
MA 160,32,48
    buffer_load_dwordx4 v9, s[4:7], s44 offen offset:0 lds
MA 164,36,48
LW 4
MA 104,160,52
TR 32,208,4096
MA 108,164,52
TR 34,208,12288
MA 168,32,52
    buffer_load_dwordx4 v10, s[4:7], s44 offen offset:1024 lds
MA 172,36,52
LW 4
MA 112,160,56
TR 36,209,4096
MA 116,164,56
TR 38,209,12288
MA 176,32,56
    buffer_load_dwordx4 v11, s[4:7], s44 offen offset:2048 lds
MA 180,36,56
LW 4
MA 120,160,60
TR 40,210,4096
MA 124,164,60
TR 42,210,12288
MA 184,32,60
    buffer_load_dwordx4 v12, s[4:7], s44 offen offset:3072 lds
MA 188,36,60
LW 4
MA 64,168,32
TR 44,211,4096
MA 68,172,32
TR 46,211,12288
MA 128,40,32
MA 132,44,32
LW 4
MA 72,168,36
TR 48,212,4096
MA 76,172,36
TR 50,212,12288
MA 136,40,36
MA 140,44,36
LW 4
MA 80,168,40
TR 52,213,4096
MA 84,172,40
TR 54,213,12288
MA 144,40,40
MA 148,44,40
LW 4
MA 88,168,44
TR 56,214,4096
MA 92,172,44
TR 58,214,12288
MA 152,40,44
MA 156,44,44
LW 4
MA 96,168,48
TR 60,215,4096
MA 100,172,48
TR 62,215,12288
MA 160,40,48
MA 164,44,48
LW 4
MA 104,168,52
    s_waitcnt vmcnt(52)
    s_barrier
TR 32,208,16384
MA 108,172,52
TR 34,208,24576
MA 168,40,52
MA 172,44,52
LW 4
MA 112,168,56
TR 36,209,16384
MA 116,172,56
TR 38,209,24576
MA 176,40,56
MA 180,44,56
LW 4
MA 120,168,60
TR 40,210,16384
MA 124,172,60
TR 42,210,24576
MA 184,40,60
MA 188,44,60
LW 4
MA 64,176,32
TR 44,211,16384
    s_add_u32 m0, s38, 114688
MA 68,180,32
TR 46,211,24576
    s_mov_b32 s44, 12386304
MA 128,48,32
    buffer_load_dwordx4 v9, s[4:7], s44 offen offset:0 lds
MA 132,52,32
    s_mov_b32 s46, 90112
LW 4
MA 72,176,36
TR 48,212,16384
MA 76,180,36
TR 50,212,24576
MA 136,48,36
    buffer_load_dwordx4 v10, s[4:7], s44 offen offset:1024 lds
MA 140,52,36
    s_mov_b32 s47, 81920
LW 4
MA 80,176,40
TR 52,213,16384
MA 84,180,40
TR 54,213,24576
MA 144,48,40
    buffer_load_dwordx4 v11, s[4:7], s44 offen offset:2048 lds
MA 148,52,40
    s_mov_b32 s48, 98304
LW 4
MA 88,176,44
TR 56,214,16384
MA 92,180,44
TR 58,214,24576
MA 152,48,44
    buffer_load_dwordx4 v12, s[4:7], s44 offen offset:3072 lds
MA 156,52,44
    s_mov_b32 s49, 106496
LW 4
MA 96,176,48
TR 60,215,16384
    s_mov_b32 s45, 106496
MA 100,180,48
TR 62,215,24576
MA 160,48,48
    buffer_load_dwordx4 a[32:35], v8, s[8:11], s45 offen offset:0 sc1
MA 164,52,48
LW 4
MA 104,176,52
TR 32,208,20480
MA 108,180,52
TR 34,208,28672
MA 168,48,52
    buffer_load_dwordx4 a[36:39], v8, s[8:11], s45 offen offset:1024 sc1
MA 172,52,52
LW 4
MA 112,176,56
TR 36,209,20480
MA 116,180,56
TR 38,209,28672
MA 176,48,56
    buffer_load_dwordx4 a[40:43], v8, s[8:11], s45 offen offset:2048 sc1
MA 180,52,56
LW 4
MA 120,176,60
TR 40,210,20480
MA 124,180,60
TR 42,210,28672
MA 184,48,60
    buffer_load_dwordx4 a[44:47], v8, s[8:11], s45 offen offset:3072 sc1
MA 188,52,60
LW 4
MA 64,184,32
TR 44,211,20480
MA 68,188,32
TR 46,211,28672
MA 128,56,32
MA 132,60,32
LW 4
MA 72,184,36
TR 48,212,20480
MA 76,188,36
TR 50,212,28672
MA 136,56,36
MA 140,60,36
LW 4
MA 80,184,40
TR 52,213,20480
MA 84,188,40
TR 54,213,28672
MA 144,56,40
MA 148,60,40
LW 4
MA 88,184,44
TR 56,214,20480
MA 92,188,44
TR 58,214,28672
MA 152,56,44
MA 156,60,44
LW 4
MA 96,184,48
TR 60,215,20480
MA 100,188,48
TR 62,215,28672
MA 160,56,48
MA 164,60,48
LW 4
MA 104,184,52
    s_waitcnt vmcnt(28)
    s_barrier
TR 32,192,0
MA 108,188,52
TR 34,192,8192
MA 168,56,52
MA 172,60,52
LW 4
MA 112,184,56
TR 36,193,0
MA 116,188,56
TR 38,193,8192
MA 176,56,56
MA 180,60,56
LW 4
MA 120,184,60
TR 40,192,4096
MA 124,188,60
TR 42,192,12288
MA 184,56,60
TR 44,193,4096
MA 188,60,60
TR 46,193,12288
    s_branch L_pass
L_miss31:
    s_mov_b32 s39, 4194304
    s_branch L_pld33
L_poll33:
    s_sub_u32 s39, s39, 1
    s_cbranch_scc1 L_exit0
    s_sleep 1
L_pld33:
    buffer_load_dwordx2 v[26:27], v22, s[8:11], 0 offen offset:128 sc1
    s_waitcnt vmcnt(0)
L_pchk33:
    v_cmp_ne_u64 vcc, s[56:57], v[26:27]
    s_nop 1
    s_cmp_lg_u64 vcc, 0
    s_cbranch_scc1 L_poll33
    s_branch L_back31
L_miss32:
    s_mov_b32 s39, 4194304
    s_branch L_pld34
L_poll34:
    s_sub_u32 s39, s39, 1
    s_cbranch_scc1 L_exit0
    s_sleep 1
L_pld34:
    buffer_load_dwordx2 v[26:27], v22, s[8:11], 0 offen offset:256 sc1
    s_waitcnt vmcnt(0)
L_pchk34:
    v_cmp_ne_u64 vcc, s[56:57], v[26:27]
    s_nop 1
    s_cmp_lg_u64 vcc, 0
    s_cbranch_scc1 L_poll34
    s_branch L_back32
L_pass:
    s_mov_b32 s66, 0xffff0000
LW 4
MA 128,64,32
TR 48,192,16384
    s_add_u32 s45, s49, 4096
MA 132,68,32
TR 50,192,24576
MA 136,64,36
TR 52,193,16384
    buffer_load_dwordx4 a[48:51], v8, s[8:11], s45 offen offset:0 sc1
MA 140,68,36
TR 54,193,24576
LW 4
MA 128,72,40
TR 56,192,20480
MA 132,76,40
TR 58,192,28672
MA 136,72,44
TR 60,193,20480
    buffer_load_dwordx4 a[52:55], v8, s[8:11], s45 offen offset:1024 sc1
MA 140,76,44
TR 62,193,28672
    s_waitcnt vmcnt(46)
LW 4
MA 128,80,48
TR 32,192,32768
MA 132,84,48
TR 34,192,40960
MA 136,80,52
TR 36,193,32768
    buffer_load_dwordx4 a[56:59], v8, s[8:11], s45 offen offset:2048 sc1
MA 140,84,52
TR 38,193,40960
LW 4
MA 128,88,56
TR 40,192,36864
MA 132,92,56
TR 42,192,45056
MA 136,88,60
TR 44,193,36864
    buffer_load_dwordx4 a[60:63], v8, s[8:11], s45 offen offset:3072 sc1
MA 140,92,60
TR 46,193,45056
    s_waitcnt vmcnt(36)
LW 4
MA 128,96,32
TR 48,192,49152
    s_add_u32 s45, s46, 0
MA 132,100,32
TR 50,192,57344
MA 136,96,36
TR 52,193,49152
    buffer_load_dwordx4 a[192:195], v7, s[8:11], s45 offen offset:0 sc1
MA 140,100,36
TR 54,193,57344
LW 4
MA 128,104,40
TR 56,192,53248
MA 132,108,40
TR 58,192,61440
MA 136,104,44
TR 60,193,53248
    buffer_load_dwordx4 a[196:199], v7, s[8:11], s45 offen offset:1024 sc1
MA 140,108,44
TR 62,193,61440
    s_waitcnt vmcnt(34)
LW 4
MA 128,112,48
    s_waitcnt vmcnt(10)
    s_barrier
TR 32,200,0
MA 132,116,48
TR 34,200,8192
MA 136,112,52
TR 36,201,0
    buffer_load_dwordx4 a[200:203], v7, s[8:11], s45 offen offset:2048 sc1
MA 140,116,52
TR 38,201,8192
LW 4
MA 128,120,56
TR 40,200,4096
MA 132,124,56
TR 42,200,12288
MA 136,120,60
TR 44,201,4096
    buffer_load_dwordx4 a[204:207], v7, s[8:11], s45 offen offset:3072 sc1
MA 140,124,60
TR 46,201,12288
LW 4
MA 128,0,32
TR 48,200,16384
    s_add_u32 s45, s46, 4096
MA 132,4,32
TR 50,200,24576
MA 136,0,36
TR 52,201,16384
    buffer_load_dwordx4 a[208:211], v7, s[8:11], s45 offen offset:0 sc1
MA 140,4,36
TR 54,201,24576
LW 4
MA 128,8,40
TR 56,200,20480
MA 132,12,40
TR 58,200,28672
MA 136,8,44
TR 60,201,20480
    buffer_load_dwordx4 a[212:215], v7, s[8:11], s45 offen offset:1024 sc1
MA 140,12,44
TR 62,201,28672
LW 4
MA 128,16,48
TR 32,200,32768
MA 132,20,48
TR 34,200,40960
MA 136,16,52
TR 36,201,32768
    buffer_load_dwordx4 a[216:219], v7, s[8:11], s45 offen offset:2048 sc1
MA 140,20,52
TR 38,201,40960
LW 4
MA 128,24,56
TR 40,200,36864
MA 132,28,56
TR 42,200,45056
MA 136,24,60
TR 44,201,36864
    buffer_load_dwordx4 a[220:223], v7, s[8:11], s45 offen offset:3072 sc1
MA 140,28,60
TR 46,201,45056
    s_waitcnt vmcnt(12)
LW 4
MA 128,32,32
TR 48,200,49152
    s_add_u32 s45, s47, 0
MA 132,36,32
TR 50,200,57344
MA 136,32,36
TR 52,201,49152
    buffer_load_dwordx4 a[224:227], v7, s[8:11], s45 offen offset:0 sc1
MA 140,36,36
TR 54,201,57344
LW 4
MA 128,40,40
TR 56,200,53248
MA 132,44,40
TR 58,200,61440
MA 136,40,44
TR 60,201,53248
    buffer_load_dwordx4 a[228:231], v7, s[8:11], s45 offen offset:1024 sc1
MA 140,44,44
TR 62,201,61440
    s_waitcnt vmcnt(10)
LW 4
MA 128,48,48
TR 32,194,0
MA 132,52,48
TR 34,194,8192
MA 136,48,52
TR 36,195,0
    buffer_load_dwordx4 a[232:235], v7, s[8:11], s45 offen offset:2048 sc1
MA 140,52,52
TR 38,195,8192
LW 4
MA 128,56,56
TR 40,194,4096
MA 132,60,56
TR 42,194,12288
MA 136,56,60
TR 44,195,4096
    buffer_load_dwordx4 a[236:239], v7, s[8:11], s45 offen offset:3072 sc1
MA 140,60,60
TR 46,195,12288
LW 4
MA 144,64,32
TR 48,194,16384
MA 148,68,32
TR 50,194,24576
MA 152,64,36
TR 52,195,16384
MA 156,68,36
TR 54,195,24576
LW 4
MA 144,72,40
TR 56,194,20480
    v_cvt_pk_bf16_f32 v128, v128, v129
    v_cvt_pk_bf16_f32 v129, v130, v131
MA 148,76,40
TR 58,194,28672
    v_cvt_pk_bf16_f32 v130, v132, v133
    v_cvt_pk_bf16_f32 v131, v134, v135
MA 152,72,44
TR 60,195,20480
    buffer_store_dwordx4 v[128:131], v1, s[8:11], s41 offen offset:0 sc1
    v_cvt_pk_bf16_f32 v136, v136, v137
MA 156,76,44
TR 62,195,28672
    v_cvt_pk_bf16_f32 v137, v138, v139
LW 4
MA 144,80,48
TR 32,194,32768
    v_cvt_pk_bf16_f32 v138, v140, v141
    v_cvt_pk_bf16_f32 v139, v142, v143
MA 148,84,48
TR 34,194,40960
    buffer_store_dwordx4 v[136:139], v1, s[8:11], s41 offen offset:1024 sc1
    s_add_u32 s41, s41, 2048
MA 152,80,52
TR 36,195,32768
    s_add_u32 s45, s47, 4096
MA 156,84,52
TR 38,195,40960
LW 4
MA 144,88,56
TR 40,194,36864
MA 148,92,56
TR 42,194,45056
MA 152,88,60
TR 44,195,36864
    buffer_load_dwordx4 a[240:243], v7, s[8:11], s45 offen offset:0 sc1
MA 156,92,60
TR 46,195,45056
LW 4
MA 144,96,32
TR 48,194,49152
MA 148,100,32
TR 50,194,57344
MA 152,96,36
TR 52,195,49152
    buffer_load_dwordx4 a[244:247], v7, s[8:11], s45 offen offset:1024 sc1
MA 156,100,36
TR 54,195,57344
LW 4
MA 144,104,40
TR 56,194,53248
MA 148,108,40
TR 58,194,61440
MA 152,104,44
TR 60,195,53248
    buffer_load_dwordx4 a[248:251], v7, s[8:11], s45 offen offset:2048 sc1
MA 156,108,44
TR 62,195,61440
LW 4
MA 144,112,48
TR 32,202,0
MA 148,116,48
TR 34,202,8192
MA 152,112,52
TR 36,203,0
    buffer_load_dwordx4 a[252:255], v7, s[8:11], s45 offen offset:3072 sc1
MA 156,116,52
TR 38,203,8192
LW 4
MA 144,120,56
TR 40,202,4096
    s_add_u32 s45, s48, 0
MA 148,124,56
TR 42,202,12288
MA 152,120,60
TR 44,203,4096
    buffer_load_dwordx4 a[128:131], v7, s[8:11], s45 offen offset:0 sc1
MA 156,124,60
TR 46,203,12288
LW 4
MA 144,0,32
TR 48,202,16384
MA 148,4,32
TR 50,202,24576
MA 152,0,36
TR 52,203,16384
    buffer_load_dwordx4 a[132:135], v7, s[8:11], s45 offen offset:1024 sc1
MA 156,4,36
TR 54,203,24576
LW 4
MA 144,8,40
TR 56,202,20480
MA 148,12,40
TR 58,202,28672
MA 152,8,44
TR 60,203,20480
    buffer_load_dwordx4 a[136:139], v7, s[8:11], s45 offen offset:2048 sc1
MA 156,12,44
TR 62,203,28672
LW 4
MA 144,16,48
TR 32,202,32768
MA 148,20,48
TR 34,202,40960
MA 152,16,52
TR 36,203,32768
    buffer_load_dwordx4 a[140:143], v7, s[8:11], s45 offen offset:3072 sc1
MA 156,20,52
TR 38,203,40960
LW 4
MA 144,24,56
TR 40,202,36864
    s_add_u32 s45, s48, 4096
MA 148,28,56
TR 42,202,45056
MA 152,24,60
TR 44,203,36864
    buffer_load_dwordx4 a[144:147], v7, s[8:11], s45 offen offset:0 sc1
MA 156,28,60
TR 46,203,45056
LW 4
MA 144,32,32
TR 48,202,49152
MA 148,36,32
TR 50,202,57344
MA 152,32,36
TR 52,203,49152
    buffer_load_dwordx4 a[148:151], v7, s[8:11], s45 offen offset:1024 sc1
MA 156,36,36
TR 54,203,57344
LW 4
MA 144,40,40
TR 56,202,53248
MA 148,44,40
TR 58,202,61440
MA 152,40,44
TR 60,203,53248
    buffer_load_dwordx4 a[152:155], v7, s[8:11], s45 offen offset:2048 sc1
MA 156,44,44
TR 62,203,61440
LW 4
MA 144,48,48
TR 32,196,0
MA 148,52,48
TR 34,196,8192
MA 152,48,52
TR 36,197,0
    buffer_load_dwordx4 a[156:159], v7, s[8:11], s45 offen offset:3072 sc1
MA 156,52,52
TR 38,197,8192
LW 4
MA 144,56,56
TR 40,196,4096
    s_add_u32 s45, s49, 0
MA 148,60,56
TR 42,196,12288
MA 152,56,60
TR 44,197,4096
    buffer_load_dwordx4 a[160:163], v7, s[8:11], s45 offen offset:0 sc1
MA 156,60,60
TR 46,197,12288
LW 4
MA 160,64,32
TR 48,196,16384
MA 164,68,32
TR 50,196,24576
MA 168,64,36
TR 52,197,16384
MA 172,68,36
TR 54,197,24576
LW 4
MA 160,72,40
TR 56,196,20480
    v_cvt_pk_bf16_f32 v144, v144, v145
    v_cvt_pk_bf16_f32 v145, v146, v147
MA 164,76,40
TR 58,196,28672
    v_cvt_pk_bf16_f32 v146, v148, v149
    v_cvt_pk_bf16_f32 v147, v150, v151
MA 168,72,44
TR 60,197,20480
    buffer_store_dwordx4 v[144:147], v1, s[8:11], s41 offen offset:0 sc1
    v_cvt_pk_bf16_f32 v152, v152, v153
MA 172,76,44
TR 62,197,28672
    v_cvt_pk_bf16_f32 v153, v154, v155
LW 4
MA 160,80,48
TR 32,196,32768
    v_cvt_pk_bf16_f32 v154, v156, v157
    v_cvt_pk_bf16_f32 v155, v158, v159
MA 164,84,48
TR 34,196,40960
    buffer_store_dwordx4 v[152:155], v1, s[8:11], s41 offen offset:1024 sc1
    s_add_u32 s41, s41, 2048
MA 168,80,52
TR 36,197,32768
    buffer_load_dwordx4 a[164:167], v7, s[8:11], s45 offen offset:1024 sc1
MA 172,84,52
TR 38,197,40960
LW 4
MA 160,88,56
TR 40,196,36864
MA 164,92,56
TR 42,196,45056
MA 168,88,60
TR 44,197,36864
    buffer_load_dwordx4 a[168:171], v7, s[8:11], s45 offen offset:2048 sc1
MA 172,92,60
TR 46,197,45056
LW 4
MA 160,96,32
TR 48,196,49152
    s_waitcnt vmcnt(17)
    s_mov_b64 exec, 0xffff
    buffer_store_dwordx2 v[4:5], v29, s[8:11], s43 offen offset:0 sc1
    s_mov_b64 exec, -1
MA 164,100,32
TR 50,196,57344
MA 168,96,36
TR 52,197,49152
    buffer_load_dwordx4 a[172:175], v7, s[8:11], s45 offen offset:3072 sc1
MA 172,100,36
TR 54,197,57344
LW 4
MA 160,104,40
TR 56,196,53248
    s_add_u32 s45, s49, 4096
MA 164,108,40
TR 58,196,61440
MA 168,104,44
TR 60,197,53248
    buffer_load_dwordx4 a[176:179], v7, s[8:11], s45 offen offset:0 sc1
MA 172,108,44
TR 62,197,61440
LW 4
MA 160,112,48
TR 32,204,0
MA 164,116,48
TR 34,204,8192
MA 168,112,52
TR 36,205,0
    buffer_load_dwordx4 a[180:183], v7, s[8:11], s45 offen offset:1024 sc1
MA 172,116,52
TR 38,205,8192
LW 4
MA 160,120,56
TR 40,204,4096
MA 164,124,56
TR 42,204,12288
MA 168,120,60
TR 44,205,4096
    buffer_load_dwordx4 a[184:187], v7, s[8:11], s45 offen offset:2048 sc1
MA 172,124,60
TR 46,205,12288
LW 4
MA 160,0,32
TR 48,204,16384
MA 164,4,32
TR 50,204,24576
MA 168,0,36
TR 52,205,16384
    buffer_load_dwordx4 a[188:191], v7, s[8:11], s45 offen offset:3072 sc1
MA 172,4,36
TR 54,205,24576
LW 4
MA 160,8,40
TR 56,204,20480
    s_mov_b32 s12, s98
MA 164,12,40
TR 58,204,28672
    s_mov_b32 s13, s99
MA 168,8,44
TR 60,205,20480
    s_mov_b32 s14, 14680064
MA 172,12,44
TR 62,205,28672
LW 4
MA 160,16,48
TR 32,204,32768
    s_mul_i32 s64, s61, 7
MA 164,20,48
TR 34,204,40960
    s_and_b32 s65, s64, 3
MA 168,16,52
TR 36,205,32768
    s_mov_b32 s101, 0x6f2a60
MA 172,20,52
TR 38,205,40960
LW 4
MA 160,24,56
TR 40,204,36864
    s_cmp_eq_u32 s65, 1
    s_cselect_b32 s101, 0xd95303, s101
MA 164,28,56
TR 42,204,45056
    s_cmp_eq_u32 s65, 2
    s_cselect_b32 s101, 0xb4c0f2, s101
MA 168,24,60
TR 44,205,36864
    s_cmp_eq_u32 s65, 3
    s_cselect_b32 s101, 0x903ca9, s101
MA 172,28,60
TR 46,205,45056
LW 4
MA 160,32,32
TR 48,204,49152
    v_lshrrev_b32 v21, 3, v0
MA 164,36,32
TR 50,204,57344
    v_mul_u32_u24 v21, 3, v21
MA 168,32,36
TR 52,205,49152
    v_lshrrev_b32 v21, v21, s101
MA 172,36,36
TR 54,205,57344
LW 4
MA 160,40,40
TR 56,204,53248
    v_and_b32 v21, 7, v21
MA 164,44,40
TR 58,204,61440
    v_add_u32 v21, s64, v21
MA 168,40,44
TR 60,205,53248
    v_and_b32 v31, 7, v0
MA 172,44,44
TR 62,205,61440
LW 4
MA 160,48,48
TR 32,198,0
    v_lshl_add_u32 v21, v21, 3, v31
MA 164,52,48
TR 34,198,8192
    v_lshlrev_b32 v21, 7, v21
MA 168,48,52
TR 36,199,0
    v_add_u32 v21, 29622272, v21
MA 172,52,52
TR 38,199,8192
LW 4
MA 160,56,56
TR 40,198,4096
    s_bfe_u32 s20, s101, 0x30000
MA 164,60,56
TR 42,198,12288
    s_lshl_b32 s20, s20, 16
MA 168,56,60
TR 44,199,4096
    s_bfe_u32 s21, s101, 0x30003
MA 172,60,60
TR 46,199,12288
LW 4
MA 176,64,32
TR 48,198,16384
MA 180,68,32
TR 50,198,24576
MA 184,64,36
TR 52,199,16384
MA 188,68,36
TR 54,199,24576
LW 4
MA 176,72,40
TR 56,198,20480
    v_cvt_pk_bf16_f32 v160, v160, v161
    v_cvt_pk_bf16_f32 v161, v162, v163
MA 180,76,40
TR 58,198,28672
    v_cvt_pk_bf16_f32 v162, v164, v165
    v_cvt_pk_bf16_f32 v163, v166, v167
MA 184,72,44
TR 60,199,20480
    buffer_store_dwordx4 v[160:163], v1, s[8:11], s41 offen offset:0 sc1
    v_cvt_pk_bf16_f32 v168, v168, v169
MA 188,76,44
TR 62,199,28672
    v_cvt_pk_bf16_f32 v169, v170, v171
LW 4
MA 176,80,48
TR 32,198,32768
    v_cvt_pk_bf16_f32 v170, v172, v173
    v_cvt_pk_bf16_f32 v171, v174, v175
MA 180,84,48
TR 34,198,40960
    buffer_store_dwordx4 v[168:171], v1, s[8:11], s41 offen offset:1024 sc1
    s_add_u32 s41, s41, 2048
MA 184,80,52
TR 36,199,32768
    s_lshl_b32 s21, s21, 16
MA 188,84,52
TR 38,199,40960
LW 4
MA 176,88,56
TR 40,198,36864
    s_bfe_u32 s22, s101, 0x30006
MA 180,92,56
TR 42,198,45056
    s_lshl_b32 s22, s22, 16
MA 184,88,60
TR 44,199,36864
    s_bfe_u32 s23, s101, 0x30009
MA 188,92,60
TR 46,199,45056
LW 4
MA 176,96,32
TR 48,198,49152
    s_waitcnt vmcnt(10)
    s_mov_b64 exec, 0xffff
    buffer_store_dwordx2 v[4:5], v29, s[8:11], s43 offen offset:128 sc1
    s_mov_b64 exec, -1
MA 180,100,32
TR 50,198,57344
    s_lshl_b32 s23, s23, 16
MA 184,96,36
TR 52,199,49152
    s_bfe_u32 s24, s101, 0x3000c
MA 188,100,36
TR 54,199,57344
LW 4
MA 176,104,40
TR 56,198,53248
    s_lshl_b32 s24, s24, 16
MA 180,108,40
TR 58,198,61440
    s_bfe_u32 s25, s101, 0x3000f
MA 184,104,44
TR 60,199,53248
    s_lshl_b32 s25, s25, 16
MA 188,108,44
TR 62,199,61440
LW 4
MA 176,112,48
TR 32,206,0
    s_bfe_u32 s26, s101, 0x30012
MA 180,116,48
TR 34,206,8192
    s_lshl_b32 s26, s26, 16
MA 184,112,52
TR 36,207,0
    v_lshlrev_b32 v16, 4, v0
MA 188,116,52
TR 38,207,8192
LW 4
MA 176,120,56
TR 40,206,4096
    v_add_u32 v17, 0x10000, v16
MA 180,124,56
TR 42,206,12288
    v_add_u32 v18, 0x20000, v16
MA 184,120,60
TR 44,207,4096
    s_mul_i32 s64, s61, 458752
MA 188,124,60
TR 46,207,12288
LW 4
MA 176,0,32
TR 48,206,16384
    buffer_load_dwordx2 v[14:15], v13, s[8:11], 0 offen offset:0 sc1
    buffer_load_dwordx2 v[10:11], v3, s[8:11], 0 offen offset:0 sc1
MA 180,4,32
TR 50,206,24576
    s_add_u32 s64, s64, s38
MA 184,0,36
TR 52,207,16384
    s_add_u32 s64, s64, 8388608
MA 188,4,36
TR 54,207,24576
LW 4
MA 176,8,40
TR 56,206,20480
    v_add_u32 v19, s64, v16
MA 180,12,40
TR 58,206,28672
    v_and_b32 v31, 15, v0
MA 184,8,44
TR 60,207,20480
    v_mul_u32_u24 v31, 7168, v31
MA 188,12,44
TR 62,207,28672
LW 4
MA 176,16,48
TR 32,206,32768
    v_lshrrev_b32 v30, 4, v0
MA 180,20,48
TR 34,206,40960
    v_lshl_add_u32 v20, v30, 4, v31
MA 184,16,52
TR 36,207,32768
    s_lshl_b32 s64, s60, 2
MA 188,20,52
TR 38,207,40960
LW 4
MA 176,24,56
TR 40,206,36864
    s_add_u32 s64, s64, s32
MA 180,28,56
TR 42,206,45056
    s_mul_i32 s27, s64, 229376
MA 184,24,60
TR 44,207,36864
    s_mul_i32 s65, s61, 448
MA 188,28,60
TR 46,207,45056
LW 4
MA 176,32,32
TR 48,206,49152
    s_add_u32 s27, s27, s65
MA 180,36,32
TR 50,206,57344
MA 184,32,36
TR 52,207,49152
MA 188,36,36
TR 54,207,57344
LW 4
MA 176,40,40
TR 56,206,53248
MA 180,44,40
TR 58,206,61440
MA 184,40,44
TR 60,207,53248
MA 188,44,44
TR 62,207,61440
LW 4
MA 176,48,48
TR 32,192,0
MA 180,52,48
TR 34,192,8192
MA 184,48,52
TR 36,193,0
MA 188,52,52
TR 38,193,8192
LW 4
MA 176,56,56
TR 40,192,4096
MA 180,60,56
TR 42,192,12288
MA 184,56,60
TR 44,193,4096
MA 188,60,60
TR 46,193,12288
    s_waitcnt vmcnt(5)
LW 4
MA 64,192,32
TR 48,192,16384
MA 68,196,32
TR 50,192,24576
MA 72,192,36
TR 52,193,16384
MA 76,196,36
TR 54,193,24576
LW 4
MA 64,200,40
TR 56,192,20480
    v_cvt_pk_bf16_f32 v176, v176, v177
    v_cvt_pk_bf16_f32 v177, v178, v179
MA 68,204,40
TR 58,192,28672
    v_cvt_pk_bf16_f32 v178, v180, v181
    v_cvt_pk_bf16_f32 v179, v182, v183
MA 72,200,44
TR 60,193,20480
    buffer_store_dwordx4 v[176:179], v1, s[8:11], s41 offen offset:0 sc1
    v_cvt_pk_bf16_f32 v184, v184, v185
MA 76,204,44
TR 62,193,28672
    v_cvt_pk_bf16_f32 v185, v186, v187
LW 4
MA 64,208,48
TR 32,192,32768
    v_cvt_pk_bf16_f32 v186, v188, v189
    v_cvt_pk_bf16_f32 v187, v190, v191
MA 68,212,48
TR 34,192,40960
    buffer_store_dwordx4 v[184:187], v1, s[8:11], s41 offen offset:1024 sc1
    s_add_u32 s41, s41, 2048
MA 72,208,52
TR 36,193,32768
MA 76,212,52
TR 38,193,40960
LW 4
MA 64,216,56
TR 40,192,36864
MA 68,220,56
TR 42,192,45056
MA 72,216,60
TR 44,193,36864
MA 76,220,60
TR 46,193,45056
LW 4
MA 64,224,32
TR 48,192,49152
    s_waitcnt vmcnt(5)
    s_mov_b64 exec, 0xffff
    buffer_store_dwordx2 v[4:5], v29, s[8:11], s43 offen offset:256 sc1
    s_mov_b64 exec, -1
MA 68,228,32
TR 50,192,57344
MA 72,224,36
TR 52,193,49152
    s_waitcnt vmcnt(4)
    v_cmp_ne_u64 vcc, s[56:57], v[14:15]
    s_nop 1
    s_cmp_lg_u64 vcc, 0
    s_cbranch_scc1 L_miss35
L_back35:
    buffer_load_dwordx4 v[216:219], v1, s[8:11], s42 offen offset:0 sc1
    buffer_load_dwordx4 v[220:223], v1, s[8:11], s42 offen offset:1024 sc1
    s_add_u32 s42, s42, 2048
    s_waitcnt vmcnt(5)
    v_cmp_ne_u64 vcc, s[56:57], v[10:11]
    s_mov_b32 s16, s8
    s_mov_b32 s17, s9
    s_cmp_eq_u64 vcc, 0
    s_cselect_b32 s18, 35651584, 0
MA 76,228,36
TR 54,193,57344
LW 4
MA 64,232,40
TR 56,192,53248
    s_mov_b32 s58, 0
MA 68,236,40
TR 58,192,61440
MA 72,232,44
TR 60,193,53248
    buffer_load_dwordx4 a[0:3], v6, s[16:19], s58 offen offset:0 sc1
MA 76,236,44
TR 62,193,61440
LW 4
MA 64,240,48
TR 32,200,0
MA 68,244,48
TR 34,200,8192
MA 72,240,52
TR 36,201,0
    buffer_load_dwordx4 a[4:7], v6, s[16:19], s58 offen offset:1024 sc1
MA 76,244,52
TR 38,201,8192
LW 4
MA 64,248,56
TR 40,200,4096
MA 68,252,56
TR 42,200,12288
MA 72,248,60
TR 44,201,4096
    buffer_load_dwordx4 a[8:11], v6, s[16:19], s58 offen offset:2048 sc1
MA 76,252,60
TR 46,201,12288
LW 4
MA 64,128,32
TR 48,200,16384
    buffer_load_dwordx2 v[14:15], v13, s[8:11], 0 offen offset:128 sc1
MA 68,132,32
TR 50,200,24576
MA 72,128,36
TR 52,201,16384
    buffer_load_dwordx4 a[12:15], v6, s[16:19], s58 offen offset:3072 sc1
MA 76,132,36
TR 54,201,24576
LW 4
MA 64,136,40
TR 56,200,20480
    s_mov_b32 s58, 4096
MA 68,140,40
TR 58,200,28672
MA 72,136,44
TR 60,201,20480
    buffer_load_dwordx4 a[16:19], v6, s[16:19], s58 offen offset:0 sc1
MA 76,140,44
TR 62,201,28672
LW 4
MA 64,144,48
TR 32,200,32768
MA 68,148,48
TR 34,200,40960
MA 72,144,52
TR 36,201,32768
    buffer_load_dwordx4 a[20:23], v6, s[16:19], s58 offen offset:1024 sc1
MA 76,148,52
TR 38,201,40960
LW 4
MA 64,152,56
TR 40,200,36864
MA 68,156,56
TR 42,200,45056
MA 72,152,60
TR 44,201,36864
    buffer_load_dwordx4 a[24:27], v6, s[16:19], s58 offen offset:2048 sc1
MA 76,156,60
TR 46,201,45056
LW 4
MA 64,160,32
TR 48,200,49152
MA 68,164,32
TR 50,200,57344
MA 72,160,36
TR 52,201,49152
    buffer_load_dwordx4 a[28:31], v6, s[16:19], s58 offen offset:3072 sc1
MA 76,164,36
TR 54,201,57344
LW 4
MA 64,168,40
TR 56,200,53248
    s_mov_b32 s58, 8192
MA 68,172,40
TR 58,200,61440
MA 72,168,44
TR 60,201,53248
    buffer_load_dwordx4 a[32:35], v6, s[16:19], s58 offen offset:0 sc1
MA 76,172,44
TR 62,201,61440
LW 4
MA 64,176,48
TR 32,194,0
MA 68,180,48
TR 34,194,8192
MA 72,176,52
TR 36,195,0
    buffer_load_dwordx4 a[36:39], v6, s[16:19], s58 offen offset:1024 sc1
MA 76,180,52
TR 38,195,8192
LW 4
MA 64,184,56
TR 40,194,4096
MA 68,188,56
TR 42,194,12288
MA 72,184,60
TR 44,195,4096
    buffer_load_dwordx4 a[40:43], v6, s[16:19], s58 offen offset:2048 sc1
MA 76,188,60
TR 46,195,12288
LW 4
MA 80,192,32
TR 48,194,16384
MA 84,196,32
TR 50,194,24576
MA 88,192,36
TR 52,195,16384
MA 92,196,36
TR 54,195,24576
LW 4
MA 80,200,40
TR 56,194,20480
    s_waitcnt vmcnt(12)
    v_lshlrev_b32 v232, 16, v216
MA 84,204,40
TR 58,194,28672
    v_and_b32 v233, s66, v216
    v_lshlrev_b32 v234, 16, v217
MA 88,200,44
TR 60,195,20480
    v_and_b32 v235, s66, v217
    v_lshlrev_b32 v236, 16, v218
MA 92,204,44
TR 62,195,28672
    v_and_b32 v237, s66, v218
LW 4
MA 80,208,48
TR 32,194,32768
    v_lshlrev_b32 v238, 16, v219
    v_and_b32 v239, s66, v219
MA 84,212,48
TR 34,194,40960
    v_lshlrev_b32 v240, 16, v220
    v_and_b32 v241, s66, v220
MA 88,208,52
TR 36,195,32768
    v_lshlrev_b32 v242, 16, v221
    v_and_b32 v243, s66, v221
MA 92,212,52
TR 38,195,40960
    v_lshlrev_b32 v244, 16, v222
LW 4
MA 80,216,56
TR 40,194,36864
    v_and_b32 v245, s66, v222
    v_lshlrev_b32 v246, 16, v223
MA 84,220,56
TR 42,194,45056
    v_and_b32 v247, s66, v223
    v_add_f32 v64, v64, v232
MA 88,216,60
TR 44,195,36864
    v_add_f32 v65, v65, v233
    v_add_f32 v66, v66, v234
MA 92,220,60
TR 46,195,45056
    v_add_f32 v67, v67, v235
LW 4
MA 80,224,32
TR 48,194,49152
    s_mov_b64 exec, 0xffff
    buffer_store_dwordx2 v[4:5], v29, s[8:11], s43 offen offset:384 sc1
    s_mov_b64 exec, -1
MA 84,228,32
TR 50,194,57344
    v_add_f32 v68, v68, v236
    v_add_f32 v69, v69, v237
MA 88,224,36
TR 52,195,49152
    s_waitcnt vmcnt(9)
    v_cmp_ne_u64 vcc, s[56:57], v[14:15]
    s_nop 1
    s_cmp_lg_u64 vcc, 0
    s_cbranch_scc1 L_miss36
L_back36:
    buffer_load_dwordx4 v[224:227], v1, s[8:11], s42 offen offset:0 sc1
    buffer_load_dwordx4 v[228:231], v1, s[8:11], s42 offen offset:1024 sc1
    s_add_u32 s42, s42, 2048
MA 92,228,36
TR 54,195,57344
    v_add_f32 v70, v70, v238
LW 4
MA 80,232,40
TR 56,194,53248
    v_add_f32 v71, v71, v239
    v_cvt_pk_bf16_f32 v64, v64, v65
MA 84,236,40
TR 58,194,61440
    v_cvt_pk_bf16_f32 v65, v66, v67
    v_cvt_pk_bf16_f32 v66, v68, v69
MA 88,232,44
TR 60,195,53248
    v_cvt_pk_bf16_f32 v67, v70, v71
MA 92,236,44
TR 62,195,61440
    buffer_store_dwordx4 v[64:67], v2, s[8:11], s62 offen offset:0 sc1
LW 4
MA 80,240,48
TR 32,202,0
    v_add_f32 v72, v72, v240
    v_add_f32 v73, v73, v241
MA 84,244,48
TR 34,202,8192
    v_add_f32 v74, v74, v242
    v_add_f32 v75, v75, v243
MA 88,240,52
TR 36,203,0
    v_add_f32 v76, v76, v244
    v_add_f32 v77, v77, v245
MA 92,244,52
TR 38,203,8192
    v_add_f32 v78, v78, v246
LW 4
MA 80,248,56
TR 40,202,4096
    v_add_f32 v79, v79, v247
    v_cvt_pk_bf16_f32 v72, v72, v73
MA 84,252,56
TR 42,202,12288
    v_cvt_pk_bf16_f32 v73, v74, v75
    v_cvt_pk_bf16_f32 v74, v76, v77
MA 88,248,60
TR 44,203,4096
    v_cvt_pk_bf16_f32 v75, v78, v79
MA 92,252,60
TR 46,203,12288
    buffer_store_dwordx4 v[72:75], v2, s[8:11], s62 offen offset:128 sc1
LW 4
MA 80,128,32
TR 48,202,16384
    buffer_load_dwordx2 v[14:15], v13, s[8:11], 0 offen offset:256 sc1
MA 84,132,32
TR 50,202,24576
    s_add_u32 s62, s62, 65536
MA 88,128,36
TR 52,203,16384
    buffer_load_dwordx4 a[44:47], v6, s[16:19], s58 offen offset:3072 sc1
MA 92,132,36
TR 54,203,24576
LW 4
MA 80,136,40
TR 56,202,20480
    s_mov_b32 s58, 12288
MA 84,140,40
TR 58,202,28672
MA 88,136,44
TR 60,203,20480
    buffer_load_dwordx4 a[48:51], v6, s[16:19], s58 offen offset:0 sc1
MA 92,140,44
TR 62,203,28672
LW 4
MA 80,144,48
TR 32,202,32768
MA 84,148,48
TR 34,202,40960
MA 88,144,52
TR 36,203,32768
    buffer_load_dwordx4 a[52:55], v6, s[16:19], s58 offen offset:1024 sc1
MA 92,148,52
TR 38,203,40960
LW 4
MA 80,152,56
TR 40,202,36864
MA 84,156,56
TR 42,202,45056
MA 88,152,60
TR 44,203,36864
    buffer_load_dwordx4 a[56:59], v6, s[16:19], s58 offen offset:2048 sc1
MA 92,156,60
TR 46,203,45056
LW 4
MA 80,160,32
TR 48,202,49152
MA 84,164,32
TR 50,202,57344
MA 88,160,36
TR 52,203,49152
    buffer_load_dwordx4 a[60:63], v6, s[16:19], s58 offen offset:3072 sc1
MA 92,164,36
TR 54,203,57344
LW 4
MA 80,168,40
TR 56,202,53248
    s_mov_b32 s58, 16384
MA 84,172,40
TR 58,202,61440
MA 88,168,44
TR 60,203,53248
    buffer_load_dwordx4 a[64:67], v6, s[16:19], s58 offen offset:0 sc1
MA 92,172,44
TR 62,203,61440
LW 4
MA 80,176,48
TR 32,196,0
MA 84,180,48
TR 34,196,8192
MA 88,176,52
TR 36,197,0
    buffer_load_dwordx4 a[68:71], v6, s[16:19], s58 offen offset:1024 sc1
MA 92,180,52
TR 38,197,8192
LW 4
MA 80,184,56
TR 40,196,4096
MA 84,188,56
TR 42,196,12288
MA 88,184,60
TR 44,197,4096
    buffer_load_dwordx4 a[72:75], v6, s[16:19], s58 offen offset:2048 sc1
MA 92,188,60
TR 46,197,12288
LW 4
MA 96,192,32
TR 48,196,16384
MA 100,196,32
TR 50,196,24576
MA 104,192,36
TR 52,197,16384
MA 108,196,36
TR 54,197,24576
LW 4
MA 96,200,40
TR 56,196,20480
    s_waitcnt vmcnt(11)
    v_lshlrev_b32 v232, 16, v224
MA 100,204,40
TR 58,196,28672
    v_and_b32 v233, s66, v224
    v_lshlrev_b32 v234, 16, v225
MA 104,200,44
TR 60,197,20480
    v_and_b32 v235, s66, v225
    v_lshlrev_b32 v236, 16, v226
MA 108,204,44
TR 62,197,28672
    v_and_b32 v237, s66, v226
LW 4
MA 96,208,48
TR 32,196,32768
    v_lshlrev_b32 v238, 16, v227
    v_and_b32 v239, s66, v227
MA 100,212,48
TR 34,196,40960
    v_lshlrev_b32 v240, 16, v228
    v_and_b32 v241, s66, v228
MA 104,208,52
TR 36,197,32768
    v_lshlrev_b32 v242, 16, v229
    v_and_b32 v243, s66, v229
MA 108,212,52
TR 38,197,40960
    v_lshlrev_b32 v244, 16, v230
LW 4
MA 96,216,56
TR 40,196,36864
    v_and_b32 v245, s66, v230
    v_lshlrev_b32 v246, 16, v231
MA 100,220,56
TR 42,196,45056
    v_and_b32 v247, s66, v231
    v_add_f32 v80, v80, v232
MA 104,216,60
TR 44,197,36864
    v_add_f32 v81, v81, v233
    v_add_f32 v82, v82, v234
MA 108,220,60
TR 46,197,45056
    v_add_f32 v83, v83, v235
LW 4
MA 96,224,32
TR 48,196,49152
    v_add_f32 v84, v84, v236
    v_add_f32 v85, v85, v237
MA 100,228,32
TR 50,196,57344
    v_add_f32 v86, v86, v238
    v_add_f32 v87, v87, v239
MA 104,224,36
TR 52,197,49152
    s_waitcnt vmcnt(8)
    v_cmp_ne_u64 vcc, s[56:57], v[14:15]
    s_nop 1
    s_cmp_lg_u64 vcc, 0
    s_cbranch_scc1 L_miss37
L_back37:
    buffer_load_dwordx4 v[216:219], v1, s[8:11], s42 offen offset:0 sc1
    buffer_load_dwordx4 v[220:223], v1, s[8:11], s42 offen offset:1024 sc1
    s_add_u32 s42, s42, 2048
MA 108,228,36
TR 54,197,57344
    v_cvt_pk_bf16_f32 v80, v80, v81
LW 4
MA 96,232,40
TR 56,196,53248
    v_cvt_pk_bf16_f32 v81, v82, v83
    v_cvt_pk_bf16_f32 v82, v84, v85
MA 100,236,40
TR 58,196,61440
    v_cvt_pk_bf16_f32 v83, v86, v87
MA 104,232,44
TR 60,197,53248
    buffer_store_dwordx4 v[80:83], v2, s[8:11], s62 offen offset:0 sc1
    v_add_f32 v88, v88, v240
MA 108,236,44
TR 62,197,61440
    v_add_f32 v89, v89, v241
LW 4
MA 96,240,48
TR 32,204,0
    s_barrier
    s_cmp_eq_u32 s100, 0
    s_cbranch_scc1 L_nof38
    s_mov_b64 exec, 0xffff
    buffer_store_dwordx2 v[4:5], v29, s[8:11], s63 offen offset:0 sc1
    s_mov_b64 exec, -1
L_nof38:
MA 100,244,48
TR 34,204,8192
    v_add_f32 v90, v90, v242
    v_add_f32 v91, v91, v243
MA 104,240,52
TR 36,205,0
    v_add_f32 v92, v92, v244
    v_add_f32 v93, v93, v245
MA 108,244,52
TR 38,205,8192
    v_add_f32 v94, v94, v246
LW 4
MA 96,248,56
TR 40,204,4096
    v_add_f32 v95, v95, v247
    v_cvt_pk_bf16_f32 v88, v88, v89
MA 100,252,56
TR 42,204,12288
    v_cvt_pk_bf16_f32 v89, v90, v91
    v_cvt_pk_bf16_f32 v90, v92, v93
MA 104,248,60
TR 44,205,4096
    v_cvt_pk_bf16_f32 v91, v94, v95
MA 108,252,60
TR 46,205,12288
    buffer_store_dwordx4 v[88:91], v2, s[8:11], s62 offen offset:128 sc1
LW 4
MA 96,128,32
TR 48,204,16384
    buffer_load_dwordx2 v[14:15], v13, s[8:11], 0 offen offset:384 sc1
MA 100,132,32
TR 50,204,24576
    s_add_u32 s62, s62, 65536
MA 104,128,36
TR 52,205,16384
    buffer_load_dwordx4 a[76:79], v6, s[16:19], s58 offen offset:3072 sc1
MA 108,132,36
TR 54,205,24576
LW 4
MA 96,136,40
TR 56,204,20480
    s_mov_b32 s58, 20480
MA 100,140,40
TR 58,204,28672
MA 104,136,44
TR 60,205,20480
    buffer_load_dwordx4 a[80:83], v6, s[16:19], s58 offen offset:0 sc1
MA 108,140,44
TR 62,205,28672
LW 4
MA 96,144,48
TR 32,204,32768
MA 100,148,48
TR 34,204,40960
MA 104,144,52
TR 36,205,32768
    buffer_load_dwordx4 a[84:87], v6, s[16:19], s58 offen offset:1024 sc1
MA 108,148,52
TR 38,205,40960
LW 4
MA 96,152,56
TR 40,204,36864
MA 100,156,56
TR 42,204,45056
MA 104,152,60
TR 44,205,36864
    buffer_load_dwordx4 a[88:91], v6, s[16:19], s58 offen offset:2048 sc1
MA 108,156,60
TR 46,205,45056
LW 4
MA 96,160,32
TR 48,204,49152
MA 100,164,32
TR 50,204,57344
MA 104,160,36
TR 52,205,49152
    buffer_load_dwordx4 a[92:95], v6, s[16:19], s58 offen offset:3072 sc1
MA 108,164,36
TR 54,205,57344
LW 4
MA 96,168,40
TR 56,204,53248
    s_mov_b32 s58, 24576
MA 100,172,40
TR 58,204,61440
MA 104,168,44
TR 60,205,53248
    buffer_load_dwordx4 a[96:99], v6, s[16:19], s58 offen offset:0 sc1
MA 108,172,44
TR 62,205,61440
LW 4
MA 96,176,48
TR 32,198,0
MA 100,180,48
TR 34,198,8192
MA 104,176,52
TR 36,199,0
    buffer_load_dwordx4 a[100:103], v6, s[16:19], s58 offen offset:1024 sc1
MA 108,180,52
TR 38,199,8192
LW 4
MA 96,184,56
TR 40,198,4096
MA 100,188,56
TR 42,198,12288
MA 104,184,60
TR 44,199,4096
    buffer_load_dwordx4 a[104:107], v6, s[16:19], s58 offen offset:2048 sc1
MA 108,188,60
TR 46,199,12288
LW 4
MA 112,192,32
TR 48,198,16384
MA 116,196,32
TR 50,198,24576
MA 120,192,36
TR 52,199,16384
MA 124,196,36
TR 54,199,24576
LW 4
MA 112,200,40
TR 56,198,20480
    s_waitcnt vmcnt(11)
    v_lshlrev_b32 v232, 16, v216
MA 116,204,40
TR 58,198,28672
    v_and_b32 v233, s66, v216
    v_lshlrev_b32 v234, 16, v217
MA 120,200,44
TR 60,199,20480
    v_and_b32 v235, s66, v217
    v_lshlrev_b32 v236, 16, v218
MA 124,204,44
TR 62,199,28672
    v_and_b32 v237, s66, v218
LW 4
MA 112,208,48
TR 32,198,32768
    v_lshlrev_b32 v238, 16, v219
    v_and_b32 v239, s66, v219
MA 116,212,48
TR 34,198,40960
    v_lshlrev_b32 v240, 16, v220
    v_and_b32 v241, s66, v220
MA 120,208,52
TR 36,199,32768
    v_lshlrev_b32 v242, 16, v221
    v_and_b32 v243, s66, v221
MA 124,212,52
TR 38,199,40960
    v_lshlrev_b32 v244, 16, v222
LW 4
MA 112,216,56
TR 40,198,36864
    v_and_b32 v245, s66, v222
    v_lshlrev_b32 v246, 16, v223
MA 116,220,56
TR 42,198,45056
    v_and_b32 v247, s66, v223
    v_add_f32 v96, v96, v232
MA 120,216,60
TR 44,199,36864
    v_add_f32 v97, v97, v233
    v_add_f32 v98, v98, v234
MA 124,220,60
TR 46,199,45056
    v_add_f32 v99, v99, v235
LW 4
MA 112,224,32
TR 48,198,49152
    v_add_f32 v100, v100, v236
    v_add_f32 v101, v101, v237
MA 116,228,32
TR 50,198,57344
    v_add_f32 v102, v102, v238
    v_add_f32 v103, v103, v239
MA 120,224,36
TR 52,199,49152
    s_waitcnt vmcnt(8)
    v_cmp_ne_u64 vcc, s[56:57], v[14:15]
    s_nop 1
    s_cmp_lg_u64 vcc, 0
    s_cbranch_scc1 L_miss39
L_back39:
    buffer_load_dwordx4 v[224:227], v1, s[8:11], s42 offen offset:0 sc1
    buffer_load_dwordx4 v[228:231], v1, s[8:11], s42 offen offset:1024 sc1
    s_add_u32 s42, s42, 2048
MA 124,228,36
TR 54,199,57344
    v_cvt_pk_bf16_f32 v96, v96, v97
LW 4
MA 112,232,40
TR 56,198,53248
    v_cvt_pk_bf16_f32 v97, v98, v99
    v_cvt_pk_bf16_f32 v98, v100, v101
MA 116,236,40
TR 58,198,61440
    v_cvt_pk_bf16_f32 v99, v102, v103
MA 120,232,44
TR 60,199,53248
    buffer_store_dwordx4 v[96:99], v2, s[8:11], s62 offen offset:0 sc1
    v_add_f32 v104, v104, v240
MA 124,236,44
TR 62,199,61440
    v_add_f32 v105, v105, v241
LW 4
MA 112,240,48
TR 32,206,0
    s_barrier
    s_cmp_eq_u32 s100, 0
    s_cbranch_scc1 L_nof40
    s_mov_b64 exec, 0xffff
    buffer_store_dwordx2 v[4:5], v29, s[8:11], s63 offen offset:1024 sc1
    s_mov_b64 exec, -1
L_nof40:
    s_bfm_b64 exec, 8, 0
    buffer_load_dwordx2 v[22:23], v21, s[8:11], 0 offen offset:0 sc1
    s_mov_b64 exec, -1
MA 116,244,48
TR 34,206,8192
    v_add_f32 v106, v106, v242
    v_add_f32 v107, v107, v243
MA 120,240,52
TR 36,207,0
    v_add_f32 v108, v108, v244
    v_add_f32 v109, v109, v245
MA 124,244,52
TR 38,207,8192
    v_add_f32 v110, v110, v246
LW 4
MA 112,248,56
TR 40,206,4096
    v_add_f32 v111, v111, v247
    v_cvt_pk_bf16_f32 v104, v104, v105
MA 116,252,56
TR 42,206,12288
    v_cvt_pk_bf16_f32 v105, v106, v107
    v_cvt_pk_bf16_f32 v106, v108, v109
MA 120,248,60
TR 44,207,4096
    v_cvt_pk_bf16_f32 v107, v110, v111
MA 124,252,60
TR 46,207,12288
    buffer_store_dwordx4 v[104:107], v2, s[8:11], s62 offen offset:128 sc1
LW 4
MA 112,128,32
TR 48,206,16384
    s_add_u32 s62, s62, 65536
MA 116,132,32
TR 50,206,24576
MA 120,128,36
TR 52,207,16384
    buffer_load_dwordx4 a[108:111], v6, s[16:19], s58 offen offset:3072 sc1
MA 124,132,36
TR 54,207,24576
LW 4
MA 112,136,40
TR 56,206,20480
    s_mov_b32 s58, 28672
MA 116,140,40
TR 58,206,28672
MA 120,136,44
TR 60,207,20480
    buffer_load_dwordx4 a[112:115], v6, s[16:19], s58 offen offset:0 sc1
MA 124,140,44
TR 62,207,28672
LW 4
MA 112,144,48
TR 32,206,32768
MA 116,148,48
TR 34,206,40960
MA 120,144,52
TR 36,207,32768
    buffer_load_dwordx4 a[116:119], v6, s[16:19], s58 offen offset:1024 sc1
MA 124,148,52
TR 38,207,40960
LW 4
MA 112,152,56
TR 40,206,36864
MA 116,156,56
TR 42,206,45056
MA 120,152,60
TR 44,207,36864
    buffer_load_dwordx4 a[120:123], v6, s[16:19], s58 offen offset:2048 sc1
MA 124,156,60
TR 46,207,45056
LW 4
MA 112,160,32
TR 48,206,49152
MA 116,164,32
TR 50,206,57344
MA 120,160,36
TR 52,207,49152
    buffer_load_dwordx4 a[124:127], v6, s[16:19], s58 offen offset:3072 sc1
MA 124,164,36
TR 54,207,57344
LW 4
MA 112,168,40
TR 56,206,53248
MA 116,172,40
TR 58,206,61440
MA 120,168,44
TR 60,207,53248
MA 124,172,44
TR 62,207,61440
LW 4
MA 112,176,48
MA 116,180,48
MA 120,176,52
MA 124,180,52
LW 0
MA 112,184,56
MA 116,188,56
MA 120,184,60
MA 124,188,60
    s_waitcnt vmcnt(6)
    v_cmp_ne_u64 vcc, s[56:57], v[22:23]
    s_nop 1
    s_bfe_u64 vcc, vcc, 0x80000
    s_cbranch_scc1 L_miss41
L_back41:
    s_add_u32 m0, s38, 131072
    s_add_u32 s68, s20, 0
    buffer_load_dwordx4 v19, s[8:11], s68 offen offset:0 sc1 lds
    buffer_load_dwordx4 v19, s[8:11], s68 offen offset:1024 sc1 lds
    buffer_load_dwordx4 v19, s[8:11], s68 offen offset:2048 sc1 lds
    buffer_load_dwordx4 v19, s[8:11], s68 offen offset:3072 sc1 lds
    s_add_u32 m0, s38, 147456
    s_add_u32 s68, s20, 16384
    buffer_load_dwordx4 v19, s[8:11], s68 offen offset:0 sc1 lds
    buffer_load_dwordx4 v19, s[8:11], s68 offen offset:1024 sc1 lds
    buffer_load_dwordx4 v19, s[8:11], s68 offen offset:2048 sc1 lds
    buffer_load_dwordx4 v19, s[8:11], s68 offen offset:3072 sc1 lds
    s_bfm_b64 exec, 16, 8
    buffer_load_dwordx2 v[22:23], v21, s[8:11], 0 offen offset:0 sc1
    s_mov_b64 exec, -1
    s_nop 7
    v_lshlrev_b32 v232, 16, v224
    v_and_b32 v233, s66, v224
    v_lshlrev_b32 v234, 16, v225
    v_and_b32 v235, s66, v225
    v_lshlrev_b32 v236, 16, v226
    v_and_b32 v237, s66, v226
    v_lshlrev_b32 v238, 16, v227
    v_and_b32 v239, s66, v227
    v_lshlrev_b32 v240, 16, v228
    v_and_b32 v241, s66, v228
    v_lshlrev_b32 v242, 16, v229
    v_and_b32 v243, s66, v229
    v_lshlrev_b32 v244, 16, v230
    v_and_b32 v245, s66, v230
    v_lshlrev_b32 v246, 16, v231
    v_and_b32 v247, s66, v231
    v_add_f32 v112, v112, v232
    v_add_f32 v113, v113, v233
    v_add_f32 v114, v114, v234
    v_add_f32 v115, v115, v235
    v_add_f32 v116, v116, v236
    v_add_f32 v117, v117, v237
    v_add_f32 v118, v118, v238
    v_add_f32 v119, v119, v239
    v_cvt_pk_bf16_f32 v112, v112, v113
    v_cvt_pk_bf16_f32 v113, v114, v115
    v_cvt_pk_bf16_f32 v114, v116, v117
    v_cvt_pk_bf16_f32 v115, v118, v119
    buffer_store_dwordx4 v[112:115], v2, s[8:11], s62 offen offset:0 sc1
    v_add_f32 v120, v120, v240
    v_add_f32 v121, v121, v241
    v_add_f32 v122, v122, v242
    v_add_f32 v123, v123, v243
    v_add_f32 v124, v124, v244
    v_add_f32 v125, v125, v245
    v_add_f32 v126, v126, v246
    v_add_f32 v127, v127, v247
    v_cvt_pk_bf16_f32 v120, v120, v121
    v_cvt_pk_bf16_f32 v121, v122, v123
    v_cvt_pk_bf16_f32 v122, v124, v125
    v_cvt_pk_bf16_f32 v123, v126, v127
    buffer_store_dwordx4 v[120:123], v2, s[8:11], s62 offen offset:128 sc1
    s_add_u32 s62, s62, 65536
    s_cmp_lg_u32 s18, 0
    s_cbranch_scc1 L_g3
    s_branch L_xlate
L_miss35:
    s_mov_b32 s39, 4194304
    s_branch L_pld42
L_poll42:
    s_sub_u32 s39, s39, 1
    s_cbranch_scc1 L_end
    s_sleep 1
L_pld42:
    buffer_load_dwordx2 v[14:15], v13, s[8:11], 0 offen offset:0 sc1
    s_waitcnt vmcnt(0)
L_pchk42:
    v_cmp_ne_u64 vcc, s[56:57], v[14:15]
    s_nop 1
    s_cmp_lg_u64 vcc, 0
    s_cbranch_scc1 L_poll42
    s_branch L_back35
L_miss36:
    s_mov_b32 s39, 4194304
    s_branch L_pld43
L_poll43:
    s_sub_u32 s39, s39, 1
    s_cbranch_scc1 L_end
    s_sleep 1
L_pld43:
    buffer_load_dwordx2 v[14:15], v13, s[8:11], 0 offen offset:128 sc1
    s_waitcnt vmcnt(0)
L_pchk43:
    v_cmp_ne_u64 vcc, s[56:57], v[14:15]
    s_nop 1
    s_cmp_lg_u64 vcc, 0
    s_cbranch_scc1 L_poll43
    s_branch L_back36
L_miss37:
    s_mov_b32 s39, 4194304
    s_branch L_pld44
L_poll44:
    s_sub_u32 s39, s39, 1
    s_cbranch_scc1 L_end
    s_sleep 1
L_pld44:
    buffer_load_dwordx2 v[14:15], v13, s[8:11], 0 offen offset:256 sc1
    s_waitcnt vmcnt(0)
L_pchk44:
    v_cmp_ne_u64 vcc, s[56:57], v[14:15]
    s_nop 1
    s_cmp_lg_u64 vcc, 0
    s_cbranch_scc1 L_poll44
    s_branch L_back37
L_miss39:
    s_mov_b32 s39, 4194304
    s_branch L_pld45
L_poll45:
    s_sub_u32 s39, s39, 1
    s_cbranch_scc1 L_end
    s_sleep 1
L_pld45:
    buffer_load_dwordx2 v[14:15], v13, s[8:11], 0 offen offset:384 sc1
    s_waitcnt vmcnt(0)
L_pchk45:
    v_cmp_ne_u64 vcc, s[56:57], v[14:15]
    s_nop 1
    s_cmp_lg_u64 vcc, 0
    s_cbranch_scc1 L_poll45
    s_branch L_back39
L_miss41:
    s_mov_b32 s39, 4194304
    s_branch L_pld46
L_poll46:
    s_sub_u32 s39, s39, 1
    s_cbranch_scc1 L_end
    s_sleep 1
L_pld46:
    s_bfm_b64 exec, 8, 0
    buffer_load_dwordx2 v[22:23], v21, s[8:11], 0 offen offset:0 sc1
    s_mov_b64 exec, -1
    s_waitcnt vmcnt(0)
L_pchk46:
    v_cmp_ne_u64 vcc, s[56:57], v[22:23]
    s_nop 1
    s_bfe_u64 vcc, vcc, 0x80000
    s_cbranch_scc1 L_poll46
    s_branch L_back41
L_g1:
    s_mov_b32 s16, s64
    s_mov_b32 s17, s65
    s_mov_b32 s18, 0x400000
    s_mov_b32 s19, 0x00020000
    s_mov_b32 s20, s72
    s_mov_b32 s21, s73
    s_mov_b32 s22, 0x200000
    s_mov_b32 s23, 0x00020000
    s_sub_u32 s47, s34, 28
    s_mov_b32 s48, 0
    s_lshl_b32 s41, s32, 14
    s_add_u32 s41, s41, 65536
    v_lshrrev_b32 v1, 4, v0
    v_and_b32 v2, 15, v0
    v_lshlrev_b32 v6, 11, v1
    s_lshl_b32 s68, s32, 15
    s_lshl_b32 s69, s47, 9
    s_add_u32 s68, s68, s69
    s_lshl_b32 s66, s33, 2
    s_add_u32 s66, s66, s32
    s_lshl_b32 s66, s66, 17
    v_or_b32 v3, 0, v1
    v_lshlrev_b32 v3, 1, v3
    v_xor_b32 v3, v3, v2
    v_lshl_add_u32 v3, v3, 4, v6
    s_add_u32 s69, s68, 0
    v_add_u32 v8, s69, v3
    v_or_b32 v3, 0, v1
    v_xor_b32 v3, v3, v2
    v_lshl_add_u32 v3, v3, 4, v6
    s_add_u32 s69, s66, 0
    v_add_u32 v16, s69, v3
    v_or_b32 v3, 0, v1
    v_lshlrev_b32 v3, 1, v3
    v_xor_b32 v3, v3, v2
    v_lshl_add_u32 v3, v3, 4, v6
    s_add_u32 s69, s68, 7168
    v_add_u32 v9, s69, v3
    v_or_b32 v3, 4, v1
    v_xor_b32 v3, v3, v2
    v_lshl_add_u32 v3, v3, 4, v6
    s_add_u32 s69, s66, 7168
    v_add_u32 v17, s69, v3
    v_or_b32 v3, 4, v1
    v_lshlrev_b32 v3, 1, v3
    v_xor_b32 v3, v3, v2
    v_lshl_add_u32 v3, v3, 4, v6
    s_add_u32 s69, s68, 14336
    v_add_u32 v10, s69, v3
    v_or_b32 v3, 8, v1
    v_xor_b32 v3, v3, v2
    v_lshl_add_u32 v3, v3, 4, v6
    s_add_u32 s69, s66, 14336
    v_add_u32 v18, s69, v3
    v_or_b32 v3, 4, v1
    v_lshlrev_b32 v3, 1, v3
    v_xor_b32 v3, v3, v2
    v_lshl_add_u32 v3, v3, 4, v6
    s_add_u32 s69, s68, 21504
    v_add_u32 v11, s69, v3
    v_or_b32 v3, 12, v1
    v_xor_b32 v3, v3, v2
    v_lshl_add_u32 v3, v3, 4, v6
    s_add_u32 s69, s66, 21504
    v_add_u32 v19, s69, v3
    s_lshl_b32 s52, s48, 10
    s_add_u32 s53, s52, 256
    s_lshl_b32 s54, s48, 10
    s_add_u32 s54, s54, 131072
    s_add_u32 s55, s54, 256
    s_add_u32 m0, s38, 0
    s_nop 0
    buffer_load_dwordx4 v8, s[20:23], s52 offen offset:0 lds
    buffer_load_dwordx4 v9, s[20:23], s52 offen offset:1024 lds
    buffer_load_dwordx4 v10, s[20:23], s52 offen offset:2048 lds
    buffer_load_dwordx4 v11, s[20:23], s52 offen offset:3072 lds
    s_add_u32 s49, s48, 0
    s_add_u32 m0, s41, 0
    s_nop 0
    buffer_load_dwordx4 v16, s[16:19], s49 offen offset:0 lds
    buffer_load_dwordx4 v17, s[16:19], s49 offen offset:1024 lds
    buffer_load_dwordx4 v18, s[16:19], s49 offen offset:2048 lds
    buffer_load_dwordx4 v19, s[16:19], s49 offen offset:3072 lds
    v_bfe_u32 v2, v0, 2, 2
    v_lshrrev_b32 v1, 4, v0
    v_lshl_add_u32 v3, v1, 3, v2
    v_lshlrev_b32 v3, 8, v3
    v_and_b32 v1, 1, v1
    v_lshl_add_u32 v2, v1, 2, v2
    v_lshl_add_u32 v3, v2, 5, v3
    v_and_b32 v6, 3, v0
    v_lshl_add_u32 v3, v6, 3, v3
    v_xor_b32 v20, 0, v3
    v_xor_b32 v21, 32, v3
    v_xor_b32 v22, 64, v3
    v_xor_b32 v23, 96, v3
    v_xor_b32 v24, 128, v3
    v_xor_b32 v25, 160, v3
    v_xor_b32 v26, 192, v3
    v_xor_b32 v27, 224, v3
    v_and_b32 v1, 15, v0
    v_lshrrev_b32 v2, 4, v0
    v_xor_b32 v2, v2, v1
    v_lshlrev_b32 v2, 4, v2
    v_lshl_add_u32 v2, v1, 8, v2
    v_add_u32 v12, s41, v2
    v_xor_b32 v13, 64, v12
    v_xor_b32 v14, 128, v12
    v_xor_b32 v15, 192, v12
    v_mov_b32 v32, 0
    v_mov_b32 v33, 0
    v_mov_b32 v34, 0
    v_mov_b32 v35, 0
    s_waitcnt vmcnt(8)
    s_nop 0
    v_mfma_f32_32x32x16_bf16 v[128:143], v[32:35], v[32:35], 0
    v_mfma_f32_32x32x16_bf16 a[0:15], v[32:35], v[32:35], 0
    v_mfma_f32_32x32x16_bf16 v[144:159], v[32:35], v[32:35], 0
    v_mfma_f32_32x32x16_bf16 a[16:31], v[32:35], v[32:35], 0
    v_mfma_f32_32x32x16_bf16 v[160:175], v[32:35], v[32:35], 0
    v_mfma_f32_32x32x16_bf16 a[32:47], v[32:35], v[32:35], 0
    v_mfma_f32_32x32x16_bf16 v[176:191], v[32:35], v[32:35], 0
    v_mfma_f32_32x32x16_bf16 a[48:63], v[32:35], v[32:35], 0
    v_mfma_f32_32x32x16_bf16 v[192:207], v[32:35], v[32:35], 0
    v_mfma_f32_32x32x16_bf16 a[64:79], v[32:35], v[32:35], 0
    v_mfma_f32_32x32x16_bf16 v[208:223], v[32:35], v[32:35], 0
    v_mfma_f32_32x32x16_bf16 a[80:95], v[32:35], v[32:35], 0
    v_mfma_f32_32x32x16_bf16 v[224:239], v[32:35], v[32:35], 0
    v_mfma_f32_32x32x16_bf16 a[96:111], v[32:35], v[32:35], 0
    v_mfma_f32_32x32x16_bf16 v[240:255], v[32:35], v[32:35], 0
    v_mfma_f32_32x32x16_bf16 a[112:127], v[32:35], v[32:35], 0
    s_lshl_b32 s64, s60, 2
    s_add_u32 s64, s64, s32
    s_lshr_b32 s65, s64, 1
    s_lshl_b32 s65, s65, 10
    s_add_u32 s65, s65, 29425664
    v_and_b32 v3, 3, v0
    v_lshlrev_b32 v3, 8, v3
    v_add_u32 v3, s65, v3
    s_lshl_b32 s64, s64, 16
    s_add_u32 s64, s64, 16777216
    v_lshlrev_b32 v6, 4, v0
    v_add_u32 v6, s64, v6
    v_lshlrev_b32 v28, 4, v0
    s_lshl_b32 s68, s33, 2
    s_add_u32 s68, s68, s32
    s_lshl_b32 s51, s68, 10
    s_lshl_b32 s69, s47, 8
    s_add_u32 s51, s51, s69
    s_add_u32 s51, s51, 29425664
    s_lshl_b32 s68, s68, 17
    s_lshl_b32 s69, s47, 13
    s_add_u32 s68, s68, s69
    s_add_u32 s42, s68, 16777216
    s_mov_b32 exec_hi, 0
    buffer_store_dwordx2 v[32:33], v29, s[8:11], s51 offen sc1
    s_mov_b32 exec_hi, -1
    s_add_u32 s49, s48, 32768
    s_add_u32 m0, s41, 4096
    s_nop 0
    buffer_load_dwordx4 v16, s[16:19], s49 offen offset:0 lds
    buffer_load_dwordx4 v17, s[16:19], s49 offen offset:1024 lds
    buffer_load_dwordx4 v18, s[16:19], s49 offen offset:2048 lds
    buffer_load_dwordx4 v19, s[16:19], s49 offen offset:3072 lds
    s_add_u32 s49, s48, 65536
    s_add_u32 m0, s41, 8192
    s_nop 0
    buffer_load_dwordx4 v16, s[16:19], s49 offen offset:0 lds
    buffer_load_dwordx4 v17, s[16:19], s49 offen offset:1024 lds
    buffer_load_dwordx4 v18, s[16:19], s49 offen offset:2048 lds
    buffer_load_dwordx4 v19, s[16:19], s49 offen offset:3072 lds
    s_add_u32 s49, s48, 98304
    s_add_u32 m0, s41, 12288
    s_nop 0
    buffer_load_dwordx4 v16, s[16:19], s49 offen offset:0 lds
    buffer_load_dwordx4 v17, s[16:19], s49 offen offset:1024 lds
    buffer_load_dwordx4 v18, s[16:19], s49 offen offset:2048 lds
    buffer_load_dwordx4 v19, s[16:19], s49 offen offset:3072 lds
    s_add_u32 m0, s38, 16384
    s_nop 0
    buffer_load_dwordx4 v8, s[20:23], s53 offen offset:0 lds
    buffer_load_dwordx4 v9, s[20:23], s53 offen offset:1024 lds
    buffer_load_dwordx4 v10, s[20:23], s53 offen offset:2048 lds
    buffer_load_dwordx4 v11, s[20:23], s53 offen offset:3072 lds
    s_add_u32 s48, s48, 256
    s_waitcnt vmcnt(4)
    s_barrier
    ds_read_b128 v[64:67], v12 offset:0
    ds_read_b128 v[68:71], v12 offset:4096
    ds_read_b128 v[72:75], v12 offset:8192
    ds_read_b128 v[76:79], v12 offset:12288
    ds_read_b128 v[80:83], v13 offset:0
    ds_read_b128 v[84:87], v13 offset:4096
    ds_read_b128 v[88:91], v13 offset:8192
    ds_read_b128 v[92:95], v13 offset:12288
TR 32,20,0
TR 34,20,1024
TR 36,21,0
TR 38,21,1024
TR 40,22,0
TR 42,22,1024
    s_mov_b32 s37, 6
    .p2align 6
L_loop1:
LW 4
    v_mfma_f32_16x16x32_bf16 v[128:131], v[32:35], v[64:67], v[128:131]
TR 44,23,0
    s_add_u32 m0, s38, 32768
    v_mfma_f32_16x16x32_bf16 v[136:139], v[32:35], v[68:71], v[136:139]
TR 46,23,1024
    v_mfma_f32_16x16x32_bf16 v[144:147], v[32:35], v[72:75], v[144:147]
    ds_read_b128 v[96:99], v14 offset:0
    buffer_load_dwordx4 v8, s[20:23], s54 offen offset:0 lds
    v_mfma_f32_16x16x32_bf16 v[152:155], v[32:35], v[76:79], v[152:155]
    ds_read_b128 v[100:103], v14 offset:4096
LW 6
    v_mfma_f32_16x16x32_bf16 v[132:135], v[36:39], v[64:67], v[132:135]
TR 48,24,0
    v_mfma_f32_16x16x32_bf16 v[140:143], v[36:39], v[68:71], v[140:143]
TR 50,24,1024
    v_mfma_f32_16x16x32_bf16 v[148:151], v[36:39], v[72:75], v[148:151]
    ds_read_b128 v[104:107], v14 offset:8192
    buffer_load_dwordx4 v9, s[20:23], s54 offen offset:1024 lds
    v_mfma_f32_16x16x32_bf16 v[156:159], v[36:39], v[76:79], v[156:159]
    ds_read_b128 v[108:111], v14 offset:12288
LW 8
    v_mfma_f32_16x16x32_bf16 v[160:163], v[40:43], v[64:67], v[160:163]
TR 52,25,0
    v_mfma_f32_16x16x32_bf16 v[168:171], v[40:43], v[68:71], v[168:171]
TR 54,25,1024
    v_mfma_f32_16x16x32_bf16 v[176:179], v[40:43], v[72:75], v[176:179]
    ds_read_b128 v[112:115], v15 offset:0
    buffer_load_dwordx4 v10, s[20:23], s54 offen offset:2048 lds
    v_mfma_f32_16x16x32_bf16 v[184:187], v[40:43], v[76:79], v[184:187]
    ds_read_b128 v[116:119], v15 offset:4096
LW 10
    v_mfma_f32_16x16x32_bf16 v[164:167], v[44:47], v[64:67], v[164:167]
TR 56,26,0
    v_mfma_f32_16x16x32_bf16 v[172:175], v[44:47], v[68:71], v[172:175]
TR 58,26,1024
    v_mfma_f32_16x16x32_bf16 v[180:183], v[44:47], v[72:75], v[180:183]
    ds_read_b128 v[120:123], v15 offset:8192
    buffer_load_dwordx4 v11, s[20:23], s54 offen offset:3072 lds
    v_mfma_f32_16x16x32_bf16 v[188:191], v[44:47], v[76:79], v[188:191]
    ds_read_b128 v[124:127], v15 offset:12288
    s_add_u32 s49, s48, 0
LW 10
    v_mfma_f32_16x16x32_bf16 v[192:195], v[48:51], v[64:67], v[192:195]
TR 60,27,0
    s_add_u32 m0, s41, 0
    v_mfma_f32_16x16x32_bf16 v[200:203], v[48:51], v[68:71], v[200:203]
TR 62,27,1024
    v_mfma_f32_16x16x32_bf16 v[208:211], v[48:51], v[72:75], v[208:211]
    v_mfma_f32_16x16x32_bf16 v[216:219], v[48:51], v[76:79], v[216:219]
LW 8
    v_mfma_f32_16x16x32_bf16 v[196:199], v[52:55], v[64:67], v[196:199]
TR 32,20,8192
    v_mfma_f32_16x16x32_bf16 v[204:207], v[52:55], v[68:71], v[204:207]
TR 34,20,9216
    v_mfma_f32_16x16x32_bf16 v[212:215], v[52:55], v[72:75], v[212:215]
    v_mfma_f32_16x16x32_bf16 v[220:223], v[52:55], v[76:79], v[220:223]
LW 6
    v_mfma_f32_16x16x32_bf16 v[224:227], v[56:59], v[64:67], v[224:227]
TR 36,21,8192
    v_mfma_f32_16x16x32_bf16 v[232:235], v[56:59], v[68:71], v[232:235]
TR 38,21,9216
    v_mfma_f32_16x16x32_bf16 v[240:243], v[56:59], v[72:75], v[240:243]
    v_mfma_f32_16x16x32_bf16 v[248:251], v[56:59], v[76:79], v[248:251]
LW 4
    v_mfma_f32_16x16x32_bf16 v[228:231], v[60:63], v[64:67], v[228:231]
TR 40,22,8192
    v_mfma_f32_16x16x32_bf16 v[236:239], v[60:63], v[68:71], v[236:239]
TR 42,22,9216
    v_mfma_f32_16x16x32_bf16 v[244:247], v[60:63], v[72:75], v[244:247]
    buffer_load_dwordx4 v16, s[16:19], s49 offen offset:0 lds
    v_mfma_f32_16x16x32_bf16 v[252:255], v[60:63], v[76:79], v[252:255]
LW 4
    v_mfma_f32_16x16x32_bf16 v[128:131], v[32:35], v[80:83], v[128:131]
TR 44,23,8192
    v_mfma_f32_16x16x32_bf16 v[136:139], v[32:35], v[84:87], v[136:139]
TR 46,23,9216
    v_mfma_f32_16x16x32_bf16 v[144:147], v[32:35], v[88:91], v[144:147]
    v_mfma_f32_16x16x32_bf16 v[152:155], v[32:35], v[92:95], v[152:155]
LW 4
    v_mfma_f32_16x16x32_bf16 v[132:135], v[36:39], v[80:83], v[132:135]
TR 48,24,8192
    v_mfma_f32_16x16x32_bf16 v[140:143], v[36:39], v[84:87], v[140:143]
TR 50,24,9216
    v_mfma_f32_16x16x32_bf16 v[148:151], v[36:39], v[88:91], v[148:151]
    buffer_load_dwordx4 v17, s[16:19], s49 offen offset:1024 lds
    v_mfma_f32_16x16x32_bf16 v[156:159], v[36:39], v[92:95], v[156:159]
LW 4
    v_mfma_f32_16x16x32_bf16 v[160:163], v[40:43], v[80:83], v[160:163]
TR 52,25,8192
    v_mfma_f32_16x16x32_bf16 v[168:171], v[40:43], v[84:87], v[168:171]
TR 54,25,9216
    v_mfma_f32_16x16x32_bf16 v[176:179], v[40:43], v[88:91], v[176:179]
    v_mfma_f32_16x16x32_bf16 v[184:187], v[40:43], v[92:95], v[184:187]
LW 4
    v_mfma_f32_16x16x32_bf16 v[164:167], v[44:47], v[80:83], v[164:167]
TR 56,26,8192
    v_mfma_f32_16x16x32_bf16 v[172:175], v[44:47], v[84:87], v[172:175]
TR 58,26,9216
    v_mfma_f32_16x16x32_bf16 v[180:183], v[44:47], v[88:91], v[180:183]
    buffer_load_dwordx4 v18, s[16:19], s49 offen offset:2048 lds
    v_mfma_f32_16x16x32_bf16 v[188:191], v[44:47], v[92:95], v[188:191]
LW 4
    v_mfma_f32_16x16x32_bf16 v[192:195], v[48:51], v[80:83], v[192:195]
TR 60,27,8192
    v_mfma_f32_16x16x32_bf16 v[200:203], v[48:51], v[84:87], v[200:203]
TR 62,27,9216
    v_mfma_f32_16x16x32_bf16 v[208:211], v[48:51], v[88:91], v[208:211]
    v_mfma_f32_16x16x32_bf16 v[216:219], v[48:51], v[92:95], v[216:219]
LW 4
    v_mfma_f32_16x16x32_bf16 v[196:199], v[52:55], v[80:83], v[196:199]
    s_waitcnt vmcnt(7)
    s_barrier
TR 32,20,16384
    v_mfma_f32_16x16x32_bf16 v[204:207], v[52:55], v[84:87], v[204:207]
TR 34,20,17408
    v_mfma_f32_16x16x32_bf16 v[212:215], v[52:55], v[88:91], v[212:215]
    buffer_load_dwordx4 v19, s[16:19], s49 offen offset:3072 lds
    v_mfma_f32_16x16x32_bf16 v[220:223], v[52:55], v[92:95], v[220:223]
LW 4
    v_mfma_f32_16x16x32_bf16 v[224:227], v[56:59], v[80:83], v[224:227]
TR 36,21,16384
    v_mfma_f32_16x16x32_bf16 v[232:235], v[56:59], v[84:87], v[232:235]
TR 38,21,17408
    v_mfma_f32_16x16x32_bf16 v[240:243], v[56:59], v[88:91], v[240:243]
    v_mfma_f32_16x16x32_bf16 v[248:251], v[56:59], v[92:95], v[248:251]
LW 4
    v_mfma_f32_16x16x32_bf16 v[228:231], v[60:63], v[80:83], v[228:231]
TR 40,22,16384
    v_mfma_f32_16x16x32_bf16 v[236:239], v[60:63], v[84:87], v[236:239]
TR 42,22,17408
    v_mfma_f32_16x16x32_bf16 v[244:247], v[60:63], v[88:91], v[244:247]
    v_mfma_f32_16x16x32_bf16 v[252:255], v[60:63], v[92:95], v[252:255]
LW 4
    v_mfma_f32_16x16x32_bf16 a[0:3], v[32:35], v[64:67], a[0:3]
TR 44,23,16384
    s_add_u32 m0, s38, 49152
    v_mfma_f32_16x16x32_bf16 a[8:11], v[32:35], v[68:71], a[8:11]
TR 46,23,17408
    v_mfma_f32_16x16x32_bf16 a[16:19], v[32:35], v[72:75], a[16:19]
    buffer_load_dwordx4 v8, s[20:23], s55 offen offset:0 lds
    v_mfma_f32_16x16x32_bf16 a[24:27], v[32:35], v[76:79], a[24:27]
LW 4
    v_mfma_f32_16x16x32_bf16 a[4:7], v[36:39], v[64:67], a[4:7]
TR 48,24,16384
    v_mfma_f32_16x16x32_bf16 a[12:15], v[36:39], v[68:71], a[12:15]
TR 50,24,17408
    v_mfma_f32_16x16x32_bf16 a[20:23], v[36:39], v[72:75], a[20:23]
    buffer_load_dwordx4 v9, s[20:23], s55 offen offset:1024 lds
    v_mfma_f32_16x16x32_bf16 a[28:31], v[36:39], v[76:79], a[28:31]
LW 4
    v_mfma_f32_16x16x32_bf16 a[32:35], v[40:43], v[64:67], a[32:35]
TR 52,25,16384
    v_mfma_f32_16x16x32_bf16 a[40:43], v[40:43], v[68:71], a[40:43]
TR 54,25,17408
    v_mfma_f32_16x16x32_bf16 a[48:51], v[40:43], v[72:75], a[48:51]
    buffer_load_dwordx4 v10, s[20:23], s55 offen offset:2048 lds
    v_mfma_f32_16x16x32_bf16 a[56:59], v[40:43], v[76:79], a[56:59]
LW 4
    v_mfma_f32_16x16x32_bf16 a[36:39], v[44:47], v[64:67], a[36:39]
TR 56,26,16384
    v_mfma_f32_16x16x32_bf16 a[44:47], v[44:47], v[68:71], a[44:47]
TR 58,26,17408
    v_mfma_f32_16x16x32_bf16 a[52:55], v[44:47], v[72:75], a[52:55]
    buffer_load_dwordx4 v11, s[20:23], s55 offen offset:3072 lds
    v_mfma_f32_16x16x32_bf16 a[60:63], v[44:47], v[76:79], a[60:63]
    s_add_u32 s49, s48, 32768
LW 4
    v_mfma_f32_16x16x32_bf16 a[64:67], v[48:51], v[64:67], a[64:67]
TR 60,27,16384
    s_add_u32 m0, s41, 4096
    v_mfma_f32_16x16x32_bf16 a[72:75], v[48:51], v[68:71], a[72:75]
TR 62,27,17408
    v_mfma_f32_16x16x32_bf16 a[80:83], v[48:51], v[72:75], a[80:83]
    v_mfma_f32_16x16x32_bf16 a[88:91], v[48:51], v[76:79], a[88:91]
LW 4
    v_mfma_f32_16x16x32_bf16 a[68:71], v[52:55], v[64:67], a[68:71]
TR 32,20,24576
    v_mfma_f32_16x16x32_bf16 a[76:79], v[52:55], v[68:71], a[76:79]
TR 34,20,25600
    v_mfma_f32_16x16x32_bf16 a[84:87], v[52:55], v[72:75], a[84:87]
    buffer_load_dwordx4 v16, s[16:19], s49 offen offset:0 lds
    v_mfma_f32_16x16x32_bf16 a[92:95], v[52:55], v[76:79], a[92:95]
LW 4
    v_mfma_f32_16x16x32_bf16 a[96:99], v[56:59], v[64:67], a[96:99]
TR 36,21,24576
    v_mfma_f32_16x16x32_bf16 a[104:107], v[56:59], v[68:71], a[104:107]
TR 38,21,25600
    v_mfma_f32_16x16x32_bf16 a[112:115], v[56:59], v[72:75], a[112:115]
    buffer_load_dwordx4 v17, s[16:19], s49 offen offset:1024 lds
    v_mfma_f32_16x16x32_bf16 a[120:123], v[56:59], v[76:79], a[120:123]
LW 4
    v_mfma_f32_16x16x32_bf16 a[100:103], v[60:63], v[64:67], a[100:103]
TR 40,22,24576
    v_mfma_f32_16x16x32_bf16 a[108:111], v[60:63], v[68:71], a[108:111]
TR 42,22,25600
    v_mfma_f32_16x16x32_bf16 a[116:119], v[60:63], v[72:75], a[116:119]
    buffer_load_dwordx4 v18, s[16:19], s49 offen offset:2048 lds
    v_mfma_f32_16x16x32_bf16 a[124:127], v[60:63], v[76:79], a[124:127]
LW 4
    v_mfma_f32_16x16x32_bf16 a[0:3], v[32:35], v[80:83], a[0:3]
TR 44,23,24576
    v_mfma_f32_16x16x32_bf16 a[8:11], v[32:35], v[84:87], a[8:11]
TR 46,23,25600
    v_mfma_f32_16x16x32_bf16 a[16:19], v[32:35], v[88:91], a[16:19]
    buffer_load_dwordx4 v19, s[16:19], s49 offen offset:3072 lds
    v_mfma_f32_16x16x32_bf16 a[24:27], v[32:35], v[92:95], a[24:27]
    s_add_u32 s49, s48, 65536
LW 4
    v_mfma_f32_16x16x32_bf16 a[4:7], v[36:39], v[80:83], a[4:7]
TR 48,24,24576
    s_add_u32 m0, s41, 8192
    v_mfma_f32_16x16x32_bf16 a[12:15], v[36:39], v[84:87], a[12:15]
TR 50,24,25600
    v_mfma_f32_16x16x32_bf16 a[20:23], v[36:39], v[88:91], a[20:23]
    buffer_load_dwordx4 v16, s[16:19], s49 offen offset:0 lds
    v_mfma_f32_16x16x32_bf16 a[28:31], v[36:39], v[92:95], a[28:31]
LW 4
    v_mfma_f32_16x16x32_bf16 a[32:35], v[40:43], v[80:83], a[32:35]
TR 52,25,24576
    v_mfma_f32_16x16x32_bf16 a[40:43], v[40:43], v[84:87], a[40:43]
TR 54,25,25600
    v_mfma_f32_16x16x32_bf16 a[48:51], v[40:43], v[88:91], a[48:51]
    buffer_load_dwordx4 v17, s[16:19], s49 offen offset:1024 lds
    v_mfma_f32_16x16x32_bf16 a[56:59], v[40:43], v[92:95], a[56:59]
LW 4
    v_mfma_f32_16x16x32_bf16 a[36:39], v[44:47], v[80:83], a[36:39]
TR 56,26,24576
    v_mfma_f32_16x16x32_bf16 a[44:47], v[44:47], v[84:87], a[44:47]
TR 58,26,25600
    v_mfma_f32_16x16x32_bf16 a[52:55], v[44:47], v[88:91], a[52:55]
    buffer_load_dwordx4 v18, s[16:19], s49 offen offset:2048 lds
    v_mfma_f32_16x16x32_bf16 a[60:63], v[44:47], v[92:95], a[60:63]
LW 4
    v_mfma_f32_16x16x32_bf16 a[64:67], v[48:51], v[80:83], a[64:67]
TR 60,27,24576
    v_mfma_f32_16x16x32_bf16 a[72:75], v[48:51], v[84:87], a[72:75]
TR 62,27,25600
    v_mfma_f32_16x16x32_bf16 a[80:83], v[48:51], v[88:91], a[80:83]
    buffer_load_dwordx4 v19, s[16:19], s49 offen offset:3072 lds
    v_mfma_f32_16x16x32_bf16 a[88:91], v[48:51], v[92:95], a[88:91]
    s_lshl_b32 s52, s48, 10
LW 4
    v_mfma_f32_16x16x32_bf16 a[68:71], v[52:55], v[80:83], a[68:71]
    s_waitcnt vmcnt(16)
    s_barrier
TR 32,20,32768
    s_add_u32 s53, s52, 256
    v_mfma_f32_16x16x32_bf16 a[76:79], v[52:55], v[84:87], a[76:79]
TR 34,20,33792
    v_mfma_f32_16x16x32_bf16 a[84:87], v[52:55], v[88:91], a[84:87]
    v_mfma_f32_16x16x32_bf16 a[92:95], v[52:55], v[92:95], a[92:95]
LW 4
    v_mfma_f32_16x16x32_bf16 a[96:99], v[56:59], v[80:83], a[96:99]
TR 36,21,32768
    v_mfma_f32_16x16x32_bf16 a[104:107], v[56:59], v[84:87], a[104:107]
TR 38,21,33792
    v_mfma_f32_16x16x32_bf16 a[112:115], v[56:59], v[88:91], a[112:115]
    v_mfma_f32_16x16x32_bf16 a[120:123], v[56:59], v[92:95], a[120:123]
LW 4
    v_mfma_f32_16x16x32_bf16 a[100:103], v[60:63], v[80:83], a[100:103]
TR 40,22,32768
    v_mfma_f32_16x16x32_bf16 a[108:111], v[60:63], v[84:87], a[108:111]
TR 42,22,33792
    v_mfma_f32_16x16x32_bf16 a[116:119], v[60:63], v[88:91], a[116:119]
    v_mfma_f32_16x16x32_bf16 a[124:127], v[60:63], v[92:95], a[124:127]
LW 4
    v_mfma_f32_16x16x32_bf16 v[128:131], v[32:35], v[96:99], v[128:131]
TR 44,23,32768
    s_add_u32 m0, s38, 0
    v_mfma_f32_16x16x32_bf16 v[136:139], v[32:35], v[100:103], v[136:139]
TR 46,23,33792
    v_mfma_f32_16x16x32_bf16 v[144:147], v[32:35], v[104:107], v[144:147]
    buffer_load_dwordx4 v8, s[20:23], s52 offen offset:0 lds
    v_mfma_f32_16x16x32_bf16 v[152:155], v[32:35], v[108:111], v[152:155]
LW 4
    v_mfma_f32_16x16x32_bf16 v[132:135], v[36:39], v[96:99], v[132:135]
TR 48,24,32768
    v_mfma_f32_16x16x32_bf16 v[140:143], v[36:39], v[100:103], v[140:143]
TR 50,24,33792
    v_mfma_f32_16x16x32_bf16 v[148:151], v[36:39], v[104:107], v[148:151]
    buffer_load_dwordx4 v9, s[20:23], s52 offen offset:1024 lds
    v_mfma_f32_16x16x32_bf16 v[156:159], v[36:39], v[108:111], v[156:159]
LW 4
    v_mfma_f32_16x16x32_bf16 v[160:163], v[40:43], v[96:99], v[160:163]
TR 52,25,32768
    v_mfma_f32_16x16x32_bf16 v[168:171], v[40:43], v[100:103], v[168:171]
TR 54,25,33792
    v_mfma_f32_16x16x32_bf16 v[176:179], v[40:43], v[104:107], v[176:179]
    buffer_load_dwordx4 v10, s[20:23], s52 offen offset:2048 lds
    v_mfma_f32_16x16x32_bf16 v[184:187], v[40:43], v[108:111], v[184:187]
LW 4
    v_mfma_f32_16x16x32_bf16 v[164:167], v[44:47], v[96:99], v[164:167]
TR 56,26,32768
    v_mfma_f32_16x16x32_bf16 v[172:175], v[44:47], v[100:103], v[172:175]
TR 58,26,33792
    v_mfma_f32_16x16x32_bf16 v[180:183], v[44:47], v[104:107], v[180:183]
    buffer_load_dwordx4 v11, s[20:23], s52 offen offset:3072 lds
    v_mfma_f32_16x16x32_bf16 v[188:191], v[44:47], v[108:111], v[188:191]
    s_add_u32 s49, s48, 98304
LW 4
    v_mfma_f32_16x16x32_bf16 v[192:195], v[48:51], v[96:99], v[192:195]
TR 60,27,32768
    s_add_u32 m0, s41, 12288
    v_mfma_f32_16x16x32_bf16 v[200:203], v[48:51], v[100:103], v[200:203]
TR 62,27,33792
    v_mfma_f32_16x16x32_bf16 v[208:211], v[48:51], v[104:107], v[208:211]
    v_mfma_f32_16x16x32_bf16 v[216:219], v[48:51], v[108:111], v[216:219]
LW 4
    v_mfma_f32_16x16x32_bf16 v[196:199], v[52:55], v[96:99], v[196:199]
TR 32,20,40960
    v_mfma_f32_16x16x32_bf16 v[204:207], v[52:55], v[100:103], v[204:207]
TR 34,20,41984
    v_mfma_f32_16x16x32_bf16 v[212:215], v[52:55], v[104:107], v[212:215]
    buffer_load_dwordx4 v16, s[16:19], s49 offen offset:0 lds
    v_mfma_f32_16x16x32_bf16 v[220:223], v[52:55], v[108:111], v[220:223]
LW 4
    v_mfma_f32_16x16x32_bf16 v[224:227], v[56:59], v[96:99], v[224:227]
TR 36,21,40960
    v_mfma_f32_16x16x32_bf16 v[232:235], v[56:59], v[100:103], v[232:235]
TR 38,21,41984
    v_mfma_f32_16x16x32_bf16 v[240:243], v[56:59], v[104:107], v[240:243]
    buffer_load_dwordx4 v17, s[16:19], s49 offen offset:1024 lds
    v_mfma_f32_16x16x32_bf16 v[248:251], v[56:59], v[108:111], v[248:251]
LW 4
    v_mfma_f32_16x16x32_bf16 v[228:231], v[60:63], v[96:99], v[228:231]
TR 40,22,40960
    v_mfma_f32_16x16x32_bf16 v[236:239], v[60:63], v[100:103], v[236:239]
TR 42,22,41984
    v_mfma_f32_16x16x32_bf16 v[244:247], v[60:63], v[104:107], v[244:247]
    buffer_load_dwordx4 v18, s[16:19], s49 offen offset:2048 lds
    v_mfma_f32_16x16x32_bf16 v[252:255], v[60:63], v[108:111], v[252:255]
LW 4
    v_mfma_f32_16x16x32_bf16 v[128:131], v[32:35], v[112:115], v[128:131]
TR 44,23,40960
    v_mfma_f32_16x16x32_bf16 v[136:139], v[32:35], v[116:119], v[136:139]
TR 46,23,41984
    v_mfma_f32_16x16x32_bf16 v[144:147], v[32:35], v[120:123], v[144:147]
    buffer_load_dwordx4 v19, s[16:19], s49 offen offset:3072 lds
    v_mfma_f32_16x16x32_bf16 v[152:155], v[32:35], v[124:127], v[152:155]
    s_lshl_b32 s54, s48, 10
LW 4
    v_mfma_f32_16x16x32_bf16 v[132:135], v[36:39], v[112:115], v[132:135]
TR 48,24,40960
    s_add_u32 s54, s54, 131072
    v_mfma_f32_16x16x32_bf16 v[140:143], v[36:39], v[116:119], v[140:143]
TR 50,24,41984
    v_mfma_f32_16x16x32_bf16 v[148:151], v[36:39], v[120:123], v[148:151]
    v_mfma_f32_16x16x32_bf16 v[156:159], v[36:39], v[124:127], v[156:159]
    s_add_u32 s55, s54, 256
LW 4
    v_mfma_f32_16x16x32_bf16 v[160:163], v[40:43], v[112:115], v[160:163]
TR 52,25,40960
    v_mfma_f32_16x16x32_bf16 v[168:171], v[40:43], v[116:119], v[168:171]
TR 54,25,41984
    v_mfma_f32_16x16x32_bf16 v[176:179], v[40:43], v[120:123], v[176:179]
    v_mfma_f32_16x16x32_bf16 v[184:187], v[40:43], v[124:127], v[184:187]
LW 4
    v_mfma_f32_16x16x32_bf16 v[164:167], v[44:47], v[112:115], v[164:167]
TR 56,26,40960
    v_mfma_f32_16x16x32_bf16 v[172:175], v[44:47], v[116:119], v[172:175]
TR 58,26,41984
    v_mfma_f32_16x16x32_bf16 v[180:183], v[44:47], v[120:123], v[180:183]
    v_mfma_f32_16x16x32_bf16 v[188:191], v[44:47], v[124:127], v[188:191]
LW 4
    v_mfma_f32_16x16x32_bf16 v[192:195], v[48:51], v[112:115], v[192:195]
TR 60,27,40960
    v_mfma_f32_16x16x32_bf16 v[200:203], v[48:51], v[116:119], v[200:203]
TR 62,27,41984
    v_mfma_f32_16x16x32_bf16 v[208:211], v[48:51], v[120:123], v[208:211]
    v_mfma_f32_16x16x32_bf16 v[216:219], v[48:51], v[124:127], v[216:219]
LW 4
    v_mfma_f32_16x16x32_bf16 v[196:199], v[52:55], v[112:115], v[196:199]
    s_waitcnt vmcnt(16)
    s_barrier
TR 32,20,49152
    v_mfma_f32_16x16x32_bf16 v[204:207], v[52:55], v[116:119], v[204:207]
TR 34,20,50176
    v_mfma_f32_16x16x32_bf16 v[212:215], v[52:55], v[120:123], v[212:215]
    v_mfma_f32_16x16x32_bf16 v[220:223], v[52:55], v[124:127], v[220:223]
LW 4
    v_mfma_f32_16x16x32_bf16 v[224:227], v[56:59], v[112:115], v[224:227]
TR 36,21,49152
    v_mfma_f32_16x16x32_bf16 v[232:235], v[56:59], v[116:119], v[232:235]
TR 38,21,50176
    v_mfma_f32_16x16x32_bf16 v[240:243], v[56:59], v[120:123], v[240:243]
    v_mfma_f32_16x16x32_bf16 v[248:251], v[56:59], v[124:127], v[248:251]
LW 4
    v_mfma_f32_16x16x32_bf16 v[228:231], v[60:63], v[112:115], v[228:231]
TR 40,22,49152
    v_mfma_f32_16x16x32_bf16 v[236:239], v[60:63], v[116:119], v[236:239]
TR 42,22,50176
    v_mfma_f32_16x16x32_bf16 v[244:247], v[60:63], v[120:123], v[244:247]
    v_mfma_f32_16x16x32_bf16 v[252:255], v[60:63], v[124:127], v[252:255]
LW 4
    v_mfma_f32_16x16x32_bf16 a[0:3], v[32:35], v[96:99], a[0:3]
TR 44,23,49152
    s_add_u32 m0, s38, 16384
    v_mfma_f32_16x16x32_bf16 a[8:11], v[32:35], v[100:103], a[8:11]
TR 46,23,50176
    v_mfma_f32_16x16x32_bf16 a[16:19], v[32:35], v[104:107], a[16:19]
    buffer_load_dwordx4 v8, s[20:23], s53 offen offset:0 lds
    v_mfma_f32_16x16x32_bf16 a[24:27], v[32:35], v[108:111], a[24:27]
LW 4
    v_mfma_f32_16x16x32_bf16 a[4:7], v[36:39], v[96:99], a[4:7]
TR 48,24,49152
    v_mfma_f32_16x16x32_bf16 a[12:15], v[36:39], v[100:103], a[12:15]
TR 50,24,50176
    v_mfma_f32_16x16x32_bf16 a[20:23], v[36:39], v[104:107], a[20:23]
    buffer_load_dwordx4 v9, s[20:23], s53 offen offset:1024 lds
    v_mfma_f32_16x16x32_bf16 a[28:31], v[36:39], v[108:111], a[28:31]
LW 4
    v_mfma_f32_16x16x32_bf16 a[32:35], v[40:43], v[96:99], a[32:35]
TR 52,25,49152
    v_mfma_f32_16x16x32_bf16 a[40:43], v[40:43], v[100:103], a[40:43]
TR 54,25,50176
    v_mfma_f32_16x16x32_bf16 a[48:51], v[40:43], v[104:107], a[48:51]
    buffer_load_dwordx4 v10, s[20:23], s53 offen offset:2048 lds
    v_mfma_f32_16x16x32_bf16 a[56:59], v[40:43], v[108:111], a[56:59]
LW 4
    v_mfma_f32_16x16x32_bf16 a[36:39], v[44:47], v[96:99], a[36:39]
TR 56,26,49152
    v_mfma_f32_16x16x32_bf16 a[44:47], v[44:47], v[100:103], a[44:47]
TR 58,26,50176
    v_mfma_f32_16x16x32_bf16 a[52:55], v[44:47], v[104:107], a[52:55]
    buffer_load_dwordx4 v11, s[20:23], s53 offen offset:3072 lds
    v_mfma_f32_16x16x32_bf16 a[60:63], v[44:47], v[108:111], a[60:63]
    s_add_u32 s48, s48, 256
LW 4
    v_mfma_f32_16x16x32_bf16 a[64:67], v[48:51], v[96:99], a[64:67]
TR 60,27,49152
    v_mfma_f32_16x16x32_bf16 a[72:75], v[48:51], v[100:103], a[72:75]
TR 62,27,50176
    v_mfma_f32_16x16x32_bf16 a[80:83], v[48:51], v[104:107], a[80:83]
    v_mfma_f32_16x16x32_bf16 a[88:91], v[48:51], v[108:111], a[88:91]
LW 4
    v_mfma_f32_16x16x32_bf16 a[68:71], v[52:55], v[96:99], a[68:71]
TR 32,20,57344
    v_mfma_f32_16x16x32_bf16 a[76:79], v[52:55], v[100:103], a[76:79]
TR 34,20,58368
    v_mfma_f32_16x16x32_bf16 a[84:87], v[52:55], v[104:107], a[84:87]
    v_mfma_f32_16x16x32_bf16 a[92:95], v[52:55], v[108:111], a[92:95]
LW 4
    v_mfma_f32_16x16x32_bf16 a[96:99], v[56:59], v[96:99], a[96:99]
TR 36,21,57344
    v_mfma_f32_16x16x32_bf16 a[104:107], v[56:59], v[100:103], a[104:107]
TR 38,21,58368
    v_mfma_f32_16x16x32_bf16 a[112:115], v[56:59], v[104:107], a[112:115]
    v_mfma_f32_16x16x32_bf16 a[120:123], v[56:59], v[108:111], a[120:123]
LW 4
    v_mfma_f32_16x16x32_bf16 a[100:103], v[60:63], v[96:99], a[100:103]
TR 40,22,57344
    v_mfma_f32_16x16x32_bf16 a[108:111], v[60:63], v[100:103], a[108:111]
TR 42,22,58368
    v_mfma_f32_16x16x32_bf16 a[116:119], v[60:63], v[104:107], a[116:119]
    v_mfma_f32_16x16x32_bf16 a[124:127], v[60:63], v[108:111], a[124:127]
LW 4
    v_mfma_f32_16x16x32_bf16 a[0:3], v[32:35], v[112:115], a[0:3]
TR 44,23,57344
    v_mfma_f32_16x16x32_bf16 a[8:11], v[32:35], v[116:119], a[8:11]
TR 46,23,58368
    v_mfma_f32_16x16x32_bf16 a[16:19], v[32:35], v[120:123], a[16:19]
    v_mfma_f32_16x16x32_bf16 a[24:27], v[32:35], v[124:127], a[24:27]
LW 4
    v_mfma_f32_16x16x32_bf16 a[4:7], v[36:39], v[112:115], a[4:7]
TR 48,24,57344
    v_mfma_f32_16x16x32_bf16 a[12:15], v[36:39], v[116:119], a[12:15]
TR 50,24,58368
    v_mfma_f32_16x16x32_bf16 a[20:23], v[36:39], v[120:123], a[20:23]
    v_mfma_f32_16x16x32_bf16 a[28:31], v[36:39], v[124:127], a[28:31]
LW 4
    v_mfma_f32_16x16x32_bf16 a[32:35], v[40:43], v[112:115], a[32:35]
    s_waitcnt vmcnt(4)
    s_barrier
TR 52,25,57344
    v_mfma_f32_16x16x32_bf16 a[40:43], v[40:43], v[116:119], a[40:43]
TR 54,25,58368
    v_mfma_f32_16x16x32_bf16 a[48:51], v[40:43], v[120:123], a[48:51]
    ds_read_b128 v[64:67], v12 offset:0
    v_mfma_f32_16x16x32_bf16 a[56:59], v[40:43], v[124:127], a[56:59]
    ds_read_b128 v[68:71], v12 offset:4096
LW 6
    v_mfma_f32_16x16x32_bf16 a[36:39], v[44:47], v[112:115], a[36:39]
TR 56,26,57344
    v_mfma_f32_16x16x32_bf16 a[44:47], v[44:47], v[116:119], a[44:47]
TR 58,26,58368
    v_mfma_f32_16x16x32_bf16 a[52:55], v[44:47], v[120:123], a[52:55]
    ds_read_b128 v[72:75], v12 offset:8192
    v_mfma_f32_16x16x32_bf16 a[60:63], v[44:47], v[124:127], a[60:63]
    ds_read_b128 v[76:79], v12 offset:12288
LW 8
    v_mfma_f32_16x16x32_bf16 a[64:67], v[48:51], v[112:115], a[64:67]
TR 60,27,57344
    v_mfma_f32_16x16x32_bf16 a[72:75], v[48:51], v[116:119], a[72:75]
TR 62,27,58368
    v_mfma_f32_16x16x32_bf16 a[80:83], v[48:51], v[120:123], a[80:83]
    ds_read_b128 v[80:83], v13 offset:0
    v_mfma_f32_16x16x32_bf16 a[88:91], v[48:51], v[124:127], a[88:91]
    ds_read_b128 v[84:87], v13 offset:4096
LW 10
    v_mfma_f32_16x16x32_bf16 a[68:71], v[52:55], v[112:115], a[68:71]
TR 32,20,0
    v_mfma_f32_16x16x32_bf16 a[76:79], v[52:55], v[116:119], a[76:79]
TR 34,20,1024
    v_mfma_f32_16x16x32_bf16 a[84:87], v[52:55], v[120:123], a[84:87]
    ds_read_b128 v[88:91], v13 offset:8192
    v_mfma_f32_16x16x32_bf16 a[92:95], v[52:55], v[124:127], a[92:95]
    ds_read_b128 v[92:95], v13 offset:12288
LW 10
    v_mfma_f32_16x16x32_bf16 a[96:99], v[56:59], v[112:115], a[96:99]
TR 36,21,0
    v_mfma_f32_16x16x32_bf16 a[104:107], v[56:59], v[116:119], a[104:107]
TR 38,21,1024
    v_mfma_f32_16x16x32_bf16 a[112:115], v[56:59], v[120:123], a[112:115]
    v_mfma_f32_16x16x32_bf16 a[120:123], v[56:59], v[124:127], a[120:123]
LW 8
    v_mfma_f32_16x16x32_bf16 a[100:103], v[60:63], v[112:115], a[100:103]
TR 40,22,0
    v_mfma_f32_16x16x32_bf16 a[108:111], v[60:63], v[116:119], a[108:111]
TR 42,22,1024
    v_mfma_f32_16x16x32_bf16 a[116:119], v[60:63], v[120:123], a[116:119]
    v_mfma_f32_16x16x32_bf16 a[124:127], v[60:63], v[124:127], a[124:127]
    s_sub_u32 s37, s37, 1
    s_cmp_lg_u32 s37, 0
    s_cbranch_scc1 L_loop1
LW 4
    v_mfma_f32_16x16x32_bf16 v[128:131], v[32:35], v[64:67], v[128:131]
TR 44,23,0
    s_add_u32 m0, s38, 32768
    v_mfma_f32_16x16x32_bf16 v[136:139], v[32:35], v[68:71], v[136:139]
TR 46,23,1024
    v_mfma_f32_16x16x32_bf16 v[144:147], v[32:35], v[72:75], v[144:147]
    ds_read_b128 v[96:99], v14 offset:0
    buffer_load_dwordx4 v8, s[20:23], s54 offen offset:0 lds
    v_mfma_f32_16x16x32_bf16 v[152:155], v[32:35], v[76:79], v[152:155]
    ds_read_b128 v[100:103], v14 offset:4096
LW 6
    v_mfma_f32_16x16x32_bf16 v[132:135], v[36:39], v[64:67], v[132:135]
TR 48,24,0
    v_mfma_f32_16x16x32_bf16 v[140:143], v[36:39], v[68:71], v[140:143]
TR 50,24,1024
    v_mfma_f32_16x16x32_bf16 v[148:151], v[36:39], v[72:75], v[148:151]
    ds_read_b128 v[104:107], v14 offset:8192
    buffer_load_dwordx4 v9, s[20:23], s54 offen offset:1024 lds
    v_mfma_f32_16x16x32_bf16 v[156:159], v[36:39], v[76:79], v[156:159]
    ds_read_b128 v[108:111], v14 offset:12288
LW 8
    v_mfma_f32_16x16x32_bf16 v[160:163], v[40:43], v[64:67], v[160:163]
TR 52,25,0
    v_mfma_f32_16x16x32_bf16 v[168:171], v[40:43], v[68:71], v[168:171]
TR 54,25,1024
    v_mfma_f32_16x16x32_bf16 v[176:179], v[40:43], v[72:75], v[176:179]
    ds_read_b128 v[112:115], v15 offset:0
    buffer_load_dwordx4 v10, s[20:23], s54 offen offset:2048 lds
    v_mfma_f32_16x16x32_bf16 v[184:187], v[40:43], v[76:79], v[184:187]
    ds_read_b128 v[116:119], v15 offset:4096
LW 10
    v_mfma_f32_16x16x32_bf16 v[164:167], v[44:47], v[64:67], v[164:167]
TR 56,26,0
    v_mfma_f32_16x16x32_bf16 v[172:175], v[44:47], v[68:71], v[172:175]
TR 58,26,1024
    v_mfma_f32_16x16x32_bf16 v[180:183], v[44:47], v[72:75], v[180:183]
    ds_read_b128 v[120:123], v15 offset:8192
    buffer_load_dwordx4 v11, s[20:23], s54 offen offset:3072 lds
    v_mfma_f32_16x16x32_bf16 v[188:191], v[44:47], v[76:79], v[188:191]
    ds_read_b128 v[124:127], v15 offset:12288
    s_add_u32 s49, s48, 0
LW 10
    v_mfma_f32_16x16x32_bf16 v[192:195], v[48:51], v[64:67], v[192:195]
TR 60,27,0
    s_add_u32 m0, s41, 0
    v_mfma_f32_16x16x32_bf16 v[200:203], v[48:51], v[68:71], v[200:203]
TR 62,27,1024
    v_mfma_f32_16x16x32_bf16 v[208:211], v[48:51], v[72:75], v[208:211]
    v_mfma_f32_16x16x32_bf16 v[216:219], v[48:51], v[76:79], v[216:219]
LW 8
    v_mfma_f32_16x16x32_bf16 v[196:199], v[52:55], v[64:67], v[196:199]
TR 32,20,8192
    v_mfma_f32_16x16x32_bf16 v[204:207], v[52:55], v[68:71], v[204:207]
TR 34,20,9216
    v_mfma_f32_16x16x32_bf16 v[212:215], v[52:55], v[72:75], v[212:215]
    v_mfma_f32_16x16x32_bf16 v[220:223], v[52:55], v[76:79], v[220:223]
LW 6
    v_mfma_f32_16x16x32_bf16 v[224:227], v[56:59], v[64:67], v[224:227]
TR 36,21,8192
    v_mfma_f32_16x16x32_bf16 v[232:235], v[56:59], v[68:71], v[232:235]
TR 38,21,9216
    v_mfma_f32_16x16x32_bf16 v[240:243], v[56:59], v[72:75], v[240:243]
    v_mfma_f32_16x16x32_bf16 v[248:251], v[56:59], v[76:79], v[248:251]
LW 4
    v_mfma_f32_16x16x32_bf16 v[228:231], v[60:63], v[64:67], v[228:231]
TR 40,22,8192
    v_mfma_f32_16x16x32_bf16 v[236:239], v[60:63], v[68:71], v[236:239]
TR 42,22,9216
    v_mfma_f32_16x16x32_bf16 v[244:247], v[60:63], v[72:75], v[244:247]
    buffer_load_dwordx4 v16, s[16:19], s49 offen offset:0 lds
    v_mfma_f32_16x16x32_bf16 v[252:255], v[60:63], v[76:79], v[252:255]
LW 4
    v_mfma_f32_16x16x32_bf16 v[128:131], v[32:35], v[80:83], v[128:131]
TR 44,23,8192
    v_mfma_f32_16x16x32_bf16 v[136:139], v[32:35], v[84:87], v[136:139]
TR 46,23,9216
    v_mfma_f32_16x16x32_bf16 v[144:147], v[32:35], v[88:91], v[144:147]
    v_mfma_f32_16x16x32_bf16 v[152:155], v[32:35], v[92:95], v[152:155]
LW 4
    v_mfma_f32_16x16x32_bf16 v[132:135], v[36:39], v[80:83], v[132:135]
TR 48,24,8192
    v_mfma_f32_16x16x32_bf16 v[140:143], v[36:39], v[84:87], v[140:143]
TR 50,24,9216
    v_mfma_f32_16x16x32_bf16 v[148:151], v[36:39], v[88:91], v[148:151]
    buffer_load_dwordx4 v17, s[16:19], s49 offen offset:1024 lds
    v_mfma_f32_16x16x32_bf16 v[156:159], v[36:39], v[92:95], v[156:159]
LW 4
    v_mfma_f32_16x16x32_bf16 v[160:163], v[40:43], v[80:83], v[160:163]
TR 52,25,8192
    v_mfma_f32_16x16x32_bf16 v[168:171], v[40:43], v[84:87], v[168:171]
TR 54,25,9216
    v_mfma_f32_16x16x32_bf16 v[176:179], v[40:43], v[88:91], v[176:179]
    v_mfma_f32_16x16x32_bf16 v[184:187], v[40:43], v[92:95], v[184:187]
LW 4
    v_mfma_f32_16x16x32_bf16 v[164:167], v[44:47], v[80:83], v[164:167]
TR 56,26,8192
    v_mfma_f32_16x16x32_bf16 v[172:175], v[44:47], v[84:87], v[172:175]
TR 58,26,9216
    v_mfma_f32_16x16x32_bf16 v[180:183], v[44:47], v[88:91], v[180:183]
    buffer_load_dwordx4 v18, s[16:19], s49 offen offset:2048 lds
    v_mfma_f32_16x16x32_bf16 v[188:191], v[44:47], v[92:95], v[188:191]
LW 4
    v_mfma_f32_16x16x32_bf16 v[192:195], v[48:51], v[80:83], v[192:195]
TR 60,27,8192
    v_mfma_f32_16x16x32_bf16 v[200:203], v[48:51], v[84:87], v[200:203]
TR 62,27,9216
    v_mfma_f32_16x16x32_bf16 v[208:211], v[48:51], v[88:91], v[208:211]
    v_mfma_f32_16x16x32_bf16 v[216:219], v[48:51], v[92:95], v[216:219]
LW 4
    v_mfma_f32_16x16x32_bf16 v[196:199], v[52:55], v[80:83], v[196:199]
    s_waitcnt vmcnt(7)
    s_barrier
TR 32,20,16384
    v_mfma_f32_16x16x32_bf16 v[204:207], v[52:55], v[84:87], v[204:207]
TR 34,20,17408
    v_mfma_f32_16x16x32_bf16 v[212:215], v[52:55], v[88:91], v[212:215]
    buffer_load_dwordx4 v19, s[16:19], s49 offen offset:3072 lds
    v_mfma_f32_16x16x32_bf16 v[220:223], v[52:55], v[92:95], v[220:223]
LW 4
    v_mfma_f32_16x16x32_bf16 v[224:227], v[56:59], v[80:83], v[224:227]
TR 36,21,16384
    v_mfma_f32_16x16x32_bf16 v[232:235], v[56:59], v[84:87], v[232:235]
TR 38,21,17408
    v_mfma_f32_16x16x32_bf16 v[240:243], v[56:59], v[88:91], v[240:243]
    v_mfma_f32_16x16x32_bf16 v[248:251], v[56:59], v[92:95], v[248:251]
LW 4
    v_mfma_f32_16x16x32_bf16 v[228:231], v[60:63], v[80:83], v[228:231]
TR 40,22,16384
    v_mfma_f32_16x16x32_bf16 v[236:239], v[60:63], v[84:87], v[236:239]
TR 42,22,17408
    v_mfma_f32_16x16x32_bf16 v[244:247], v[60:63], v[88:91], v[244:247]
    v_mfma_f32_16x16x32_bf16 v[252:255], v[60:63], v[92:95], v[252:255]
LW 4
    v_mfma_f32_16x16x32_bf16 a[0:3], v[32:35], v[64:67], a[0:3]
TR 44,23,16384
    s_add_u32 m0, s38, 49152
    v_mfma_f32_16x16x32_bf16 a[8:11], v[32:35], v[68:71], a[8:11]
TR 46,23,17408
    v_mfma_f32_16x16x32_bf16 a[16:19], v[32:35], v[72:75], a[16:19]
    buffer_load_dwordx4 v8, s[20:23], s55 offen offset:0 lds
    v_mfma_f32_16x16x32_bf16 a[24:27], v[32:35], v[76:79], a[24:27]
LW 4
    v_mfma_f32_16x16x32_bf16 a[4:7], v[36:39], v[64:67], a[4:7]
TR 48,24,16384
    v_mfma_f32_16x16x32_bf16 a[12:15], v[36:39], v[68:71], a[12:15]
TR 50,24,17408
    v_mfma_f32_16x16x32_bf16 a[20:23], v[36:39], v[72:75], a[20:23]
    buffer_load_dwordx4 v9, s[20:23], s55 offen offset:1024 lds
    v_mfma_f32_16x16x32_bf16 a[28:31], v[36:39], v[76:79], a[28:31]
LW 4
    v_mfma_f32_16x16x32_bf16 a[32:35], v[40:43], v[64:67], a[32:35]
TR 52,25,16384
    v_mfma_f32_16x16x32_bf16 a[40:43], v[40:43], v[68:71], a[40:43]
TR 54,25,17408
    v_mfma_f32_16x16x32_bf16 a[48:51], v[40:43], v[72:75], a[48:51]
    buffer_load_dwordx4 v10, s[20:23], s55 offen offset:2048 lds
    v_mfma_f32_16x16x32_bf16 a[56:59], v[40:43], v[76:79], a[56:59]
LW 4
    v_mfma_f32_16x16x32_bf16 a[36:39], v[44:47], v[64:67], a[36:39]
TR 56,26,16384
    v_mfma_f32_16x16x32_bf16 a[44:47], v[44:47], v[68:71], a[44:47]
TR 58,26,17408
    v_mfma_f32_16x16x32_bf16 a[52:55], v[44:47], v[72:75], a[52:55]
    buffer_load_dwordx4 v11, s[20:23], s55 offen offset:3072 lds
    v_mfma_f32_16x16x32_bf16 a[60:63], v[44:47], v[76:79], a[60:63]
    s_add_u32 s49, s48, 32768
LW 4
    v_mfma_f32_16x16x32_bf16 a[64:67], v[48:51], v[64:67], a[64:67]
TR 60,27,16384
    s_add_u32 m0, s41, 4096
    v_mfma_f32_16x16x32_bf16 a[72:75], v[48:51], v[68:71], a[72:75]
TR 62,27,17408
    v_mfma_f32_16x16x32_bf16 a[80:83], v[48:51], v[72:75], a[80:83]
    v_mfma_f32_16x16x32_bf16 a[88:91], v[48:51], v[76:79], a[88:91]
LW 4
    v_mfma_f32_16x16x32_bf16 a[68:71], v[52:55], v[64:67], a[68:71]
TR 32,20,24576
    v_mfma_f32_16x16x32_bf16 a[76:79], v[52:55], v[68:71], a[76:79]
TR 34,20,25600
    v_mfma_f32_16x16x32_bf16 a[84:87], v[52:55], v[72:75], a[84:87]
    buffer_load_dwordx4 v16, s[16:19], s49 offen offset:0 lds
    v_mfma_f32_16x16x32_bf16 a[92:95], v[52:55], v[76:79], a[92:95]
LW 4
    v_mfma_f32_16x16x32_bf16 a[96:99], v[56:59], v[64:67], a[96:99]
TR 36,21,24576
    v_mfma_f32_16x16x32_bf16 a[104:107], v[56:59], v[68:71], a[104:107]
TR 38,21,25600
    v_mfma_f32_16x16x32_bf16 a[112:115], v[56:59], v[72:75], a[112:115]
    buffer_load_dwordx4 v17, s[16:19], s49 offen offset:1024 lds
    v_mfma_f32_16x16x32_bf16 a[120:123], v[56:59], v[76:79], a[120:123]
LW 4
    v_mfma_f32_16x16x32_bf16 a[100:103], v[60:63], v[64:67], a[100:103]
TR 40,22,24576
    v_mfma_f32_16x16x32_bf16 a[108:111], v[60:63], v[68:71], a[108:111]
TR 42,22,25600
    v_mfma_f32_16x16x32_bf16 a[116:119], v[60:63], v[72:75], a[116:119]
    buffer_load_dwordx4 v18, s[16:19], s49 offen offset:2048 lds
    v_mfma_f32_16x16x32_bf16 a[124:127], v[60:63], v[76:79], a[124:127]
LW 4
    v_mfma_f32_16x16x32_bf16 a[0:3], v[32:35], v[80:83], a[0:3]
TR 44,23,24576
    v_mfma_f32_16x16x32_bf16 a[8:11], v[32:35], v[84:87], a[8:11]
TR 46,23,25600
    v_mfma_f32_16x16x32_bf16 a[16:19], v[32:35], v[88:91], a[16:19]
    buffer_load_dwordx4 v19, s[16:19], s49 offen offset:3072 lds
    v_mfma_f32_16x16x32_bf16 a[24:27], v[32:35], v[92:95], a[24:27]
    s_add_u32 s49, s48, 65536
LW 4
    v_mfma_f32_16x16x32_bf16 a[4:7], v[36:39], v[80:83], a[4:7]
TR 48,24,24576
    s_add_u32 m0, s41, 8192
    v_mfma_f32_16x16x32_bf16 a[12:15], v[36:39], v[84:87], a[12:15]
TR 50,24,25600
    v_mfma_f32_16x16x32_bf16 a[20:23], v[36:39], v[88:91], a[20:23]
    buffer_load_dwordx4 v16, s[16:19], s49 offen offset:0 lds
    v_mfma_f32_16x16x32_bf16 a[28:31], v[36:39], v[92:95], a[28:31]
LW 4
    v_mfma_f32_16x16x32_bf16 a[32:35], v[40:43], v[80:83], a[32:35]
TR 52,25,24576
    v_mfma_f32_16x16x32_bf16 a[40:43], v[40:43], v[84:87], a[40:43]
TR 54,25,25600
    v_mfma_f32_16x16x32_bf16 a[48:51], v[40:43], v[88:91], a[48:51]
    buffer_load_dwordx4 v17, s[16:19], s49 offen offset:1024 lds
    v_mfma_f32_16x16x32_bf16 a[56:59], v[40:43], v[92:95], a[56:59]
LW 4
    v_mfma_f32_16x16x32_bf16 a[36:39], v[44:47], v[80:83], a[36:39]
TR 56,26,24576
    v_mfma_f32_16x16x32_bf16 a[44:47], v[44:47], v[84:87], a[44:47]
TR 58,26,25600
    v_mfma_f32_16x16x32_bf16 a[52:55], v[44:47], v[88:91], a[52:55]
    buffer_load_dwordx4 v18, s[16:19], s49 offen offset:2048 lds
    v_mfma_f32_16x16x32_bf16 a[60:63], v[44:47], v[92:95], a[60:63]
LW 4
    v_mfma_f32_16x16x32_bf16 a[64:67], v[48:51], v[80:83], a[64:67]
TR 60,27,24576
    v_mfma_f32_16x16x32_bf16 a[72:75], v[48:51], v[84:87], a[72:75]
TR 62,27,25600
    v_mfma_f32_16x16x32_bf16 a[80:83], v[48:51], v[88:91], a[80:83]
    buffer_load_dwordx4 v19, s[16:19], s49 offen offset:3072 lds
    v_mfma_f32_16x16x32_bf16 a[88:91], v[48:51], v[92:95], a[88:91]
    s_lshl_b32 s52, s48, 10
LW 4
    v_mfma_f32_16x16x32_bf16 a[68:71], v[52:55], v[80:83], a[68:71]
    s_waitcnt vmcnt(16)
    s_barrier
TR 32,20,32768
    s_add_u32 s53, s52, 256
    v_mfma_f32_16x16x32_bf16 a[76:79], v[52:55], v[84:87], a[76:79]
TR 34,20,33792
    v_mfma_f32_16x16x32_bf16 a[84:87], v[52:55], v[88:91], a[84:87]
    v_mfma_f32_16x16x32_bf16 a[92:95], v[52:55], v[92:95], a[92:95]
LW 4
    v_mfma_f32_16x16x32_bf16 a[96:99], v[56:59], v[80:83], a[96:99]
TR 36,21,32768
    v_mfma_f32_16x16x32_bf16 a[104:107], v[56:59], v[84:87], a[104:107]
TR 38,21,33792
    v_mfma_f32_16x16x32_bf16 a[112:115], v[56:59], v[88:91], a[112:115]
    v_mfma_f32_16x16x32_bf16 a[120:123], v[56:59], v[92:95], a[120:123]
LW 4
    v_mfma_f32_16x16x32_bf16 a[100:103], v[60:63], v[80:83], a[100:103]
TR 40,22,32768
    v_mfma_f32_16x16x32_bf16 a[108:111], v[60:63], v[84:87], a[108:111]
TR 42,22,33792
    v_mfma_f32_16x16x32_bf16 a[116:119], v[60:63], v[88:91], a[116:119]
    v_mfma_f32_16x16x32_bf16 a[124:127], v[60:63], v[92:95], a[124:127]
LW 4
    v_mfma_f32_16x16x32_bf16 v[128:131], v[32:35], v[96:99], v[128:131]
TR 44,23,32768
    s_add_u32 m0, s38, 0
    v_mfma_f32_16x16x32_bf16 v[136:139], v[32:35], v[100:103], v[136:139]
TR 46,23,33792
    v_mfma_f32_16x16x32_bf16 v[144:147], v[32:35], v[104:107], v[144:147]
    buffer_load_dwordx4 v8, s[20:23], s52 offen offset:0 lds
    v_mfma_f32_16x16x32_bf16 v[152:155], v[32:35], v[108:111], v[152:155]
LW 4
    v_mfma_f32_16x16x32_bf16 v[132:135], v[36:39], v[96:99], v[132:135]
TR 48,24,32768
    v_mfma_f32_16x16x32_bf16 v[140:143], v[36:39], v[100:103], v[140:143]
TR 50,24,33792
    v_mfma_f32_16x16x32_bf16 v[148:151], v[36:39], v[104:107], v[148:151]
    buffer_load_dwordx4 v9, s[20:23], s52 offen offset:1024 lds
    v_mfma_f32_16x16x32_bf16 v[156:159], v[36:39], v[108:111], v[156:159]
LW 4
    v_mfma_f32_16x16x32_bf16 v[160:163], v[40:43], v[96:99], v[160:163]
TR 52,25,32768
    v_mfma_f32_16x16x32_bf16 v[168:171], v[40:43], v[100:103], v[168:171]
TR 54,25,33792
    v_mfma_f32_16x16x32_bf16 v[176:179], v[40:43], v[104:107], v[176:179]
    buffer_load_dwordx4 v10, s[20:23], s52 offen offset:2048 lds
    v_mfma_f32_16x16x32_bf16 v[184:187], v[40:43], v[108:111], v[184:187]
LW 4
    v_mfma_f32_16x16x32_bf16 v[164:167], v[44:47], v[96:99], v[164:167]
TR 56,26,32768
    v_mfma_f32_16x16x32_bf16 v[172:175], v[44:47], v[100:103], v[172:175]
TR 58,26,33792
    v_mfma_f32_16x16x32_bf16 v[180:183], v[44:47], v[104:107], v[180:183]
    buffer_load_dwordx4 v11, s[20:23], s52 offen offset:3072 lds
    v_mfma_f32_16x16x32_bf16 v[188:191], v[44:47], v[108:111], v[188:191]
    s_add_u32 s49, s48, 98304
LW 4
    v_mfma_f32_16x16x32_bf16 v[192:195], v[48:51], v[96:99], v[192:195]
TR 60,27,32768
    s_add_u32 m0, s41, 12288
    v_mfma_f32_16x16x32_bf16 v[200:203], v[48:51], v[100:103], v[200:203]
TR 62,27,33792
    v_mfma_f32_16x16x32_bf16 v[208:211], v[48:51], v[104:107], v[208:211]
    v_mfma_f32_16x16x32_bf16 v[216:219], v[48:51], v[108:111], v[216:219]
LW 4
    v_mfma_f32_16x16x32_bf16 v[196:199], v[52:55], v[96:99], v[196:199]
TR 32,20,40960
    v_mfma_f32_16x16x32_bf16 v[204:207], v[52:55], v[100:103], v[204:207]
TR 34,20,41984
    v_mfma_f32_16x16x32_bf16 v[212:215], v[52:55], v[104:107], v[212:215]
    buffer_load_dwordx4 v16, s[16:19], s49 offen offset:0 lds
    v_mfma_f32_16x16x32_bf16 v[220:223], v[52:55], v[108:111], v[220:223]
LW 4
    v_mfma_f32_16x16x32_bf16 v[224:227], v[56:59], v[96:99], v[224:227]
TR 36,21,40960
    v_mfma_f32_16x16x32_bf16 v[232:235], v[56:59], v[100:103], v[232:235]
TR 38,21,41984
    v_mfma_f32_16x16x32_bf16 v[240:243], v[56:59], v[104:107], v[240:243]
    buffer_load_dwordx4 v17, s[16:19], s49 offen offset:1024 lds
    v_mfma_f32_16x16x32_bf16 v[248:251], v[56:59], v[108:111], v[248:251]
LW 4
    v_mfma_f32_16x16x32_bf16 v[228:231], v[60:63], v[96:99], v[228:231]
TR 40,22,40960
    v_mfma_f32_16x16x32_bf16 v[236:239], v[60:63], v[100:103], v[236:239]
TR 42,22,41984
    v_mfma_f32_16x16x32_bf16 v[244:247], v[60:63], v[104:107], v[244:247]
    buffer_load_dwordx4 v18, s[16:19], s49 offen offset:2048 lds
    v_mfma_f32_16x16x32_bf16 v[252:255], v[60:63], v[108:111], v[252:255]
LW 4
    v_mfma_f32_16x16x32_bf16 v[128:131], v[32:35], v[112:115], v[128:131]
TR 44,23,40960
    v_mfma_f32_16x16x32_bf16 v[136:139], v[32:35], v[116:119], v[136:139]
TR 46,23,41984
    v_mfma_f32_16x16x32_bf16 v[144:147], v[32:35], v[120:123], v[144:147]
    buffer_load_dwordx4 v19, s[16:19], s49 offen offset:3072 lds
    v_mfma_f32_16x16x32_bf16 v[152:155], v[32:35], v[124:127], v[152:155]
    s_lshl_b32 s54, s48, 10
LW 4
    v_mfma_f32_16x16x32_bf16 v[132:135], v[36:39], v[112:115], v[132:135]
TR 48,24,40960
    s_add_u32 s54, s54, 131072
    v_mfma_f32_16x16x32_bf16 v[140:143], v[36:39], v[116:119], v[140:143]
TR 50,24,41984
    v_mfma_f32_16x16x32_bf16 v[148:151], v[36:39], v[120:123], v[148:151]
    v_mfma_f32_16x16x32_bf16 v[156:159], v[36:39], v[124:127], v[156:159]
    s_add_u32 s55, s54, 256
LW 4
    v_mfma_f32_16x16x32_bf16 v[160:163], v[40:43], v[112:115], v[160:163]
TR 52,25,40960
    v_mfma_f32_16x16x32_bf16 v[168:171], v[40:43], v[116:119], v[168:171]
TR 54,25,41984
    v_mfma_f32_16x16x32_bf16 v[176:179], v[40:43], v[120:123], v[176:179]
    v_mfma_f32_16x16x32_bf16 v[184:187], v[40:43], v[124:127], v[184:187]
LW 4
    v_mfma_f32_16x16x32_bf16 v[164:167], v[44:47], v[112:115], v[164:167]
TR 56,26,40960
    v_mfma_f32_16x16x32_bf16 v[172:175], v[44:47], v[116:119], v[172:175]
TR 58,26,41984
    v_mfma_f32_16x16x32_bf16 v[180:183], v[44:47], v[120:123], v[180:183]
    v_mfma_f32_16x16x32_bf16 v[188:191], v[44:47], v[124:127], v[188:191]
LW 4
    v_mfma_f32_16x16x32_bf16 v[192:195], v[48:51], v[112:115], v[192:195]
TR 60,27,40960
    v_mfma_f32_16x16x32_bf16 v[200:203], v[48:51], v[116:119], v[200:203]
TR 62,27,41984
    v_mfma_f32_16x16x32_bf16 v[208:211], v[48:51], v[120:123], v[208:211]
    v_mfma_f32_16x16x32_bf16 v[216:219], v[48:51], v[124:127], v[216:219]
LW 4
    v_mfma_f32_16x16x32_bf16 v[196:199], v[52:55], v[112:115], v[196:199]
    s_waitcnt vmcnt(16)
    s_barrier
TR 32,20,49152
    v_mfma_f32_16x16x32_bf16 v[204:207], v[52:55], v[116:119], v[204:207]
TR 34,20,50176
    v_mfma_f32_16x16x32_bf16 v[212:215], v[52:55], v[120:123], v[212:215]
    v_mfma_f32_16x16x32_bf16 v[220:223], v[52:55], v[124:127], v[220:223]
LW 4
    v_mfma_f32_16x16x32_bf16 v[224:227], v[56:59], v[112:115], v[224:227]
TR 36,21,49152
    v_mfma_f32_16x16x32_bf16 v[232:235], v[56:59], v[116:119], v[232:235]
TR 38,21,50176
    v_mfma_f32_16x16x32_bf16 v[240:243], v[56:59], v[120:123], v[240:243]
    v_mfma_f32_16x16x32_bf16 v[248:251], v[56:59], v[124:127], v[248:251]
LW 4
    v_mfma_f32_16x16x32_bf16 v[228:231], v[60:63], v[112:115], v[228:231]
TR 40,22,49152
    v_mfma_f32_16x16x32_bf16 v[236:239], v[60:63], v[116:119], v[236:239]
TR 42,22,50176
    v_mfma_f32_16x16x32_bf16 v[244:247], v[60:63], v[120:123], v[244:247]
    v_mfma_f32_16x16x32_bf16 v[252:255], v[60:63], v[124:127], v[252:255]
LW 4
    v_mfma_f32_16x16x32_bf16 a[0:3], v[32:35], v[96:99], a[0:3]
TR 44,23,49152
    s_add_u32 m0, s38, 16384
    v_mfma_f32_16x16x32_bf16 a[8:11], v[32:35], v[100:103], a[8:11]
TR 46,23,50176
    v_mfma_f32_16x16x32_bf16 a[16:19], v[32:35], v[104:107], a[16:19]
    buffer_load_dwordx4 v8, s[20:23], s54 offen offset:0 lds
    v_mfma_f32_16x16x32_bf16 a[24:27], v[32:35], v[108:111], a[24:27]
LW 4
    v_mfma_f32_16x16x32_bf16 a[4:7], v[36:39], v[96:99], a[4:7]
TR 48,24,49152
    v_mfma_f32_16x16x32_bf16 a[12:15], v[36:39], v[100:103], a[12:15]
TR 50,24,50176
    v_mfma_f32_16x16x32_bf16 a[20:23], v[36:39], v[104:107], a[20:23]
    buffer_load_dwordx4 v9, s[20:23], s54 offen offset:1024 lds
    v_mfma_f32_16x16x32_bf16 a[28:31], v[36:39], v[108:111], a[28:31]
LW 4
    v_mfma_f32_16x16x32_bf16 a[32:35], v[40:43], v[96:99], a[32:35]
TR 52,25,49152
    v_mfma_f32_16x16x32_bf16 a[40:43], v[40:43], v[100:103], a[40:43]
TR 54,25,50176
    v_mfma_f32_16x16x32_bf16 a[48:51], v[40:43], v[104:107], a[48:51]
    buffer_load_dwordx4 v10, s[20:23], s54 offen offset:2048 lds
    v_mfma_f32_16x16x32_bf16 a[56:59], v[40:43], v[108:111], a[56:59]
LW 4
    v_mfma_f32_16x16x32_bf16 a[36:39], v[44:47], v[96:99], a[36:39]
TR 56,26,49152
    v_mfma_f32_16x16x32_bf16 a[44:47], v[44:47], v[100:103], a[44:47]
TR 58,26,50176
    v_mfma_f32_16x16x32_bf16 a[52:55], v[44:47], v[104:107], a[52:55]
    buffer_load_dwordx4 v11, s[20:23], s54 offen offset:3072 lds
    v_mfma_f32_16x16x32_bf16 a[60:63], v[44:47], v[108:111], a[60:63]
    s_add_u32 s48, s48, 256
LW 4
    v_mfma_f32_16x16x32_bf16 a[64:67], v[48:51], v[96:99], a[64:67]
TR 60,27,49152
    v_mfma_f32_16x16x32_bf16 a[72:75], v[48:51], v[100:103], a[72:75]
TR 62,27,50176
    v_mfma_f32_16x16x32_bf16 a[80:83], v[48:51], v[104:107], a[80:83]
    v_mfma_f32_16x16x32_bf16 a[88:91], v[48:51], v[108:111], a[88:91]
LW 4
    v_mfma_f32_16x16x32_bf16 a[68:71], v[52:55], v[96:99], a[68:71]
TR 32,20,57344
    v_mfma_f32_16x16x32_bf16 a[76:79], v[52:55], v[100:103], a[76:79]
TR 34,20,58368
    v_mfma_f32_16x16x32_bf16 a[84:87], v[52:55], v[104:107], a[84:87]
    v_mfma_f32_16x16x32_bf16 a[92:95], v[52:55], v[108:111], a[92:95]
LW 4
    v_mfma_f32_16x16x32_bf16 a[96:99], v[56:59], v[96:99], a[96:99]
TR 36,21,57344
    v_mfma_f32_16x16x32_bf16 a[104:107], v[56:59], v[100:103], a[104:107]
TR 38,21,58368
    v_mfma_f32_16x16x32_bf16 a[112:115], v[56:59], v[104:107], a[112:115]
    v_mfma_f32_16x16x32_bf16 a[120:123], v[56:59], v[108:111], a[120:123]
LW 4
    v_mfma_f32_16x16x32_bf16 a[100:103], v[60:63], v[96:99], a[100:103]
TR 40,22,57344
    v_mfma_f32_16x16x32_bf16 a[108:111], v[60:63], v[100:103], a[108:111]
TR 42,22,58368
    v_mfma_f32_16x16x32_bf16 a[116:119], v[60:63], v[104:107], a[116:119]
    v_mfma_f32_16x16x32_bf16 a[124:127], v[60:63], v[108:111], a[124:127]
LW 4
    v_mfma_f32_16x16x32_bf16 a[0:3], v[32:35], v[112:115], a[0:3]
TR 44,23,57344
    v_mfma_f32_16x16x32_bf16 a[8:11], v[32:35], v[116:119], a[8:11]
TR 46,23,58368
    v_mfma_f32_16x16x32_bf16 a[16:19], v[32:35], v[120:123], a[16:19]
    v_mfma_f32_16x16x32_bf16 a[24:27], v[32:35], v[124:127], a[24:27]
LW 4
    v_mfma_f32_16x16x32_bf16 a[4:7], v[36:39], v[112:115], a[4:7]
TR 48,24,57344
    v_mfma_f32_16x16x32_bf16 a[12:15], v[36:39], v[116:119], a[12:15]
TR 50,24,58368
    v_mfma_f32_16x16x32_bf16 a[20:23], v[36:39], v[120:123], a[20:23]
    v_mfma_f32_16x16x32_bf16 a[28:31], v[36:39], v[124:127], a[28:31]
LW 4
    v_mfma_f32_16x16x32_bf16 a[32:35], v[40:43], v[112:115], a[32:35]
    s_waitcnt vmcnt(4)
    s_barrier
TR 52,25,57344
    v_mfma_f32_16x16x32_bf16 a[40:43], v[40:43], v[116:119], a[40:43]
TR 54,25,58368
    v_mfma_f32_16x16x32_bf16 a[48:51], v[40:43], v[120:123], a[48:51]
    ds_read_b128 v[64:67], v12 offset:0
    v_mfma_f32_16x16x32_bf16 a[56:59], v[40:43], v[124:127], a[56:59]
    ds_read_b128 v[68:71], v12 offset:4096
LW 6
    v_mfma_f32_16x16x32_bf16 a[36:39], v[44:47], v[112:115], a[36:39]
TR 56,26,57344
    v_mfma_f32_16x16x32_bf16 a[44:47], v[44:47], v[116:119], a[44:47]
TR 58,26,58368
    v_mfma_f32_16x16x32_bf16 a[52:55], v[44:47], v[120:123], a[52:55]
    ds_read_b128 v[72:75], v12 offset:8192
    v_mfma_f32_16x16x32_bf16 a[60:63], v[44:47], v[124:127], a[60:63]
    ds_read_b128 v[76:79], v12 offset:12288
LW 8
    v_mfma_f32_16x16x32_bf16 a[64:67], v[48:51], v[112:115], a[64:67]
TR 60,27,57344
    v_mfma_f32_16x16x32_bf16 a[72:75], v[48:51], v[116:119], a[72:75]
TR 62,27,58368
    v_mfma_f32_16x16x32_bf16 a[80:83], v[48:51], v[120:123], a[80:83]
    ds_read_b128 v[80:83], v13 offset:0
    v_mfma_f32_16x16x32_bf16 a[88:91], v[48:51], v[124:127], a[88:91]
    ds_read_b128 v[84:87], v13 offset:4096
LW 10
    v_mfma_f32_16x16x32_bf16 a[68:71], v[52:55], v[112:115], a[68:71]
TR 32,20,0
    v_mfma_f32_16x16x32_bf16 a[76:79], v[52:55], v[116:119], a[76:79]
TR 34,20,1024
    v_mfma_f32_16x16x32_bf16 a[84:87], v[52:55], v[120:123], a[84:87]
    ds_read_b128 v[88:91], v13 offset:8192
    v_mfma_f32_16x16x32_bf16 a[92:95], v[52:55], v[124:127], a[92:95]
    ds_read_b128 v[92:95], v13 offset:12288
LW 10
    v_mfma_f32_16x16x32_bf16 a[96:99], v[56:59], v[112:115], a[96:99]
TR 36,21,0
    v_mfma_f32_16x16x32_bf16 a[104:107], v[56:59], v[116:119], a[104:107]
TR 38,21,1024
    v_mfma_f32_16x16x32_bf16 a[112:115], v[56:59], v[120:123], a[112:115]
    v_mfma_f32_16x16x32_bf16 a[120:123], v[56:59], v[124:127], a[120:123]
LW 8
    v_mfma_f32_16x16x32_bf16 a[100:103], v[60:63], v[112:115], a[100:103]
TR 40,22,0
    v_mfma_f32_16x16x32_bf16 a[108:111], v[60:63], v[116:119], a[108:111]
TR 42,22,1024
    v_mfma_f32_16x16x32_bf16 a[116:119], v[60:63], v[120:123], a[116:119]
    v_mfma_f32_16x16x32_bf16 a[124:127], v[60:63], v[124:127], a[124:127]
LW 4
    v_mfma_f32_16x16x32_bf16 v[128:131], v[32:35], v[64:67], v[128:131]
TR 44,23,0
    s_add_u32 m0, s38, 32768
    v_mfma_f32_16x16x32_bf16 v[136:139], v[32:35], v[68:71], v[136:139]
TR 46,23,1024
    v_mfma_f32_16x16x32_bf16 v[144:147], v[32:35], v[72:75], v[144:147]
    ds_read_b128 v[96:99], v14 offset:0
    buffer_load_dwordx4 v8, s[20:23], s53 offen offset:0 lds
    v_mfma_f32_16x16x32_bf16 v[152:155], v[32:35], v[76:79], v[152:155]
    ds_read_b128 v[100:103], v14 offset:4096
LW 6
    v_mfma_f32_16x16x32_bf16 v[132:135], v[36:39], v[64:67], v[132:135]
TR 48,24,0
    v_mfma_f32_16x16x32_bf16 v[140:143], v[36:39], v[68:71], v[140:143]
TR 50,24,1024
    v_mfma_f32_16x16x32_bf16 v[148:151], v[36:39], v[72:75], v[148:151]
    ds_read_b128 v[104:107], v14 offset:8192
    buffer_load_dwordx4 v9, s[20:23], s53 offen offset:1024 lds
    v_mfma_f32_16x16x32_bf16 v[156:159], v[36:39], v[76:79], v[156:159]
    ds_read_b128 v[108:111], v14 offset:12288
LW 8
    v_mfma_f32_16x16x32_bf16 v[160:163], v[40:43], v[64:67], v[160:163]
TR 52,25,0
    v_mfma_f32_16x16x32_bf16 v[168:171], v[40:43], v[68:71], v[168:171]
TR 54,25,1024
    v_mfma_f32_16x16x32_bf16 v[176:179], v[40:43], v[72:75], v[176:179]
    ds_read_b128 v[112:115], v15 offset:0
    buffer_load_dwordx4 v10, s[20:23], s53 offen offset:2048 lds
    v_mfma_f32_16x16x32_bf16 v[184:187], v[40:43], v[76:79], v[184:187]
    ds_read_b128 v[116:119], v15 offset:4096
LW 10
    v_mfma_f32_16x16x32_bf16 v[164:167], v[44:47], v[64:67], v[164:167]
TR 56,26,0
    v_mfma_f32_16x16x32_bf16 v[172:175], v[44:47], v[68:71], v[172:175]
TR 58,26,1024
    v_mfma_f32_16x16x32_bf16 v[180:183], v[44:47], v[72:75], v[180:183]
    ds_read_b128 v[120:123], v15 offset:8192
    buffer_load_dwordx4 v11, s[20:23], s53 offen offset:3072 lds
    v_mfma_f32_16x16x32_bf16 v[188:191], v[44:47], v[76:79], v[188:191]
    ds_read_b128 v[124:127], v15 offset:12288
LW 10
    v_mfma_f32_16x16x32_bf16 v[192:195], v[48:51], v[64:67], v[192:195]
TR 60,27,0
    v_mfma_f32_16x16x32_bf16 v[200:203], v[48:51], v[68:71], v[200:203]
TR 62,27,1024
    v_mfma_f32_16x16x32_bf16 v[208:211], v[48:51], v[72:75], v[208:211]
    v_mfma_f32_16x16x32_bf16 v[216:219], v[48:51], v[76:79], v[216:219]
LW 8
    v_mfma_f32_16x16x32_bf16 v[196:199], v[52:55], v[64:67], v[196:199]
TR 32,20,8192
    v_mfma_f32_16x16x32_bf16 v[204:207], v[52:55], v[68:71], v[204:207]
TR 34,20,9216
    v_mfma_f32_16x16x32_bf16 v[212:215], v[52:55], v[72:75], v[212:215]
    buffer_load_dwordx2 v[4:5], off, s[28:31], 0 sc1
    v_mfma_f32_16x16x32_bf16 v[220:223], v[52:55], v[76:79], v[220:223]
LW 6
    v_mfma_f32_16x16x32_bf16 v[224:227], v[56:59], v[64:67], v[224:227]
TR 36,21,8192
    v_mfma_f32_16x16x32_bf16 v[232:235], v[56:59], v[68:71], v[232:235]
TR 38,21,9216
    v_mfma_f32_16x16x32_bf16 v[240:243], v[56:59], v[72:75], v[240:243]
    v_mfma_f32_16x16x32_bf16 v[248:251], v[56:59], v[76:79], v[248:251]
LW 4
    v_mfma_f32_16x16x32_bf16 v[228:231], v[60:63], v[64:67], v[228:231]
TR 40,22,8192
    v_mfma_f32_16x16x32_bf16 v[236:239], v[60:63], v[68:71], v[236:239]
TR 42,22,9216
    v_mfma_f32_16x16x32_bf16 v[244:247], v[60:63], v[72:75], v[244:247]
    v_mfma_f32_16x16x32_bf16 v[252:255], v[60:63], v[76:79], v[252:255]
LW 4
    v_mfma_f32_16x16x32_bf16 v[128:131], v[32:35], v[80:83], v[128:131]
TR 44,23,8192
    v_mfma_f32_16x16x32_bf16 v[136:139], v[32:35], v[84:87], v[136:139]
TR 46,23,9216
    v_mfma_f32_16x16x32_bf16 v[144:147], v[32:35], v[88:91], v[144:147]
    v_mfma_f32_16x16x32_bf16 v[152:155], v[32:35], v[92:95], v[152:155]
LW 4
    v_mfma_f32_16x16x32_bf16 v[132:135], v[36:39], v[80:83], v[132:135]
TR 48,24,8192
    v_mfma_f32_16x16x32_bf16 v[140:143], v[36:39], v[84:87], v[140:143]
TR 50,24,9216
    v_mfma_f32_16x16x32_bf16 v[148:151], v[36:39], v[88:91], v[148:151]
    v_mfma_f32_16x16x32_bf16 v[156:159], v[36:39], v[92:95], v[156:159]
LW 4
    v_mfma_f32_16x16x32_bf16 v[160:163], v[40:43], v[80:83], v[160:163]
TR 52,25,8192
    v_mfma_f32_16x16x32_bf16 v[168:171], v[40:43], v[84:87], v[168:171]
TR 54,25,9216
    v_mfma_f32_16x16x32_bf16 v[176:179], v[40:43], v[88:91], v[176:179]
    v_mfma_f32_16x16x32_bf16 v[184:187], v[40:43], v[92:95], v[184:187]
LW 4
    v_mfma_f32_16x16x32_bf16 v[164:167], v[44:47], v[80:83], v[164:167]
TR 56,26,8192
    v_mfma_f32_16x16x32_bf16 v[172:175], v[44:47], v[84:87], v[172:175]
TR 58,26,9216
    v_mfma_f32_16x16x32_bf16 v[180:183], v[44:47], v[88:91], v[180:183]
    v_mfma_f32_16x16x32_bf16 v[188:191], v[44:47], v[92:95], v[188:191]
LW 4
    v_mfma_f32_16x16x32_bf16 v[192:195], v[48:51], v[80:83], v[192:195]
TR 60,27,8192
    v_mfma_f32_16x16x32_bf16 v[200:203], v[48:51], v[84:87], v[200:203]
TR 62,27,9216
    v_mfma_f32_16x16x32_bf16 v[208:211], v[48:51], v[88:91], v[208:211]
    v_mfma_f32_16x16x32_bf16 v[216:219], v[48:51], v[92:95], v[216:219]
LW 4
    v_mfma_f32_16x16x32_bf16 v[196:199], v[52:55], v[80:83], v[196:199]
    s_waitcnt vmcnt(5)
    s_barrier
TR 32,20,16384
    v_mfma_f32_16x16x32_bf16 v[204:207], v[52:55], v[84:87], v[204:207]
TR 34,20,17408
    v_mfma_f32_16x16x32_bf16 v[212:215], v[52:55], v[88:91], v[212:215]
    v_mfma_f32_16x16x32_bf16 v[220:223], v[52:55], v[92:95], v[220:223]
LW 4
    v_mfma_f32_16x16x32_bf16 v[224:227], v[56:59], v[80:83], v[224:227]
TR 36,21,16384
    v_mfma_f32_16x16x32_bf16 v[232:235], v[56:59], v[84:87], v[232:235]
TR 38,21,17408
    v_mfma_f32_16x16x32_bf16 v[240:243], v[56:59], v[88:91], v[240:243]
    v_mfma_f32_16x16x32_bf16 v[248:251], v[56:59], v[92:95], v[248:251]
LW 4
    v_mfma_f32_16x16x32_bf16 v[228:231], v[60:63], v[80:83], v[228:231]
TR 40,22,16384
    v_mfma_f32_16x16x32_bf16 v[236:239], v[60:63], v[84:87], v[236:239]
TR 42,22,17408
    v_mfma_f32_16x16x32_bf16 v[244:247], v[60:63], v[88:91], v[244:247]
    v_mfma_f32_16x16x32_bf16 v[252:255], v[60:63], v[92:95], v[252:255]
LW 4
    v_mfma_f32_16x16x32_bf16 v[128:131], v[32:35], v[96:99], v[128:131]
TR 44,23,16384
    s_add_u32 m0, s38, 49152
    v_mfma_f32_16x16x32_bf16 v[136:139], v[32:35], v[100:103], v[136:139]
TR 46,23,17408
    v_mfma_f32_16x16x32_bf16 v[144:147], v[32:35], v[104:107], v[144:147]
    buffer_load_dwordx4 v8, s[20:23], s55 offen offset:0 lds
    v_mfma_f32_16x16x32_bf16 v[152:155], v[32:35], v[108:111], v[152:155]
LW 4
    v_mfma_f32_16x16x32_bf16 v[132:135], v[36:39], v[96:99], v[132:135]
TR 48,24,16384
    v_mfma_f32_16x16x32_bf16 v[140:143], v[36:39], v[100:103], v[140:143]
TR 50,24,17408
    v_mfma_f32_16x16x32_bf16 v[148:151], v[36:39], v[104:107], v[148:151]
    buffer_load_dwordx4 v9, s[20:23], s55 offen offset:1024 lds
    v_mfma_f32_16x16x32_bf16 v[156:159], v[36:39], v[108:111], v[156:159]
LW 4
    v_mfma_f32_16x16x32_bf16 v[160:163], v[40:43], v[96:99], v[160:163]
TR 52,25,16384
    v_mfma_f32_16x16x32_bf16 v[168:171], v[40:43], v[100:103], v[168:171]
TR 54,25,17408
    v_mfma_f32_16x16x32_bf16 v[176:179], v[40:43], v[104:107], v[176:179]
    buffer_load_dwordx4 v10, s[20:23], s55 offen offset:2048 lds
    v_mfma_f32_16x16x32_bf16 v[184:187], v[40:43], v[108:111], v[184:187]
LW 4
    v_mfma_f32_16x16x32_bf16 v[164:167], v[44:47], v[96:99], v[164:167]
TR 56,26,16384
    v_mfma_f32_16x16x32_bf16 v[172:175], v[44:47], v[100:103], v[172:175]
TR 58,26,17408
    v_mfma_f32_16x16x32_bf16 v[180:183], v[44:47], v[104:107], v[180:183]
    buffer_load_dwordx4 v11, s[20:23], s55 offen offset:3072 lds
    v_mfma_f32_16x16x32_bf16 v[188:191], v[44:47], v[108:111], v[188:191]
LW 4
    v_mfma_f32_16x16x32_bf16 v[192:195], v[48:51], v[96:99], v[192:195]
TR 60,27,16384
    v_mfma_f32_16x16x32_bf16 v[200:203], v[48:51], v[100:103], v[200:203]
TR 62,27,17408
    v_mfma_f32_16x16x32_bf16 v[208:211], v[48:51], v[104:107], v[208:211]
    v_mfma_f32_16x16x32_bf16 v[216:219], v[48:51], v[108:111], v[216:219]
LW 4
    v_mfma_f32_16x16x32_bf16 v[196:199], v[52:55], v[96:99], v[196:199]
TR 32,20,24576
    v_mfma_f32_16x16x32_bf16 v[204:207], v[52:55], v[100:103], v[204:207]
TR 34,20,25600
    v_mfma_f32_16x16x32_bf16 v[212:215], v[52:55], v[104:107], v[212:215]
    v_mfma_f32_16x16x32_bf16 v[220:223], v[52:55], v[108:111], v[220:223]
LW 4
    v_mfma_f32_16x16x32_bf16 v[224:227], v[56:59], v[96:99], v[224:227]
TR 36,21,24576
    v_mfma_f32_16x16x32_bf16 v[232:235], v[56:59], v[100:103], v[232:235]
TR 38,21,25600
    v_mfma_f32_16x16x32_bf16 v[240:243], v[56:59], v[104:107], v[240:243]
    v_mfma_f32_16x16x32_bf16 v[248:251], v[56:59], v[108:111], v[248:251]
LW 4
    v_mfma_f32_16x16x32_bf16 v[228:231], v[60:63], v[96:99], v[228:231]
TR 40,22,24576
    v_mfma_f32_16x16x32_bf16 v[236:239], v[60:63], v[100:103], v[236:239]
TR 42,22,25600
    v_mfma_f32_16x16x32_bf16 v[244:247], v[60:63], v[104:107], v[244:247]
    v_mfma_f32_16x16x32_bf16 v[252:255], v[60:63], v[108:111], v[252:255]
LW 4
    v_mfma_f32_16x16x32_bf16 v[128:131], v[32:35], v[112:115], v[128:131]
TR 44,23,24576
    v_mfma_f32_16x16x32_bf16 v[136:139], v[32:35], v[116:119], v[136:139]
TR 46,23,25600
    v_mfma_f32_16x16x32_bf16 v[144:147], v[32:35], v[120:123], v[144:147]
    v_mfma_f32_16x16x32_bf16 v[152:155], v[32:35], v[124:127], v[152:155]
LW 4
    v_mfma_f32_16x16x32_bf16 v[132:135], v[36:39], v[112:115], v[132:135]
TR 48,24,24576
    v_mfma_f32_16x16x32_bf16 v[140:143], v[36:39], v[116:119], v[140:143]
TR 50,24,25600
    v_mfma_f32_16x16x32_bf16 v[148:151], v[36:39], v[120:123], v[148:151]
    v_mfma_f32_16x16x32_bf16 v[156:159], v[36:39], v[124:127], v[156:159]
LW 4
    v_mfma_f32_16x16x32_bf16 v[160:163], v[40:43], v[112:115], v[160:163]
TR 52,25,24576
    v_mfma_f32_16x16x32_bf16 v[168:171], v[40:43], v[116:119], v[168:171]
TR 54,25,25600
    v_mfma_f32_16x16x32_bf16 v[176:179], v[40:43], v[120:123], v[176:179]
    v_mfma_f32_16x16x32_bf16 v[184:187], v[40:43], v[124:127], v[184:187]
LW 4
    v_mfma_f32_16x16x32_bf16 v[164:167], v[44:47], v[112:115], v[164:167]
TR 56,26,24576
    v_mfma_f32_16x16x32_bf16 v[172:175], v[44:47], v[116:119], v[172:175]
TR 58,26,25600
    v_mfma_f32_16x16x32_bf16 v[180:183], v[44:47], v[120:123], v[180:183]
    v_mfma_f32_16x16x32_bf16 v[188:191], v[44:47], v[124:127], v[188:191]
LW 4
    v_mfma_f32_16x16x32_bf16 v[192:195], v[48:51], v[112:115], v[192:195]
TR 60,27,24576
    v_mfma_f32_16x16x32_bf16 v[200:203], v[48:51], v[116:119], v[200:203]
TR 62,27,25600
    v_mfma_f32_16x16x32_bf16 v[208:211], v[48:51], v[120:123], v[208:211]
    v_mfma_f32_16x16x32_bf16 v[216:219], v[48:51], v[124:127], v[216:219]
LW 4
    v_mfma_f32_16x16x32_bf16 v[196:199], v[52:55], v[112:115], v[196:199]
    s_waitcnt vmcnt(5)
    s_barrier
TR 32,20,32768
    v_mfma_f32_16x16x32_bf16 v[204:207], v[52:55], v[116:119], v[204:207]
TR 34,20,33792
    v_mfma_f32_16x16x32_bf16 v[212:215], v[52:55], v[120:123], v[212:215]
    v_mfma_f32_16x16x32_bf16 v[220:223], v[52:55], v[124:127], v[220:223]
LW 4
    v_mfma_f32_16x16x32_bf16 v[224:227], v[56:59], v[112:115], v[224:227]
TR 36,21,32768
    v_mfma_f32_16x16x32_bf16 v[232:235], v[56:59], v[116:119], v[232:235]
TR 38,21,33792
    v_mfma_f32_16x16x32_bf16 v[240:243], v[56:59], v[120:123], v[240:243]
    v_mfma_f32_16x16x32_bf16 v[248:251], v[56:59], v[124:127], v[248:251]
LW 4
    v_mfma_f32_16x16x32_bf16 v[228:231], v[60:63], v[112:115], v[228:231]
TR 40,22,32768
    v_mfma_f32_16x16x32_bf16 v[236:239], v[60:63], v[116:119], v[236:239]
TR 42,22,33792
    v_mfma_f32_16x16x32_bf16 v[244:247], v[60:63], v[120:123], v[244:247]
    v_mfma_f32_16x16x32_bf16 v[252:255], v[60:63], v[124:127], v[252:255]
LW 4
    v_mfma_f32_16x16x32_bf16 a[0:3], v[32:35], v[64:67], a[0:3]
TR 44,23,32768
    s_add_u32 s43, s42, 0
    v_mfma_f32_16x16x32_bf16 a[8:11], v[32:35], v[68:71], a[8:11]
TR 46,23,33792
    s_add_u32 s44, s43, 65536
    v_mfma_f32_16x16x32_bf16 a[16:19], v[32:35], v[72:75], a[16:19]
    v_cvt_pk_bf16_f32 v128, v128, v129
    v_cvt_pk_bf16_f32 v129, v130, v131
    v_mfma_f32_16x16x32_bf16 a[24:27], v[32:35], v[76:79], a[24:27]
    v_cvt_pk_bf16_f32 v130, v132, v133
    v_cvt_pk_bf16_f32 v131, v134, v135
LW 4
    v_mfma_f32_16x16x32_bf16 a[4:7], v[36:39], v[64:67], a[4:7]
TR 48,24,32768
    buffer_store_dwordx4 v[128:131], v28, s[8:11], s43 offen offset:0 sc1
    v_mfma_f32_16x16x32_bf16 a[12:15], v[36:39], v[68:71], a[12:15]
TR 50,24,33792
    v_cvt_pk_bf16_f32 v136, v136, v137
    v_mfma_f32_16x16x32_bf16 a[20:23], v[36:39], v[72:75], a[20:23]
    v_cvt_pk_bf16_f32 v137, v138, v139
    v_cvt_pk_bf16_f32 v138, v140, v141
    v_mfma_f32_16x16x32_bf16 a[28:31], v[36:39], v[76:79], a[28:31]
    v_cvt_pk_bf16_f32 v139, v142, v143
    buffer_store_dwordx4 v[136:139], v28, s[8:11], s43 offen offset:1024 sc1
LW 4
    v_mfma_f32_16x16x32_bf16 a[32:35], v[40:43], v[64:67], a[32:35]
TR 52,25,32768
    v_cvt_pk_bf16_f32 v144, v144, v145
    v_mfma_f32_16x16x32_bf16 a[40:43], v[40:43], v[68:71], a[40:43]
TR 54,25,33792
    v_cvt_pk_bf16_f32 v145, v146, v147
    v_mfma_f32_16x16x32_bf16 a[48:51], v[40:43], v[72:75], a[48:51]
    v_cvt_pk_bf16_f32 v146, v148, v149
    v_cvt_pk_bf16_f32 v147, v150, v151
    v_mfma_f32_16x16x32_bf16 a[56:59], v[40:43], v[76:79], a[56:59]
    buffer_store_dwordx4 v[144:147], v28, s[8:11], s44 offen offset:0 sc1
    v_cvt_pk_bf16_f32 v152, v152, v153
LW 4
    v_mfma_f32_16x16x32_bf16 a[36:39], v[44:47], v[64:67], a[36:39]
TR 56,26,32768
    v_cvt_pk_bf16_f32 v153, v154, v155
    v_mfma_f32_16x16x32_bf16 a[44:47], v[44:47], v[68:71], a[44:47]
TR 58,26,33792
    v_cvt_pk_bf16_f32 v154, v156, v157
    v_mfma_f32_16x16x32_bf16 a[52:55], v[44:47], v[72:75], a[52:55]
    v_cvt_pk_bf16_f32 v155, v158, v159
    buffer_store_dwordx4 v[152:155], v28, s[8:11], s44 offen offset:1024 sc1
    v_mfma_f32_16x16x32_bf16 a[60:63], v[44:47], v[76:79], a[60:63]
    s_add_u32 s43, s42, 2048
    s_add_u32 s44, s43, 65536
LW 4
    v_mfma_f32_16x16x32_bf16 a[64:67], v[48:51], v[64:67], a[64:67]
TR 60,27,32768
    v_cvt_pk_bf16_f32 v160, v160, v161
    v_mfma_f32_16x16x32_bf16 a[72:75], v[48:51], v[68:71], a[72:75]
TR 62,27,33792
    v_cvt_pk_bf16_f32 v161, v162, v163
    v_mfma_f32_16x16x32_bf16 a[80:83], v[48:51], v[72:75], a[80:83]
    v_cvt_pk_bf16_f32 v162, v164, v165
    v_cvt_pk_bf16_f32 v163, v166, v167
    v_mfma_f32_16x16x32_bf16 a[88:91], v[48:51], v[76:79], a[88:91]
    buffer_store_dwordx4 v[160:163], v28, s[8:11], s43 offen offset:0 sc1
    v_cvt_pk_bf16_f32 v168, v168, v169
LW 4
    v_mfma_f32_16x16x32_bf16 a[68:71], v[52:55], v[64:67], a[68:71]
TR 32,20,40960
    v_cvt_pk_bf16_f32 v169, v170, v171
    v_mfma_f32_16x16x32_bf16 a[76:79], v[52:55], v[68:71], a[76:79]
TR 34,20,41984
    v_cvt_pk_bf16_f32 v170, v172, v173
    v_mfma_f32_16x16x32_bf16 a[84:87], v[52:55], v[72:75], a[84:87]
    v_cvt_pk_bf16_f32 v171, v174, v175
    buffer_store_dwordx4 v[168:171], v28, s[8:11], s43 offen offset:1024 sc1
    v_mfma_f32_16x16x32_bf16 a[92:95], v[52:55], v[76:79], a[92:95]
    v_cvt_pk_bf16_f32 v176, v176, v177
    v_cvt_pk_bf16_f32 v177, v178, v179
LW 4
    v_mfma_f32_16x16x32_bf16 a[96:99], v[56:59], v[64:67], a[96:99]
TR 36,21,40960
    v_cvt_pk_bf16_f32 v178, v180, v181
    v_mfma_f32_16x16x32_bf16 a[104:107], v[56:59], v[68:71], a[104:107]
TR 38,21,41984
    v_cvt_pk_bf16_f32 v179, v182, v183
    v_mfma_f32_16x16x32_bf16 a[112:115], v[56:59], v[72:75], a[112:115]
    buffer_store_dwordx4 v[176:179], v28, s[8:11], s44 offen offset:0 sc1
    v_cvt_pk_bf16_f32 v184, v184, v185
    v_mfma_f32_16x16x32_bf16 a[120:123], v[56:59], v[76:79], a[120:123]
    v_cvt_pk_bf16_f32 v185, v186, v187
    v_cvt_pk_bf16_f32 v186, v188, v189
LW 4
    v_mfma_f32_16x16x32_bf16 a[100:103], v[60:63], v[64:67], a[100:103]
TR 40,22,40960
    v_cvt_pk_bf16_f32 v187, v190, v191
    v_mfma_f32_16x16x32_bf16 a[108:111], v[60:63], v[68:71], a[108:111]
TR 42,22,41984
    buffer_store_dwordx4 v[184:187], v28, s[8:11], s44 offen offset:1024 sc1
    v_mfma_f32_16x16x32_bf16 a[116:119], v[60:63], v[72:75], a[116:119]
    s_add_u32 s43, s42, 4096
    s_add_u32 s44, s43, 65536
    v_mfma_f32_16x16x32_bf16 a[124:127], v[60:63], v[76:79], a[124:127]
    v_cvt_pk_bf16_f32 v192, v192, v193
    v_cvt_pk_bf16_f32 v193, v194, v195
LW 4
    v_mfma_f32_16x16x32_bf16 a[0:3], v[32:35], v[80:83], a[0:3]
TR 44,23,40960
    v_cvt_pk_bf16_f32 v194, v196, v197
    v_mfma_f32_16x16x32_bf16 a[8:11], v[32:35], v[84:87], a[8:11]
TR 46,23,41984
    v_cvt_pk_bf16_f32 v195, v198, v199
    v_mfma_f32_16x16x32_bf16 a[16:19], v[32:35], v[88:91], a[16:19]
    buffer_store_dwordx4 v[192:195], v28, s[8:11], s43 offen offset:0 sc1
    v_cvt_pk_bf16_f32 v200, v200, v201
    v_mfma_f32_16x16x32_bf16 a[24:27], v[32:35], v[92:95], a[24:27]
    v_cvt_pk_bf16_f32 v201, v202, v203
    v_cvt_pk_bf16_f32 v202, v204, v205
LW 4
    v_mfma_f32_16x16x32_bf16 a[4:7], v[36:39], v[80:83], a[4:7]
TR 48,24,40960
    v_cvt_pk_bf16_f32 v203, v206, v207
    v_mfma_f32_16x16x32_bf16 a[12:15], v[36:39], v[84:87], a[12:15]
TR 50,24,41984
    buffer_store_dwordx4 v[200:203], v28, s[8:11], s43 offen offset:1024 sc1
    v_mfma_f32_16x16x32_bf16 a[20:23], v[36:39], v[88:91], a[20:23]
    v_cvt_pk_bf16_f32 v208, v208, v209
    v_cvt_pk_bf16_f32 v209, v210, v211
    v_mfma_f32_16x16x32_bf16 a[28:31], v[36:39], v[92:95], a[28:31]
    v_cvt_pk_bf16_f32 v210, v212, v213
    v_cvt_pk_bf16_f32 v211, v214, v215
LW 4
    v_mfma_f32_16x16x32_bf16 a[32:35], v[40:43], v[80:83], a[32:35]
TR 52,25,40960
    buffer_store_dwordx4 v[208:211], v28, s[8:11], s44 offen offset:0 sc1
    v_mfma_f32_16x16x32_bf16 a[40:43], v[40:43], v[84:87], a[40:43]
TR 54,25,41984
    v_cvt_pk_bf16_f32 v216, v216, v217
    v_mfma_f32_16x16x32_bf16 a[48:51], v[40:43], v[88:91], a[48:51]
    v_cvt_pk_bf16_f32 v217, v218, v219
    v_cvt_pk_bf16_f32 v218, v220, v221
    v_mfma_f32_16x16x32_bf16 a[56:59], v[40:43], v[92:95], a[56:59]
    v_cvt_pk_bf16_f32 v219, v222, v223
    buffer_store_dwordx4 v[216:219], v28, s[8:11], s44 offen offset:1024 sc1
LW 4
    v_mfma_f32_16x16x32_bf16 a[36:39], v[44:47], v[80:83], a[36:39]
TR 56,26,40960
    s_add_u32 s43, s42, 6144
    v_mfma_f32_16x16x32_bf16 a[44:47], v[44:47], v[84:87], a[44:47]
TR 58,26,41984
    s_add_u32 s44, s43, 65536
    v_mfma_f32_16x16x32_bf16 a[52:55], v[44:47], v[88:91], a[52:55]
    v_cvt_pk_bf16_f32 v224, v224, v225
    v_cvt_pk_bf16_f32 v225, v226, v227
    v_mfma_f32_16x16x32_bf16 a[60:63], v[44:47], v[92:95], a[60:63]
    v_cvt_pk_bf16_f32 v226, v228, v229
    v_cvt_pk_bf16_f32 v227, v230, v231
LW 4
    v_mfma_f32_16x16x32_bf16 a[64:67], v[48:51], v[80:83], a[64:67]
TR 60,27,40960
    buffer_store_dwordx4 v[224:227], v28, s[8:11], s43 offen offset:0 sc1
    v_mfma_f32_16x16x32_bf16 a[72:75], v[48:51], v[84:87], a[72:75]
TR 62,27,41984
    v_cvt_pk_bf16_f32 v232, v232, v233
    v_mfma_f32_16x16x32_bf16 a[80:83], v[48:51], v[88:91], a[80:83]
    v_cvt_pk_bf16_f32 v233, v234, v235
    v_cvt_pk_bf16_f32 v234, v236, v237
    v_mfma_f32_16x16x32_bf16 a[88:91], v[48:51], v[92:95], a[88:91]
    v_cvt_pk_bf16_f32 v235, v238, v239
    buffer_store_dwordx4 v[232:235], v28, s[8:11], s43 offen offset:1024 sc1
LW 4
    v_mfma_f32_16x16x32_bf16 a[68:71], v[52:55], v[80:83], a[68:71]
    s_waitcnt vmcnt(14)
    s_barrier
TR 32,20,49152
    v_cvt_pk_bf16_f32 v240, v240, v241
    v_mfma_f32_16x16x32_bf16 a[76:79], v[52:55], v[84:87], a[76:79]
TR 34,20,50176
    v_cvt_pk_bf16_f32 v241, v242, v243
    v_mfma_f32_16x16x32_bf16 a[84:87], v[52:55], v[88:91], a[84:87]
    v_cvt_pk_bf16_f32 v242, v244, v245
    v_cvt_pk_bf16_f32 v243, v246, v247
    v_mfma_f32_16x16x32_bf16 a[92:95], v[52:55], v[92:95], a[92:95]
    buffer_store_dwordx4 v[240:243], v28, s[8:11], s44 offen offset:0 sc1
    v_cvt_pk_bf16_f32 v248, v248, v249
LW 4
    v_mfma_f32_16x16x32_bf16 a[96:99], v[56:59], v[80:83], a[96:99]
TR 36,21,49152
    v_cvt_pk_bf16_f32 v249, v250, v251
    v_mfma_f32_16x16x32_bf16 a[104:107], v[56:59], v[84:87], a[104:107]
TR 38,21,50176
    v_cvt_pk_bf16_f32 v250, v252, v253
    v_mfma_f32_16x16x32_bf16 a[112:115], v[56:59], v[88:91], a[112:115]
    v_cvt_pk_bf16_f32 v251, v254, v255
    buffer_store_dwordx4 v[248:251], v28, s[8:11], s44 offen offset:1024 sc1
    v_mfma_f32_16x16x32_bf16 a[120:123], v[56:59], v[92:95], a[120:123]
LW 4
    v_mfma_f32_16x16x32_bf16 a[100:103], v[60:63], v[80:83], a[100:103]
TR 40,22,49152
    v_mfma_f32_16x16x32_bf16 a[108:111], v[60:63], v[84:87], a[108:111]
TR 42,22,50176
    v_mfma_f32_16x16x32_bf16 a[116:119], v[60:63], v[88:91], a[116:119]
    v_mfma_f32_16x16x32_bf16 a[124:127], v[60:63], v[92:95], a[124:127]
LW 4
    v_mfma_f32_16x16x32_bf16 a[0:3], v[32:35], v[96:99], a[0:3]
TR 44,23,49152
    v_mfma_f32_16x16x32_bf16 a[8:11], v[32:35], v[100:103], a[8:11]
TR 46,23,50176
    v_mfma_f32_16x16x32_bf16 a[16:19], v[32:35], v[104:107], a[16:19]
    v_mfma_f32_16x16x32_bf16 a[24:27], v[32:35], v[108:111], a[24:27]
LW 4
    v_mfma_f32_16x16x32_bf16 a[4:7], v[36:39], v[96:99], a[4:7]
TR 48,24,49152
    v_mfma_f32_16x16x32_bf16 a[12:15], v[36:39], v[100:103], a[12:15]
TR 50,24,50176
    v_mfma_f32_16x16x32_bf16 a[20:23], v[36:39], v[104:107], a[20:23]
    v_mfma_f32_16x16x32_bf16 a[28:31], v[36:39], v[108:111], a[28:31]
LW 4
    v_mfma_f32_16x16x32_bf16 a[32:35], v[40:43], v[96:99], a[32:35]
TR 52,25,49152
    v_mfma_f32_16x16x32_bf16 a[40:43], v[40:43], v[100:103], a[40:43]
TR 54,25,50176
    v_mfma_f32_16x16x32_bf16 a[48:51], v[40:43], v[104:107], a[48:51]
    v_mfma_f32_16x16x32_bf16 a[56:59], v[40:43], v[108:111], a[56:59]
LW 4
    v_mfma_f32_16x16x32_bf16 a[36:39], v[44:47], v[96:99], a[36:39]
TR 56,26,49152
    v_mfma_f32_16x16x32_bf16 a[44:47], v[44:47], v[100:103], a[44:47]
TR 58,26,50176
    v_mfma_f32_16x16x32_bf16 a[52:55], v[44:47], v[104:107], a[52:55]
    v_mfma_f32_16x16x32_bf16 a[60:63], v[44:47], v[108:111], a[60:63]
LW 4
    v_mfma_f32_16x16x32_bf16 a[64:67], v[48:51], v[96:99], a[64:67]
TR 60,27,49152
    v_mfma_f32_16x16x32_bf16 a[72:75], v[48:51], v[100:103], a[72:75]
TR 62,27,50176
    v_mfma_f32_16x16x32_bf16 a[80:83], v[48:51], v[104:107], a[80:83]
    v_mfma_f32_16x16x32_bf16 a[88:91], v[48:51], v[108:111], a[88:91]
LW 4
    v_mfma_f32_16x16x32_bf16 a[68:71], v[52:55], v[96:99], a[68:71]
TR 32,20,57344
    v_mfma_f32_16x16x32_bf16 a[76:79], v[52:55], v[100:103], a[76:79]
TR 34,20,58368
    v_mfma_f32_16x16x32_bf16 a[84:87], v[52:55], v[104:107], a[84:87]
    v_mfma_f32_16x16x32_bf16 a[92:95], v[52:55], v[108:111], a[92:95]
LW 4
    v_mfma_f32_16x16x32_bf16 a[96:99], v[56:59], v[96:99], a[96:99]
TR 36,21,57344
    v_mfma_f32_16x16x32_bf16 a[104:107], v[56:59], v[100:103], a[104:107]
TR 38,21,58368
    v_mfma_f32_16x16x32_bf16 a[112:115], v[56:59], v[104:107], a[112:115]
    v_mfma_f32_16x16x32_bf16 a[120:123], v[56:59], v[108:111], a[120:123]
LW 4
    v_mfma_f32_16x16x32_bf16 a[100:103], v[60:63], v[96:99], a[100:103]
TR 40,22,57344
    v_mfma_f32_16x16x32_bf16 a[108:111], v[60:63], v[100:103], a[108:111]
TR 42,22,58368
    v_mfma_f32_16x16x32_bf16 a[116:119], v[60:63], v[104:107], a[116:119]
    v_mfma_f32_16x16x32_bf16 a[124:127], v[60:63], v[108:111], a[124:127]
LW 4
    v_mfma_f32_16x16x32_bf16 a[0:3], v[32:35], v[112:115], a[0:3]
TR 44,23,57344
    v_mfma_f32_16x16x32_bf16 a[8:11], v[32:35], v[116:119], a[8:11]
TR 46,23,58368
    v_mfma_f32_16x16x32_bf16 a[16:19], v[32:35], v[120:123], a[16:19]
    v_mfma_f32_16x16x32_bf16 a[24:27], v[32:35], v[124:127], a[24:27]
LW 4
    v_mfma_f32_16x16x32_bf16 a[4:7], v[36:39], v[112:115], a[4:7]
TR 48,24,57344
    v_mfma_f32_16x16x32_bf16 a[12:15], v[36:39], v[116:119], a[12:15]
TR 50,24,58368
    v_mfma_f32_16x16x32_bf16 a[20:23], v[36:39], v[120:123], a[20:23]
    v_mfma_f32_16x16x32_bf16 a[28:31], v[36:39], v[124:127], a[28:31]
LW 4
    v_mfma_f32_16x16x32_bf16 a[32:35], v[40:43], v[112:115], a[32:35]
TR 52,25,57344
    v_mfma_f32_16x16x32_bf16 a[40:43], v[40:43], v[116:119], a[40:43]
TR 54,25,58368
    v_mfma_f32_16x16x32_bf16 a[48:51], v[40:43], v[120:123], a[48:51]
    v_mfma_f32_16x16x32_bf16 a[56:59], v[40:43], v[124:127], a[56:59]
LW 4
    v_mfma_f32_16x16x32_bf16 a[36:39], v[44:47], v[112:115], a[36:39]
TR 56,26,57344
    v_mfma_f32_16x16x32_bf16 a[44:47], v[44:47], v[116:119], a[44:47]
TR 58,26,58368
    v_mfma_f32_16x16x32_bf16 a[52:55], v[44:47], v[120:123], a[52:55]
    v_mfma_f32_16x16x32_bf16 a[60:63], v[44:47], v[124:127], a[60:63]
    s_waitcnt vmcnt(0)
    s_mov_b32 s39, 4194304
    s_branch L_nchk47
L_npoll47:
    buffer_load_dwordx2 v[4:5], off, s[28:31], 0 sc1
    s_waitcnt vmcnt(0)
L_nchk47:
    v_readfirstlane_b32 s56, v4
    v_readfirstlane_b32 s57, v5
    s_sub_u32 s39, s39, 1
    s_cbranch_scc1 L_end
    s_cmp_eq_u64 s[56:57], 0
    s_cbranch_scc1 L_npoll47
    s_mov_b64 exec, 0xffff
    buffer_store_dwordx2 v[4:5], v29, s[8:11], s51 offen offset:0 sc1
    s_mov_b64 exec, -1
LW 4
    v_mfma_f32_16x16x32_bf16 a[64:67], v[48:51], v[112:115], a[64:67]
TR 60,27,57344
    v_mfma_f32_16x16x32_bf16 a[72:75], v[48:51], v[116:119], a[72:75]
TR 62,27,58368
    v_mfma_f32_16x16x32_bf16 a[80:83], v[48:51], v[120:123], a[80:83]
    v_mfma_f32_16x16x32_bf16 a[88:91], v[48:51], v[124:127], a[88:91]
LW 4
    v_mfma_f32_16x16x32_bf16 a[68:71], v[52:55], v[112:115], a[68:71]
    v_mfma_f32_16x16x32_bf16 a[76:79], v[52:55], v[116:119], a[76:79]
    v_mfma_f32_16x16x32_bf16 a[84:87], v[52:55], v[120:123], a[84:87]
    v_mfma_f32_16x16x32_bf16 a[92:95], v[52:55], v[124:127], a[92:95]
LW 2
    v_mfma_f32_16x16x32_bf16 a[96:99], v[56:59], v[112:115], a[96:99]
    v_mfma_f32_16x16x32_bf16 a[104:107], v[56:59], v[116:119], a[104:107]
    v_mfma_f32_16x16x32_bf16 a[112:115], v[56:59], v[120:123], a[112:115]
    v_mfma_f32_16x16x32_bf16 a[120:123], v[56:59], v[124:127], a[120:123]
LW 0
    v_mfma_f32_16x16x32_bf16 a[100:103], v[60:63], v[112:115], a[100:103]
    v_mfma_f32_16x16x32_bf16 a[108:111], v[60:63], v[116:119], a[108:111]
    v_mfma_f32_16x16x32_bf16 a[116:119], v[60:63], v[120:123], a[116:119]
    v_mfma_f32_16x16x32_bf16 a[124:127], v[60:63], v[124:127], a[124:127]
    s_barrier
    s_nop 7
    s_add_u32 s43, s42, 32768
    s_add_u32 s44, s43, 65536
    v_accvgpr_read_b32 v128, a0
    v_accvgpr_read_b32 v129, a1
    v_accvgpr_read_b32 v130, a2
    v_accvgpr_read_b32 v131, a3
    v_accvgpr_read_b32 v132, a4
    v_accvgpr_read_b32 v133, a5
    v_accvgpr_read_b32 v134, a6
    v_accvgpr_read_b32 v135, a7
    v_cvt_pk_bf16_f32 v128, v128, v129
    v_cvt_pk_bf16_f32 v129, v130, v131
    v_cvt_pk_bf16_f32 v130, v132, v133
    v_cvt_pk_bf16_f32 v131, v134, v135
    buffer_store_dwordx4 v[128:131], v28, s[8:11], s43 offen offset:0 sc1
    v_accvgpr_read_b32 v136, a8
    v_accvgpr_read_b32 v137, a9
    v_accvgpr_read_b32 v138, a10
    v_accvgpr_read_b32 v139, a11
    v_accvgpr_read_b32 v140, a12
    v_accvgpr_read_b32 v141, a13
    v_accvgpr_read_b32 v142, a14
    v_accvgpr_read_b32 v143, a15
    v_cvt_pk_bf16_f32 v136, v136, v137
    v_cvt_pk_bf16_f32 v137, v138, v139
    v_cvt_pk_bf16_f32 v138, v140, v141
    v_cvt_pk_bf16_f32 v139, v142, v143
    buffer_store_dwordx4 v[136:139], v28, s[8:11], s43 offen offset:1024 sc1
    v_accvgpr_read_b32 v144, a16
    v_accvgpr_read_b32 v145, a17
    v_accvgpr_read_b32 v146, a18
    v_accvgpr_read_b32 v147, a19
    v_accvgpr_read_b32 v148, a20
    v_accvgpr_read_b32 v149, a21
    v_accvgpr_read_b32 v150, a22
    v_accvgpr_read_b32 v151, a23
    v_cvt_pk_bf16_f32 v144, v144, v145
    v_cvt_pk_bf16_f32 v145, v146, v147
    v_cvt_pk_bf16_f32 v146, v148, v149
    v_cvt_pk_bf16_f32 v147, v150, v151
    buffer_store_dwordx4 v[144:147], v28, s[8:11], s44 offen offset:0 sc1
    v_accvgpr_read_b32 v152, a24
    v_accvgpr_read_b32 v153, a25
    v_accvgpr_read_b32 v154, a26
    v_accvgpr_read_b32 v155, a27
    v_accvgpr_read_b32 v156, a28
    v_accvgpr_read_b32 v157, a29
    v_accvgpr_read_b32 v158, a30
    v_accvgpr_read_b32 v159, a31
    v_cvt_pk_bf16_f32 v152, v152, v153
    v_cvt_pk_bf16_f32 v153, v154, v155
    v_cvt_pk_bf16_f32 v154, v156, v157
    v_cvt_pk_bf16_f32 v155, v158, v159
    buffer_store_dwordx4 v[152:155], v28, s[8:11], s44 offen offset:1024 sc1
    s_add_u32 s43, s42, 34816
    s_add_u32 s44, s43, 65536
    v_accvgpr_read_b32 v160, a32
    v_accvgpr_read_b32 v161, a33
    v_accvgpr_read_b32 v162, a34
    v_accvgpr_read_b32 v163, a35
    v_accvgpr_read_b32 v164, a36
    v_accvgpr_read_b32 v165, a37
    v_accvgpr_read_b32 v166, a38
    v_accvgpr_read_b32 v167, a39
    v_cvt_pk_bf16_f32 v160, v160, v161
    v_cvt_pk_bf16_f32 v161, v162, v163
    v_cvt_pk_bf16_f32 v162, v164, v165
    v_cvt_pk_bf16_f32 v163, v166, v167
    buffer_store_dwordx4 v[160:163], v28, s[8:11], s43 offen offset:0 sc1
    v_accvgpr_read_b32 v168, a40
    v_accvgpr_read_b32 v169, a41
    v_accvgpr_read_b32 v170, a42
    v_accvgpr_read_b32 v171, a43
    v_accvgpr_read_b32 v172, a44
    v_accvgpr_read_b32 v173, a45
    v_accvgpr_read_b32 v174, a46
    v_accvgpr_read_b32 v175, a47
    v_cvt_pk_bf16_f32 v168, v168, v169
    v_cvt_pk_bf16_f32 v169, v170, v171
    v_cvt_pk_bf16_f32 v170, v172, v173
    v_cvt_pk_bf16_f32 v171, v174, v175
    buffer_store_dwordx4 v[168:171], v28, s[8:11], s43 offen offset:1024 sc1
    v_accvgpr_read_b32 v176, a48
    v_accvgpr_read_b32 v177, a49
    v_accvgpr_read_b32 v178, a50
    v_accvgpr_read_b32 v179, a51
    v_accvgpr_read_b32 v180, a52
    v_accvgpr_read_b32 v181, a53
    v_accvgpr_read_b32 v182, a54
    v_accvgpr_read_b32 v183, a55
    v_cvt_pk_bf16_f32 v176, v176, v177
    v_cvt_pk_bf16_f32 v177, v178, v179
    v_cvt_pk_bf16_f32 v178, v180, v181
    v_cvt_pk_bf16_f32 v179, v182, v183
    buffer_store_dwordx4 v[176:179], v28, s[8:11], s44 offen offset:0 sc1
    v_accvgpr_read_b32 v184, a56
    v_accvgpr_read_b32 v185, a57
    v_accvgpr_read_b32 v186, a58
    v_accvgpr_read_b32 v187, a59
    v_accvgpr_read_b32 v188, a60
    v_accvgpr_read_b32 v189, a61
    v_accvgpr_read_b32 v190, a62
    v_accvgpr_read_b32 v191, a63
    v_cvt_pk_bf16_f32 v184, v184, v185
    v_cvt_pk_bf16_f32 v185, v186, v187
    v_cvt_pk_bf16_f32 v186, v188, v189
    v_cvt_pk_bf16_f32 v187, v190, v191
    buffer_store_dwordx4 v[184:187], v28, s[8:11], s44 offen offset:1024 sc1
    s_add_u32 s43, s42, 36864
    s_add_u32 s44, s43, 65536
    v_accvgpr_read_b32 v192, a64
    v_accvgpr_read_b32 v193, a65
    v_accvgpr_read_b32 v194, a66
    v_accvgpr_read_b32 v195, a67
    v_accvgpr_read_b32 v196, a68
    v_accvgpr_read_b32 v197, a69
    v_accvgpr_read_b32 v198, a70
    v_accvgpr_read_b32 v199, a71
    v_cvt_pk_bf16_f32 v192, v192, v193
    v_cvt_pk_bf16_f32 v193, v194, v195
    v_cvt_pk_bf16_f32 v194, v196, v197
    v_cvt_pk_bf16_f32 v195, v198, v199
    buffer_store_dwordx4 v[192:195], v28, s[8:11], s43 offen offset:0 sc1
    v_accvgpr_read_b32 v200, a72
    v_accvgpr_read_b32 v201, a73
    v_accvgpr_read_b32 v202, a74
    v_accvgpr_read_b32 v203, a75
    v_accvgpr_read_b32 v204, a76
    v_accvgpr_read_b32 v205, a77
    v_accvgpr_read_b32 v206, a78
    v_accvgpr_read_b32 v207, a79
    v_cvt_pk_bf16_f32 v200, v200, v201
    v_cvt_pk_bf16_f32 v201, v202, v203
    v_cvt_pk_bf16_f32 v202, v204, v205
    v_cvt_pk_bf16_f32 v203, v206, v207
    buffer_store_dwordx4 v[200:203], v28, s[8:11], s43 offen offset:1024 sc1
    v_accvgpr_read_b32 v208, a80
    v_accvgpr_read_b32 v209, a81
    v_accvgpr_read_b32 v210, a82
    v_accvgpr_read_b32 v211, a83
    v_accvgpr_read_b32 v212, a84
    v_accvgpr_read_b32 v213, a85
    v_accvgpr_read_b32 v214, a86
    v_accvgpr_read_b32 v215, a87
    v_cvt_pk_bf16_f32 v208, v208, v209
    v_cvt_pk_bf16_f32 v209, v210, v211
    v_cvt_pk_bf16_f32 v210, v212, v213
    v_cvt_pk_bf16_f32 v211, v214, v215
    buffer_store_dwordx4 v[208:211], v28, s[8:11], s44 offen offset:0 sc1
    v_accvgpr_read_b32 v216, a88
    v_accvgpr_read_b32 v217, a89
    v_accvgpr_read_b32 v218, a90
    v_accvgpr_read_b32 v219, a91
    v_accvgpr_read_b32 v220, a92
    v_accvgpr_read_b32 v221, a93
    v_accvgpr_read_b32 v222, a94
    v_accvgpr_read_b32 v223, a95
    v_cvt_pk_bf16_f32 v216, v216, v217
    v_cvt_pk_bf16_f32 v217, v218, v219
    v_cvt_pk_bf16_f32 v218, v220, v221
    v_cvt_pk_bf16_f32 v219, v222, v223
    buffer_store_dwordx4 v[216:219], v28, s[8:11], s44 offen offset:1024 sc1
    s_add_u32 s43, s42, 38912
    s_add_u32 s44, s43, 65536
    v_accvgpr_read_b32 v224, a96
    v_accvgpr_read_b32 v225, a97
    v_accvgpr_read_b32 v226, a98
    v_accvgpr_read_b32 v227, a99
    v_accvgpr_read_b32 v228, a100
    v_accvgpr_read_b32 v229, a101
    v_accvgpr_read_b32 v230, a102
    v_accvgpr_read_b32 v231, a103
    v_cvt_pk_bf16_f32 v224, v224, v225
    v_cvt_pk_bf16_f32 v225, v226, v227
    v_cvt_pk_bf16_f32 v226, v228, v229
    v_cvt_pk_bf16_f32 v227, v230, v231
    buffer_store_dwordx4 v[224:227], v28, s[8:11], s43 offen offset:0 sc1
    v_accvgpr_read_b32 v232, a104
    v_accvgpr_read_b32 v233, a105
    v_accvgpr_read_b32 v234, a106
    v_accvgpr_read_b32 v235, a107
    v_accvgpr_read_b32 v236, a108
    v_accvgpr_read_b32 v237, a109
    v_accvgpr_read_b32 v238, a110
    v_accvgpr_read_b32 v239, a111
    v_cvt_pk_bf16_f32 v232, v232, v233
    v_cvt_pk_bf16_f32 v233, v234, v235
    v_cvt_pk_bf16_f32 v234, v236, v237
    v_cvt_pk_bf16_f32 v235, v238, v239
    buffer_store_dwordx4 v[232:235], v28, s[8:11], s43 offen offset:1024 sc1
    v_accvgpr_read_b32 v240, a112
    v_accvgpr_read_b32 v241, a113
    v_accvgpr_read_b32 v242, a114
    v_accvgpr_read_b32 v243, a115
    v_accvgpr_read_b32 v244, a116
    v_accvgpr_read_b32 v245, a117
    v_accvgpr_read_b32 v246, a118
    v_accvgpr_read_b32 v247, a119
    v_cvt_pk_bf16_f32 v240, v240, v241
    v_cvt_pk_bf16_f32 v241, v242, v243
    v_cvt_pk_bf16_f32 v242, v244, v245
    v_cvt_pk_bf16_f32 v243, v246, v247
    buffer_store_dwordx4 v[240:243], v28, s[8:11], s44 offen offset:0 sc1
    v_accvgpr_read_b32 v248, a120
    v_accvgpr_read_b32 v249, a121
    v_accvgpr_read_b32 v250, a122
    v_accvgpr_read_b32 v251, a123
    v_accvgpr_read_b32 v252, a124
    v_accvgpr_read_b32 v253, a125
    v_accvgpr_read_b32 v254, a126
    v_accvgpr_read_b32 v255, a127
    v_cvt_pk_bf16_f32 v248, v248, v249
    v_cvt_pk_bf16_f32 v249, v250, v251
    v_cvt_pk_bf16_f32 v250, v252, v253
    v_cvt_pk_bf16_f32 v251, v254, v255
    buffer_store_dwordx4 v[248:251], v28, s[8:11], s44 offen offset:1024 sc1
    s_waitcnt vmcnt(0)
    s_mov_b64 exec, 0xffff
    buffer_store_dwordx2 v[4:5], v29, s[8:11], s51 offen offset:128 sc1
    s_mov_b64 exec, -1
    s_mov_b32 s12, s98
    s_mov_b32 s13, s99
    s_mov_b32 s14, 14680064
    s_mul_i32 s64, s61, 7
    s_and_b32 s65, s64, 3
    s_mov_b32 s101, 0x6f2a60
    s_cmp_eq_u32 s65, 1
    s_cselect_b32 s101, 0xd95303, s101
    s_cmp_eq_u32 s65, 2
    s_cselect_b32 s101, 0xb4c0f2, s101
    s_cmp_eq_u32 s65, 3
    s_cselect_b32 s101, 0x903ca9, s101
    v_lshrrev_b32 v21, 3, v0
    v_mul_u32_u24 v21, 3, v21
    v_lshrrev_b32 v21, v21, s101
    v_and_b32 v21, 7, v21
    v_add_u32 v21, s64, v21
    v_and_b32 v31, 7, v0
    v_lshl_add_u32 v21, v21, 3, v31
    v_lshlrev_b32 v21, 7, v21
    v_add_u32 v21, 29622272, v21
    s_bfe_u32 s20, s101, 0x30000
    s_lshl_b32 s20, s20, 16
    s_bfe_u32 s21, s101, 0x30003
    s_lshl_b32 s21, s21, 16
    s_bfe_u32 s22, s101, 0x30006
    s_lshl_b32 s22, s22, 16
    s_bfe_u32 s23, s101, 0x30009
    s_lshl_b32 s23, s23, 16
    s_bfe_u32 s24, s101, 0x3000c
    s_lshl_b32 s24, s24, 16
    s_bfe_u32 s25, s101, 0x3000f
    s_lshl_b32 s25, s25, 16
    s_bfe_u32 s26, s101, 0x30012
    s_lshl_b32 s26, s26, 16
    v_lshlrev_b32 v16, 4, v0
    v_add_u32 v17, 0x10000, v16
    v_add_u32 v18, 0x20000, v16
    s_mul_i32 s64, s61, 458752
    s_add_u32 s64, s64, s38
    s_add_u32 s64, s64, 8388608
    v_add_u32 v19, s64, v16
    v_and_b32 v31, 15, v0
    v_mul_u32_u24 v31, 7168, v31
    v_lshrrev_b32 v30, 4, v0
    v_lshl_add_u32 v20, v30, 4, v31
    s_lshl_b32 s64, s60, 2
    s_add_u32 s64, s64, s32
    s_mul_i32 s27, s64, 229376
    s_mul_i32 s65, s61, 448
    s_add_u32 s27, s27, s65
L_xlate:
    s_mov_b32 s39, 4194304
    s_branch L_pld48
L_poll48:
    s_sub_u32 s39, s39, 1
    s_cbranch_scc1 L_end
    s_sleep 2
L_pld48:
    buffer_load_dwordx2 v[10:11], v3, s[8:11], 0 offen offset:0 sc1
    s_waitcnt vmcnt(0)
L_pchk48:
    v_cmp_ne_u64 vcc, s[56:57], v[10:11]
    s_nop 1
    s_cmp_lg_u64 vcc, 0
    s_cbranch_scc1 L_poll48
    s_mov_b32 s58, 0
    buffer_load_dwordx4 a[0:3], v6, s[8:11], s58 offen offset:0 sc1
    buffer_load_dwordx4 a[4:7], v6, s[8:11], s58 offen offset:1024 sc1
    buffer_load_dwordx4 a[8:11], v6, s[8:11], s58 offen offset:2048 sc1
    buffer_load_dwordx4 a[12:15], v6, s[8:11], s58 offen offset:3072 sc1
    s_mov_b32 s58, 4096
    buffer_load_dwordx4 a[16:19], v6, s[8:11], s58 offen offset:0 sc1
    buffer_load_dwordx4 a[20:23], v6, s[8:11], s58 offen offset:1024 sc1
    buffer_load_dwordx4 a[24:27], v6, s[8:11], s58 offen offset:2048 sc1
    buffer_load_dwordx4 a[28:31], v6, s[8:11], s58 offen offset:3072 sc1
    s_mov_b32 s58, 8192
    buffer_load_dwordx4 a[32:35], v6, s[8:11], s58 offen offset:0 sc1
    buffer_load_dwordx4 a[36:39], v6, s[8:11], s58 offen offset:1024 sc1
    buffer_load_dwordx4 a[40:43], v6, s[8:11], s58 offen offset:2048 sc1
    buffer_load_dwordx4 a[44:47], v6, s[8:11], s58 offen offset:3072 sc1
    s_mov_b32 s58, 12288
    buffer_load_dwordx4 a[48:51], v6, s[8:11], s58 offen offset:0 sc1
    buffer_load_dwordx4 a[52:55], v6, s[8:11], s58 offen offset:1024 sc1
    buffer_load_dwordx4 a[56:59], v6, s[8:11], s58 offen offset:2048 sc1
    buffer_load_dwordx4 a[60:63], v6, s[8:11], s58 offen offset:3072 sc1
    s_mov_b32 s58, 16384
    buffer_load_dwordx4 a[64:67], v6, s[8:11], s58 offen offset:0 sc1
    buffer_load_dwordx4 a[68:71], v6, s[8:11], s58 offen offset:1024 sc1
    buffer_load_dwordx4 a[72:75], v6, s[8:11], s58 offen offset:2048 sc1
    buffer_load_dwordx4 a[76:79], v6, s[8:11], s58 offen offset:3072 sc1
    s_mov_b32 s58, 20480
    buffer_load_dwordx4 a[80:83], v6, s[8:11], s58 offen offset:0 sc1
    buffer_load_dwordx4 a[84:87], v6, s[8:11], s58 offen offset:1024 sc1
    buffer_load_dwordx4 a[88:91], v6, s[8:11], s58 offen offset:2048 sc1
    buffer_load_dwordx4 a[92:95], v6, s[8:11], s58 offen offset:3072 sc1
    s_mov_b32 s58, 24576
    buffer_load_dwordx4 a[96:99], v6, s[8:11], s58 offen offset:0 sc1
    buffer_load_dwordx4 a[100:103], v6, s[8:11], s58 offen offset:1024 sc1
    buffer_load_dwordx4 a[104:107], v6, s[8:11], s58 offen offset:2048 sc1
    buffer_load_dwordx4 a[108:111], v6, s[8:11], s58 offen offset:3072 sc1
    s_mov_b32 s58, 28672
    buffer_load_dwordx4 a[112:115], v6, s[8:11], s58 offen offset:0 sc1
    buffer_load_dwordx4 a[116:119], v6, s[8:11], s58 offen offset:1024 sc1
    buffer_load_dwordx4 a[120:123], v6, s[8:11], s58 offen offset:2048 sc1
    buffer_load_dwordx4 a[124:127], v6, s[8:11], s58 offen offset:3072 sc1
    s_cmp_lt_u32 s34, 28
    s_cbranch_scc1 L_xlate2
    s_cmp_lg_u32 s32, 0
    s_cbranch_scc1 L_pdone49
    s_mov_b32 s39, 4194304
    s_branch L_pld49
L_poll49:
    s_sub_u32 s39, s39, 1
    s_cbranch_scc1 L_end
    s_sleep 2
L_pld49:
    s_bfm_b64 exec, 8, 0
    buffer_load_dwordx2 v[22:23], v21, s[8:11], 0 offen offset:0 sc1
    s_mov_b64 exec, -1
    s_waitcnt vmcnt(0)
L_pchk49:
    v_cmp_ne_u64 vcc, s[56:57], v[22:23]
    s_nop 1
    s_bfe_u64 vcc, vcc, 0x80000
    s_cbranch_scc1 L_poll49
L_pdone49:
    s_barrier
    s_add_u32 m0, s38, 131072
    s_add_u32 s68, s20, 0
    buffer_load_dwordx4 v19, s[8:11], s68 offen offset:0 sc1 lds
    buffer_load_dwordx4 v19, s[8:11], s68 offen offset:1024 sc1 lds
    buffer_load_dwordx4 v19, s[8:11], s68 offen offset:2048 sc1 lds
    buffer_load_dwordx4 v19, s[8:11], s68 offen offset:3072 sc1 lds
    s_add_u32 m0, s38, 147456
    s_add_u32 s68, s20, 16384
    buffer_load_dwordx4 v19, s[8:11], s68 offen offset:0 sc1 lds
    buffer_load_dwordx4 v19, s[8:11], s68 offen offset:1024 sc1 lds
    buffer_load_dwordx4 v19, s[8:11], s68 offen offset:2048 sc1 lds
    buffer_load_dwordx4 v19, s[8:11], s68 offen offset:3072 sc1 lds
L_xlate2:
    s_bfm_b64 exec, 16, 8
    buffer_load_dwordx2 v[22:23], v21, s[8:11], 0 offen offset:0 sc1
    s_mov_b64 exec, -1
    s_waitcnt vmcnt(0)
L_g3:
    s_waitcnt vmcnt(2)
    s_barrier
    s_cmp_eq_u32 s100, 0
    s_cbranch_scc1 L_nof50
    s_mov_b64 exec, 0xffff
    buffer_store_dwordx2 v[4:5], v29, s[8:11], s63 offen offset:2048 sc1
    s_mov_b64 exec, -1
L_nof50:
    ds_read_b128 v[32:35], v18 offset:0
    ds_read_b128 v[36:39], v18 offset:1024
    ds_read_b128 v[40:43], v18 offset:2048
    ds_read_b128 v[44:47], v18 offset:3072
    ds_read_b128 v[48:51], v18 offset:4096
    v_cmp_ne_u64 vcc, s[56:57], v[22:23]
    s_nop 1
    s_bfe_u64 vcc, vcc, 0x100008
    s_cbranch_scc1 L_miss51
L_back51:
LW 4
    v_mfma_f32_16x16x32_bf16 v[128:131], v[32:35], a[0:3], 0
    ds_read_b128 v[52:55], v18 offset:5120
    v_mfma_f32_16x16x32_bf16 v[136:139], v[32:35], a[4:7], 0
    buffer_load_dwordx2 v[10:11], v3, s[8:11], 0 offen offset:128 sc1
LW 4
    v_mfma_f32_16x16x32_bf16 v[132:135], v[36:39], a[0:3], 0
    ds_read_b128 v[56:59], v18 offset:6144
    s_add_u32 m0, s38, 0
    s_add_u32 s68, s21, 0
    v_mfma_f32_16x16x32_bf16 v[140:143], v[36:39], a[4:7], 0
    buffer_load_dwordx4 v19, s[8:11], s68 offen offset:0 sc1 lds
LW 4
MB 128,40,8
    ds_read_b128 v[60:63], v18 offset:7168
MB 136,40,12
LW 4
MB 132,44,8
    ds_read_b128 v[32:35], v18 offset:8192
MB 140,44,12
    buffer_load_dwordx4 v19, s[8:11], s68 offen offset:1024 sc1 lds
LW 4
MB 128,48,16
    ds_read_b128 v[36:39], v18 offset:9216
MB 136,48,20
LW 4
MB 132,52,16
    ds_read_b128 v[40:43], v18 offset:10240
MB 140,52,20
    buffer_load_dwordx4 v19, s[8:11], s68 offen offset:2048 sc1 lds
LW 4
MB 128,56,24
    ds_read_b128 v[44:47], v18 offset:11264
MB 136,56,28
LW 4
MB 132,60,24
    ds_read_b128 v[48:51], v18 offset:12288
MB 140,60,28
    buffer_load_dwordx4 v19, s[8:11], s68 offen offset:3072 sc1 lds
LW 4
MB 128,32,32
    ds_read_b128 v[52:55], v18 offset:13312
    s_add_u32 m0, s38, 16384
    s_add_u32 s68, s21, 16384
MB 136,32,36
    buffer_load_dwordx4 v19, s[8:11], s68 offen offset:0 sc1 lds
LW 4
MB 132,36,32
    ds_read_b128 v[56:59], v18 offset:14336
MB 140,36,36
LW 4
MB 128,40,40
    ds_read_b128 v[60:63], v18 offset:15360
MB 136,40,44
    buffer_load_dwordx4 v19, s[8:11], s68 offen offset:1024 sc1 lds
LW 4
MB 132,44,40
    s_barrier
    ds_read_b128 v[32:35], v18 offset:16384
MB 140,44,44
LW 4
MB 128,48,48
    ds_read_b128 v[36:39], v18 offset:17408
MB 136,48,52
    buffer_load_dwordx4 v19, s[8:11], s68 offen offset:2048 sc1 lds
LW 4
MB 132,52,48
    ds_read_b128 v[40:43], v18 offset:18432
MB 140,52,52
LW 4
MB 128,56,56
    ds_read_b128 v[44:47], v18 offset:19456
MB 136,56,60
    buffer_load_dwordx4 v19, s[8:11], s68 offen offset:3072 sc1 lds
LW 4
MB 132,60,56
    ds_read_b128 v[48:51], v18 offset:20480
MB 140,60,60
LW 4
MB 128,32,64
    ds_read_b128 v[52:55], v18 offset:21504
    s_add_u32 m0, s38, 32768
    s_add_u32 s68, s22, 0
MB 136,32,68
    buffer_load_dwordx4 v19, s[8:11], s68 offen offset:0 sc1 lds
LW 4
MB 132,36,64
    ds_read_b128 v[56:59], v18 offset:22528
MB 140,36,68
LW 4
MB 128,40,72
    ds_read_b128 v[60:63], v18 offset:23552
MB 136,40,76
    buffer_load_dwordx4 v19, s[8:11], s68 offen offset:1024 sc1 lds
LW 4
MB 132,44,72
    ds_read_b128 v[32:35], v18 offset:24576
MB 140,44,76
LW 4
MB 128,48,80
    ds_read_b128 v[36:39], v18 offset:25600
MB 136,48,84
    buffer_load_dwordx4 v19, s[8:11], s68 offen offset:2048 sc1 lds
LW 4
MB 132,52,80
    ds_read_b128 v[40:43], v18 offset:26624
MB 140,52,84
LW 4
MB 128,56,88
    ds_read_b128 v[44:47], v18 offset:27648
MB 136,56,92
    buffer_load_dwordx4 v19, s[8:11], s68 offen offset:3072 sc1 lds
LW 4
MB 132,60,88
    ds_read_b128 v[48:51], v18 offset:28672
    s_add_u32 m0, s38, 49152
    s_add_u32 s68, s22, 16384
MB 140,60,92
LW 4
MB 128,32,96
    ds_read_b128 v[52:55], v18 offset:29696
MB 136,32,100
    buffer_load_dwordx4 v19, s[8:11], s68 offen offset:0 sc1 lds
LW 4
MB 132,36,96
    ds_read_b128 v[56:59], v18 offset:30720
MB 140,36,100
LW 4
MB 128,40,104
    ds_read_b128 v[60:63], v18 offset:31744
MB 136,40,108
    buffer_load_dwordx4 v19, s[8:11], s68 offen offset:1024 sc1 lds
LW 4
MB 132,44,104
    s_waitcnt vmcnt(10)
    s_barrier
    s_cmp_eq_u32 s100, 0
    s_cbranch_scc1 L_nof52
    s_mov_b64 exec, 0xffff
    buffer_store_dwordx2 v[4:5], v29, s[8:11], s63 offen offset:3072 sc1
    s_mov_b64 exec, -1
L_nof52:
    ds_read_b128 v[32:35], v16 offset:0
MB 140,44,108
LW 4
MB 128,48,112
    ds_read_b128 v[36:39], v16 offset:1024
MB 136,48,116
    buffer_load_dwordx4 v19, s[8:11], s68 offen offset:2048 sc1 lds
LW 4
MB 132,52,112
    ds_read_b128 v[40:43], v16 offset:2048
MB 140,52,116
LW 4
MB 128,56,120
    ds_read_b128 v[44:47], v16 offset:3072
MB 136,56,124
    buffer_load_dwordx4 v19, s[8:11], s68 offen offset:3072 sc1 lds
LW 4
MB 132,60,120
    ds_read_b128 v[48:51], v16 offset:4096
MB 140,60,124
    v_cmp_ne_u64 vcc, s[56:57], v[10:11]
    s_nop 1
    s_cmp_lg_u64 vcc, 0
    s_cbranch_scc1 L_miss53
L_back53:
    s_bfm_b64 exec, 16, 24
    buffer_load_dwordx2 v[22:23], v21, s[8:11], 0 offen offset:0 sc1
    s_mov_b64 exec, -1
LW 4
    v_mfma_f32_16x16x32_bf16 v[144:147], v[32:35], a[0:3], 0
    ds_read_b128 v[52:55], v16 offset:5120
    s_mov_b32 s58, 32768
    v_mfma_f32_16x16x32_bf16 v[152:155], v[32:35], a[4:7], 0
    buffer_load_dwordx4 a[128:131], v6, s[8:11], s58 offen offset:0 sc1
LW 4
    v_mfma_f32_16x16x32_bf16 v[148:151], v[36:39], a[0:3], 0
    ds_read_b128 v[56:59], v16 offset:6144
    v_mfma_f32_16x16x32_bf16 v[156:159], v[36:39], a[4:7], 0
LW 4
MB 144,40,8
    ds_read_b128 v[60:63], v16 offset:7168
MB 152,40,12
    buffer_load_dwordx4 a[132:135], v6, s[8:11], s58 offen offset:1024 sc1
LW 4
MB 148,44,8
    ds_read_b128 v[32:35], v16 offset:8192
MB 156,44,12
LW 4
MB 144,48,16
    ds_read_b128 v[36:39], v16 offset:9216
MB 152,48,20
    buffer_load_dwordx4 a[136:139], v6, s[8:11], s58 offen offset:2048 sc1
LW 4
MB 148,52,16
    ds_read_b128 v[40:43], v16 offset:10240
MB 156,52,20
LW 4
MB 144,56,24
    ds_read_b128 v[44:47], v16 offset:11264
MB 152,56,28
    buffer_load_dwordx4 a[140:143], v6, s[8:11], s58 offen offset:3072 sc1
LW 4
MB 148,60,24
    ds_read_b128 v[48:51], v16 offset:12288
    s_mov_b32 s58, 36864
MB 156,60,28
LW 4
MB 144,32,32
    ds_read_b128 v[52:55], v16 offset:13312
MB 152,32,36
LW 4
MB 148,36,32
    ds_read_b128 v[56:59], v16 offset:14336
MB 156,36,36
    buffer_load_dwordx4 a[144:147], v6, s[8:11], s58 offen offset:0 sc1
LW 4
MB 144,40,40
    ds_read_b128 v[60:63], v16 offset:15360
MB 152,40,44
LW 4
MB 148,44,40
    s_waitcnt vmcnt(14)
    s_barrier
    ds_read_b128 v[32:35], v16 offset:16384
MB 156,44,44
    buffer_load_dwordx4 a[148:151], v6, s[8:11], s58 offen offset:1024 sc1
LW 4
MB 144,48,48
    ds_read_b128 v[36:39], v16 offset:17408
MB 152,48,52
LW 4
MB 148,52,48
    ds_read_b128 v[40:43], v16 offset:18432
MB 156,52,52
    buffer_load_dwordx4 a[152:155], v6, s[8:11], s58 offen offset:2048 sc1
LW 4
MB 144,56,56
    ds_read_b128 v[44:47], v16 offset:19456
MB 152,56,60
LW 4
MB 148,60,56
    ds_read_b128 v[48:51], v16 offset:20480
MB 156,60,60
LW 4
MB 144,32,64
    ds_read_b128 v[52:55], v16 offset:21504
MB 152,32,68
    buffer_load_dwordx4 a[156:159], v6, s[8:11], s58 offen offset:3072 sc1
LW 4
MB 148,36,64
    ds_read_b128 v[56:59], v16 offset:22528
    s_mov_b32 s58, 40960
MB 156,36,68
LW 4
MB 144,40,72
    ds_read_b128 v[60:63], v16 offset:23552
MB 152,40,76
    buffer_load_dwordx4 a[160:163], v6, s[8:11], s58 offen offset:0 sc1
LW 4
MB 148,44,72
    ds_read_b128 v[32:35], v16 offset:24576
MB 156,44,76
LW 4
MB 144,48,80
    ds_read_b128 v[36:39], v16 offset:25600
MB 152,48,84
    buffer_load_dwordx4 a[164:167], v6, s[8:11], s58 offen offset:1024 sc1
LW 4
MB 148,52,80
    ds_read_b128 v[40:43], v16 offset:26624
MB 156,52,84
LW 4
MB 144,56,88
    ds_read_b128 v[44:47], v16 offset:27648
MB 152,56,92
    buffer_load_dwordx4 a[168:171], v6, s[8:11], s58 offen offset:2048 sc1
LW 4
MB 148,60,88
    ds_read_b128 v[48:51], v16 offset:28672
MB 156,60,92
LW 4
MB 144,32,96
    ds_read_b128 v[52:55], v16 offset:29696
MB 152,32,100
LW 4
MB 148,36,96
    ds_read_b128 v[56:59], v16 offset:30720
MB 156,36,100
    buffer_load_dwordx4 a[172:175], v6, s[8:11], s58 offen offset:3072 sc1
LW 4
MB 144,40,104
    ds_read_b128 v[60:63], v16 offset:31744
    s_mov_b32 s58, 45056
MB 152,40,108
LW 4
MB 148,44,104
    s_waitcnt vmcnt(12)
    v_cmp_ne_u64 vcc, s[56:57], v[22:23]
    s_nop 1
    s_bfe_u64 vcc, vcc, 0x100018
    s_cbranch_scc1 L_miss54
L_back54:
    s_barrier
    ds_read_b128 v[32:35], v16 offset:32768
MB 156,44,108
    buffer_load_dwordx4 a[176:179], v6, s[8:11], s58 offen offset:0 sc1
LW 4
MB 144,48,112
    ds_read_b128 v[36:39], v16 offset:33792
MB 152,48,116
LW 4
MB 148,52,112
    ds_read_b128 v[40:43], v16 offset:34816
MB 156,52,116
    buffer_load_dwordx4 a[180:183], v6, s[8:11], s58 offen offset:1024 sc1
LW 4
MB 144,56,120
    ds_read_b128 v[44:47], v16 offset:35840
MB 152,56,124
LW 4
MB 148,60,120
    ds_read_b128 v[48:51], v16 offset:36864
MB 156,60,124
LW 4
    v_mfma_f32_16x16x32_bf16 v[160:163], v[32:35], a[0:3], 0
    ds_read_b128 v[52:55], v16 offset:37888
    s_add_u32 m0, s38, 65536
    s_add_u32 s68, s23, 0
    v_mfma_f32_16x16x32_bf16 v[168:171], v[32:35], a[4:7], 0
    buffer_load_dwordx4 v19, s[8:11], s68 offen offset:0 sc1 lds
LW 4
    v_mfma_f32_16x16x32_bf16 v[164:167], v[36:39], a[0:3], 0
    ds_read_b128 v[56:59], v16 offset:38912
    v_mfma_f32_16x16x32_bf16 v[172:175], v[36:39], a[4:7], 0
LW 4
MB 160,40,8
    ds_read_b128 v[60:63], v16 offset:39936
MB 168,40,12
    buffer_load_dwordx4 v19, s[8:11], s68 offen offset:1024 sc1 lds
LW 4
MB 164,44,8
    ds_read_b128 v[32:35], v16 offset:40960
MB 172,44,12
LW 4
MB 160,48,16
    ds_read_b128 v[36:39], v16 offset:41984
MB 168,48,20
    buffer_load_dwordx4 v19, s[8:11], s68 offen offset:2048 sc1 lds
LW 4
MB 164,52,16
    ds_read_b128 v[40:43], v16 offset:43008
MB 172,52,20
LW 4
MB 160,56,24
    ds_read_b128 v[44:47], v16 offset:44032
MB 168,56,28
    buffer_load_dwordx4 v19, s[8:11], s68 offen offset:3072 sc1 lds
LW 4
MB 164,60,24
    ds_read_b128 v[48:51], v16 offset:45056
    s_add_u32 m0, s38, 81920
    s_add_u32 s68, s23, 16384
MB 172,60,28
LW 4
MB 160,32,32
    ds_read_b128 v[52:55], v16 offset:46080
MB 168,32,36
    buffer_load_dwordx4 v19, s[8:11], s68 offen offset:0 sc1 lds
LW 4
MB 164,36,32
    ds_read_b128 v[56:59], v16 offset:47104
MB 172,36,36
LW 4
MB 160,40,40
    ds_read_b128 v[60:63], v16 offset:48128
MB 168,40,44
    buffer_load_dwordx4 v19, s[8:11], s68 offen offset:1024 sc1 lds
LW 4
MB 164,44,40
    ds_read_b128 v[32:35], v16 offset:49152
MB 172,44,44
LW 4
MB 160,48,48
    ds_read_b128 v[36:39], v16 offset:50176
MB 168,48,52
    buffer_load_dwordx4 v19, s[8:11], s68 offen offset:2048 sc1 lds
LW 4
MB 164,52,48
    ds_read_b128 v[40:43], v16 offset:51200
MB 172,52,52
LW 4
MB 160,56,56
    ds_read_b128 v[44:47], v16 offset:52224
MB 168,56,60
    buffer_load_dwordx4 v19, s[8:11], s68 offen offset:3072 sc1 lds
LW 4
MB 164,60,56
    ds_read_b128 v[48:51], v16 offset:53248
MB 172,60,60
LW 4
MB 160,32,64
    ds_read_b128 v[52:55], v16 offset:54272
    s_add_u32 m0, s38, 98304
    s_add_u32 s68, s24, 0
MB 168,32,68
    buffer_load_dwordx4 v19, s[8:11], s68 offen offset:0 sc1 lds
LW 4
MB 164,36,64
    ds_read_b128 v[56:59], v16 offset:55296
MB 172,36,68
LW 4
MB 160,40,72
    ds_read_b128 v[60:63], v16 offset:56320
MB 168,40,76
    buffer_load_dwordx4 v19, s[8:11], s68 offen offset:1024 sc1 lds
LW 4
MB 164,44,72
    ds_read_b128 v[32:35], v16 offset:57344
MB 172,44,76
LW 4
MB 160,48,80
    ds_read_b128 v[36:39], v16 offset:58368
MB 168,48,84
    buffer_load_dwordx4 v19, s[8:11], s68 offen offset:2048 sc1 lds
LW 4
MB 164,52,80
    ds_read_b128 v[40:43], v16 offset:59392
MB 172,52,84
LW 4
MB 160,56,88
    ds_read_b128 v[44:47], v16 offset:60416
MB 168,56,92
    buffer_load_dwordx4 v19, s[8:11], s68 offen offset:3072 sc1 lds
LW 4
MB 164,60,88
    ds_read_b128 v[48:51], v16 offset:61440
    s_add_u32 m0, s38, 114688
    s_add_u32 s68, s24, 16384
MB 172,60,92
LW 4
MB 160,32,96
    ds_read_b128 v[52:55], v16 offset:62464
MB 168,32,100
    buffer_load_dwordx4 v19, s[8:11], s68 offen offset:0 sc1 lds
LW 4
MB 164,36,96
    ds_read_b128 v[56:59], v16 offset:63488
MB 172,36,100
LW 4
MB 160,40,104
    ds_read_b128 v[60:63], v16 offset:64512
MB 168,40,108
    buffer_load_dwordx4 v19, s[8:11], s68 offen offset:1024 sc1 lds
LW 4
MB 164,44,104
    s_waitcnt vmcnt(6)
    s_barrier
    ds_read_b128 v[32:35], v17 offset:0
MB 172,44,108
LW 4
MB 160,48,112
    ds_read_b128 v[36:39], v17 offset:1024
MB 168,48,116
    buffer_load_dwordx4 v19, s[8:11], s68 offen offset:2048 sc1 lds
LW 4
MB 164,52,112
    ds_read_b128 v[40:43], v17 offset:2048
MB 172,52,116
LW 4
MB 160,56,120
    ds_read_b128 v[44:47], v17 offset:3072
MB 168,56,124
    buffer_load_dwordx4 v19, s[8:11], s68 offen offset:3072 sc1 lds
LW 4
MB 164,60,120
    ds_read_b128 v[48:51], v17 offset:4096
MB 172,60,124
    s_bfm_b64 exec, 16, 40
    buffer_load_dwordx2 v[22:23], v21, s[8:11], 0 offen offset:0 sc1
    s_mov_b64 exec, -1
LW 4
    v_mfma_f32_16x16x32_bf16 v[176:179], v[32:35], a[0:3], 0
    ds_read_b128 v[52:55], v17 offset:5120
    v_mfma_f32_16x16x32_bf16 v[184:187], v[32:35], a[4:7], 0
    buffer_load_dwordx4 a[184:187], v6, s[8:11], s58 offen offset:2048 sc1
LW 4
    v_mfma_f32_16x16x32_bf16 v[180:183], v[36:39], a[0:3], 0
    ds_read_b128 v[56:59], v17 offset:6144
    v_mfma_f32_16x16x32_bf16 v[188:191], v[36:39], a[4:7], 0
LW 4
MB 176,40,8
    ds_read_b128 v[60:63], v17 offset:7168
MB 184,40,12
    buffer_load_dwordx4 a[188:191], v6, s[8:11], s58 offen offset:3072 sc1
LW 4
MB 180,44,8
    ds_read_b128 v[32:35], v17 offset:8192
    s_mov_b32 s58, 49152
MB 188,44,12
LW 4
MB 176,48,16
    ds_read_b128 v[36:39], v17 offset:9216
MB 184,48,20
    buffer_load_dwordx4 a[192:195], v6, s[8:11], s58 offen offset:0 sc1
LW 4
MB 180,52,16
    ds_read_b128 v[40:43], v17 offset:10240
MB 188,52,20
LW 4
MB 176,56,24
    ds_read_b128 v[44:47], v17 offset:11264
MB 184,56,28
    buffer_load_dwordx4 a[196:199], v6, s[8:11], s58 offen offset:1024 sc1
LW 4
MB 180,60,24
    ds_read_b128 v[48:51], v17 offset:12288
MB 188,60,28
LW 4
MB 176,32,32
    ds_read_b128 v[52:55], v17 offset:13312
MB 184,32,36
LW 4
MB 180,36,32
    ds_read_b128 v[56:59], v17 offset:14336
MB 188,36,36
    buffer_load_dwordx4 a[200:203], v6, s[8:11], s58 offen offset:2048 sc1
LW 4
MB 176,40,40
    ds_read_b128 v[60:63], v17 offset:15360
MB 184,40,44
LW 4
MB 180,44,40
    ds_read_b128 v[32:35], v17 offset:16384
MB 188,44,44
    buffer_load_dwordx4 a[204:207], v6, s[8:11], s58 offen offset:3072 sc1
LW 4
MB 176,48,48
    ds_read_b128 v[36:39], v17 offset:17408
    s_mov_b32 s58, 53248
MB 184,48,52
LW 4
MB 180,52,48
    ds_read_b128 v[40:43], v17 offset:18432
MB 188,52,52
    buffer_load_dwordx4 a[208:211], v6, s[8:11], s58 offen offset:0 sc1
LW 4
MB 176,56,56
    ds_read_b128 v[44:47], v17 offset:19456
MB 184,56,60
LW 4
MB 180,60,56
    ds_read_b128 v[48:51], v17 offset:20480
MB 188,60,60
LW 4
MB 176,32,64
    ds_read_b128 v[52:55], v17 offset:21504
MB 184,32,68
    buffer_load_dwordx4 a[212:215], v6, s[8:11], s58 offen offset:1024 sc1
LW 4
MB 180,36,64
    ds_read_b128 v[56:59], v17 offset:22528
MB 188,36,68
LW 4
MB 176,40,72
    ds_read_b128 v[60:63], v17 offset:23552
MB 184,40,76
    buffer_load_dwordx4 a[216:219], v6, s[8:11], s58 offen offset:2048 sc1
LW 4
MB 180,44,72
    ds_read_b128 v[32:35], v17 offset:24576
MB 188,44,76
LW 4
MB 176,48,80
    ds_read_b128 v[36:39], v17 offset:25600
MB 184,48,84
    buffer_load_dwordx4 a[220:223], v6, s[8:11], s58 offen offset:3072 sc1
LW 4
MB 180,52,80
    ds_read_b128 v[40:43], v17 offset:26624
    s_mov_b32 s58, 57344
MB 188,52,84
LW 4
MB 176,56,88
    ds_read_b128 v[44:47], v17 offset:27648
MB 184,56,92
    buffer_load_dwordx4 a[224:227], v6, s[8:11], s58 offen offset:0 sc1
LW 4
MB 180,60,88
    ds_read_b128 v[48:51], v17 offset:28672
MB 188,60,92
LW 4
MB 176,32,96
    ds_read_b128 v[52:55], v17 offset:29696
MB 184,32,100
LW 4
MB 180,36,96
    ds_read_b128 v[56:59], v17 offset:30720
MB 188,36,100
    buffer_load_dwordx4 a[228:231], v6, s[8:11], s58 offen offset:1024 sc1
LW 4
MB 176,40,104
    ds_read_b128 v[60:63], v17 offset:31744
MB 184,40,108
LW 4
MB 180,44,104
    s_waitcnt vmcnt(12)
    v_cmp_ne_u64 vcc, s[56:57], v[22:23]
    s_nop 1
    s_bfe_u64 vcc, vcc, 0x100028
    s_cbranch_scc1 L_miss55
L_back55:
    s_barrier
    ds_read_b128 v[32:35], v17 offset:32768
MB 188,44,108
    buffer_load_dwordx4 a[232:235], v6, s[8:11], s58 offen offset:2048 sc1
LW 4
MB 176,48,112
    ds_read_b128 v[36:39], v17 offset:33792
MB 184,48,116
LW 4
MB 180,52,112
    ds_read_b128 v[40:43], v17 offset:34816
MB 188,52,116
    buffer_load_dwordx4 a[236:239], v6, s[8:11], s58 offen offset:3072 sc1
LW 4
MB 176,56,120
    ds_read_b128 v[44:47], v17 offset:35840
MB 184,56,124
LW 4
MB 180,60,120
    ds_read_b128 v[48:51], v17 offset:36864
MB 188,60,124
LW 4
    v_mfma_f32_16x16x32_bf16 v[192:195], v[32:35], a[0:3], 0
    ds_read_b128 v[52:55], v17 offset:37888
    s_add_u32 m0, s38, 131072
    s_add_u32 s68, s25, 0
    v_mfma_f32_16x16x32_bf16 v[200:203], v[32:35], a[4:7], 0
    buffer_load_dwordx4 v19, s[8:11], s68 offen offset:0 sc1 lds
LW 4
    v_mfma_f32_16x16x32_bf16 v[196:199], v[36:39], a[0:3], 0
    ds_read_b128 v[56:59], v17 offset:38912
    v_mfma_f32_16x16x32_bf16 v[204:207], v[36:39], a[4:7], 0
LW 4
MB 192,40,8
    ds_read_b128 v[60:63], v17 offset:39936
MB 200,40,12
    buffer_load_dwordx4 v19, s[8:11], s68 offen offset:1024 sc1 lds
LW 4
MB 196,44,8
    ds_read_b128 v[32:35], v17 offset:40960
MB 204,44,12
LW 4
MB 192,48,16
    ds_read_b128 v[36:39], v17 offset:41984
MB 200,48,20
    buffer_load_dwordx4 v19, s[8:11], s68 offen offset:2048 sc1 lds
LW 4
MB 196,52,16
    ds_read_b128 v[40:43], v17 offset:43008
MB 204,52,20
LW 4
MB 192,56,24
    ds_read_b128 v[44:47], v17 offset:44032
MB 200,56,28
    buffer_load_dwordx4 v19, s[8:11], s68 offen offset:3072 sc1 lds
LW 4
MB 196,60,24
    ds_read_b128 v[48:51], v17 offset:45056
    s_add_u32 m0, s38, 147456
    s_add_u32 s68, s25, 16384
MB 204,60,28
LW 4
MB 192,32,32
    ds_read_b128 v[52:55], v17 offset:46080
MB 200,32,36
    buffer_load_dwordx4 v19, s[8:11], s68 offen offset:0 sc1 lds
LW 4
MB 196,36,32
    ds_read_b128 v[56:59], v17 offset:47104
MB 204,36,36
LW 4
MB 192,40,40
    ds_read_b128 v[60:63], v17 offset:48128
MB 200,40,44
    buffer_load_dwordx4 v19, s[8:11], s68 offen offset:1024 sc1 lds
LW 4
MB 196,44,40
    ds_read_b128 v[32:35], v17 offset:49152
MB 204,44,44
LW 4
MB 192,48,48
    ds_read_b128 v[36:39], v17 offset:50176
MB 200,48,52
    buffer_load_dwordx4 v19, s[8:11], s68 offen offset:2048 sc1 lds
LW 4
MB 196,52,48
    ds_read_b128 v[40:43], v17 offset:51200
MB 204,52,52
LW 4
MB 192,56,56
    ds_read_b128 v[44:47], v17 offset:52224
MB 200,56,60
    buffer_load_dwordx4 v19, s[8:11], s68 offen offset:3072 sc1 lds
LW 4
MB 196,60,56
    ds_read_b128 v[48:51], v17 offset:53248
MB 204,60,60
LW 4
MB 192,32,64
    ds_read_b128 v[52:55], v17 offset:54272
    s_add_u32 m0, s38, 0
    s_add_u32 s68, s26, 0
MB 200,32,68
    buffer_load_dwordx4 v19, s[8:11], s68 offen offset:0 sc1 lds
LW 4
MB 196,36,64
    ds_read_b128 v[56:59], v17 offset:55296
MB 204,36,68
LW 4
MB 192,40,72
    ds_read_b128 v[60:63], v17 offset:56320
MB 200,40,76
    buffer_load_dwordx4 v19, s[8:11], s68 offen offset:1024 sc1 lds
LW 4
MB 196,44,72
    ds_read_b128 v[32:35], v17 offset:57344
MB 204,44,76
LW 4
MB 192,48,80
    ds_read_b128 v[36:39], v17 offset:58368
MB 200,48,84
    buffer_load_dwordx4 v19, s[8:11], s68 offen offset:2048 sc1 lds
LW 4
MB 196,52,80
    ds_read_b128 v[40:43], v17 offset:59392
MB 204,52,84
LW 4
MB 192,56,88
    ds_read_b128 v[44:47], v17 offset:60416
MB 200,56,92
    buffer_load_dwordx4 v19, s[8:11], s68 offen offset:3072 sc1 lds
LW 4
MB 196,60,88
    ds_read_b128 v[48:51], v17 offset:61440
    s_add_u32 m0, s38, 16384
    s_add_u32 s68, s26, 16384
MB 204,60,92
LW 4
MB 192,32,96
    ds_read_b128 v[52:55], v17 offset:62464
MB 200,32,100
    buffer_load_dwordx4 v19, s[8:11], s68 offen offset:0 sc1 lds
LW 4
MB 196,36,96
    ds_read_b128 v[56:59], v17 offset:63488
MB 204,36,100
LW 4
MB 192,40,104
    ds_read_b128 v[60:63], v17 offset:64512
MB 200,40,108
    buffer_load_dwordx4 v19, s[8:11], s68 offen offset:1024 sc1 lds
LW 4
MB 196,44,104
    s_waitcnt vmcnt(6)
    s_barrier
    ds_read_b128 v[32:35], v18 offset:0
MB 204,44,108
LW 4
MB 192,48,112
    ds_read_b128 v[36:39], v18 offset:1024
MB 200,48,116
    buffer_load_dwordx4 v19, s[8:11], s68 offen offset:2048 sc1 lds
LW 4
MB 196,52,112
    ds_read_b128 v[40:43], v18 offset:2048
MB 204,52,116
LW 4
MB 192,56,120
    ds_read_b128 v[44:47], v18 offset:3072
MB 200,56,124
    buffer_load_dwordx4 v19, s[8:11], s68 offen offset:3072 sc1 lds
LW 4
MB 196,60,120
    ds_read_b128 v[48:51], v18 offset:4096
MB 204,60,124
LW 4
    v_mfma_f32_16x16x32_bf16 v[208:211], v[32:35], a[0:3], 0
    ds_read_b128 v[52:55], v18 offset:5120
    s_add_u32 m0, s38, 32768
    s_add_u32 s68, s20, 32768
    v_mfma_f32_16x16x32_bf16 v[216:219], v[32:35], a[4:7], 0
    buffer_load_dwordx4 v19, s[8:11], s68 offen offset:0 sc1 lds
LW 4
    v_mfma_f32_16x16x32_bf16 v[212:215], v[36:39], a[0:3], 0
    ds_read_b128 v[56:59], v18 offset:6144
    v_mfma_f32_16x16x32_bf16 v[220:223], v[36:39], a[4:7], 0
LW 4
MB 208,40,8
    ds_read_b128 v[60:63], v18 offset:7168
MB 216,40,12
    buffer_load_dwordx4 v19, s[8:11], s68 offen offset:1024 sc1 lds
LW 4
MB 212,44,8
    ds_read_b128 v[32:35], v18 offset:8192
MB 220,44,12
LW 4
MB 208,48,16
    ds_read_b128 v[36:39], v18 offset:9216
MB 216,48,20
    buffer_load_dwordx4 v19, s[8:11], s68 offen offset:2048 sc1 lds
LW 4
MB 212,52,16
    ds_read_b128 v[40:43], v18 offset:10240
MB 220,52,20
LW 4
MB 208,56,24
    ds_read_b128 v[44:47], v18 offset:11264
MB 216,56,28
    buffer_load_dwordx4 v19, s[8:11], s68 offen offset:3072 sc1 lds
LW 4
MB 212,60,24
    ds_read_b128 v[48:51], v18 offset:12288
    s_add_u32 m0, s38, 49152
    s_add_u32 s68, s20, 49152
MB 220,60,28
LW 4
MB 208,32,32
    ds_read_b128 v[52:55], v18 offset:13312
MB 216,32,36
    buffer_load_dwordx4 v19, s[8:11], s68 offen offset:0 sc1 lds
LW 4
MB 212,36,32
    ds_read_b128 v[56:59], v18 offset:14336
MB 220,36,36
LW 4
MB 208,40,40
    ds_read_b128 v[60:63], v18 offset:15360
MB 216,40,44
    buffer_load_dwordx4 v19, s[8:11], s68 offen offset:1024 sc1 lds
LW 4
MB 212,44,40
    ds_read_b128 v[32:35], v18 offset:16384
MB 220,44,44
LW 4
MB 208,48,48
    ds_read_b128 v[36:39], v18 offset:17408
MB 216,48,52
    buffer_load_dwordx4 v19, s[8:11], s68 offen offset:2048 sc1 lds
LW 4
MB 212,52,48
    ds_read_b128 v[40:43], v18 offset:18432
MB 220,52,52
LW 4
MB 208,56,56
    ds_read_b128 v[44:47], v18 offset:19456
MB 216,56,60
    buffer_load_dwordx4 v19, s[8:11], s68 offen offset:3072 sc1 lds
LW 4
MB 212,60,56
    ds_read_b128 v[48:51], v18 offset:20480
MB 220,60,60
LW 4
MB 208,32,64
    ds_read_b128 v[52:55], v18 offset:21504
    s_add_u32 m0, s38, 65536
    s_add_u32 s68, s21, 32768
MB 216,32,68
    buffer_load_dwordx4 v19, s[8:11], s68 offen offset:0 sc1 lds
LW 4
MB 212,36,64
    ds_read_b128 v[56:59], v18 offset:22528
MB 220,36,68
LW 4
MB 208,40,72
    ds_read_b128 v[60:63], v18 offset:23552
MB 216,40,76
    buffer_load_dwordx4 v19, s[8:11], s68 offen offset:1024 sc1 lds
LW 4
MB 212,44,72
    ds_read_b128 v[32:35], v18 offset:24576
MB 220,44,76
LW 4
MB 208,48,80
    ds_read_b128 v[36:39], v18 offset:25600
MB 216,48,84
    buffer_load_dwordx4 v19, s[8:11], s68 offen offset:2048 sc1 lds
LW 4
MB 212,52,80
    ds_read_b128 v[40:43], v18 offset:26624
MB 220,52,84
LW 4
MB 208,56,88
    ds_read_b128 v[44:47], v18 offset:27648
MB 216,56,92
    buffer_load_dwordx4 v19, s[8:11], s68 offen offset:3072 sc1 lds
LW 4
MB 212,60,88
    ds_read_b128 v[48:51], v18 offset:28672
    s_mov_b32 s58, 61440
MB 220,60,92
LW 4
MB 208,32,96
    ds_read_b128 v[52:55], v18 offset:29696
MB 216,32,100
LW 4
MB 212,36,96
    ds_read_b128 v[56:59], v18 offset:30720
MB 220,36,100
    buffer_load_dwordx4 a[240:243], v6, s[8:11], s58 offen offset:0 sc1
LW 4
MB 208,40,104
    ds_read_b128 v[60:63], v18 offset:31744
MB 216,40,108
LW 4
MB 212,44,104
    s_waitcnt vmcnt(13)
    s_barrier
    ds_read_b128 v[32:35], v16 offset:0
MB 220,44,108
    buffer_load_dwordx4 a[244:247], v6, s[8:11], s58 offen offset:1024 sc1
LW 4
MB 208,48,112
    ds_read_b128 v[36:39], v16 offset:1024
MB 216,48,116
LW 4
MB 212,52,112
    ds_read_b128 v[40:43], v16 offset:2048
MB 220,52,116
    buffer_load_dwordx4 a[248:251], v6, s[8:11], s58 offen offset:2048 sc1
LW 4
MB 208,56,120
    ds_read_b128 v[44:47], v16 offset:3072
MB 216,56,124
LW 4
MB 212,60,120
    ds_read_b128 v[48:51], v16 offset:4096
MB 220,60,124
LW 4
    v_mfma_f32_16x16x32_bf16 v[224:227], v[32:35], a[0:3], 0
    ds_read_b128 v[52:55], v16 offset:5120
    s_add_u32 m0, s38, 81920
    s_add_u32 s68, s21, 49152
    v_mfma_f32_16x16x32_bf16 v[232:235], v[32:35], a[4:7], 0
    buffer_load_dwordx4 v19, s[8:11], s68 offen offset:0 sc1 lds
LW 4
    v_mfma_f32_16x16x32_bf16 v[228:231], v[36:39], a[0:3], 0
    ds_read_b128 v[56:59], v16 offset:6144
    v_mfma_f32_16x16x32_bf16 v[236:239], v[36:39], a[4:7], 0
LW 4
MB 224,40,8
    ds_read_b128 v[60:63], v16 offset:7168
MB 232,40,12
LW 4
MB 228,44,8
    ds_read_b128 v[32:35], v16 offset:8192
MB 236,44,12
    buffer_load_dwordx4 v19, s[8:11], s68 offen offset:1024 sc1 lds
LW 4
MB 224,48,16
    ds_read_b128 v[36:39], v16 offset:9216
MB 232,48,20
LW 4
MB 228,52,16
    ds_read_b128 v[40:43], v16 offset:10240
MB 236,52,20
LW 4
MB 224,56,24
    ds_read_b128 v[44:47], v16 offset:11264
MB 232,56,28
    buffer_load_dwordx4 v19, s[8:11], s68 offen offset:2048 sc1 lds
LW 4
MB 228,60,24
    ds_read_b128 v[48:51], v16 offset:12288
MB 236,60,28
LW 4
MB 224,32,32
    ds_read_b128 v[52:55], v16 offset:13312
MB 232,32,36
LW 4
MB 228,36,32
    ds_read_b128 v[56:59], v16 offset:14336
MB 236,36,36
    buffer_load_dwordx4 v19, s[8:11], s68 offen offset:3072 sc1 lds
LW 4
MB 224,40,40
    ds_read_b128 v[60:63], v16 offset:15360
MB 232,40,44
LW 4
MB 228,44,40
    ds_read_b128 v[32:35], v16 offset:16384
MB 236,44,44
LW 4
MB 224,48,48
    ds_read_b128 v[36:39], v16 offset:17408
MB 232,48,52
    buffer_load_dwordx4 a[252:255], v6, s[8:11], s58 offen offset:3072 sc1
LW 4
MB 228,52,48
    ds_read_b128 v[40:43], v16 offset:18432
MB 236,52,52
LW 4
MB 224,56,56
    ds_read_b128 v[44:47], v16 offset:19456
MB 232,56,60
LW 4
MB 228,60,56
    ds_read_b128 v[48:51], v16 offset:20480
MB 236,60,60
LW 4
MB 224,32,64
    ds_read_b128 v[52:55], v16 offset:21504
    s_add_u32 m0, s38, 98304
    s_add_u32 s68, s22, 32768
MB 232,32,68
LW 4
MB 228,36,64
    ds_read_b128 v[56:59], v16 offset:22528
MB 236,36,68
LW 4
MB 224,40,72
    ds_read_b128 v[60:63], v16 offset:23552
MB 232,40,76
    buffer_load_dwordx4 v19, s[8:11], s68 offen offset:0 sc1 lds
LW 4
MB 228,44,72
    ds_read_b128 v[32:35], v16 offset:24576
MB 236,44,76
LW 4
MB 224,48,80
    ds_read_b128 v[36:39], v16 offset:25600
MB 232,48,84
LW 4
MB 228,52,80
    ds_read_b128 v[40:43], v16 offset:26624
MB 236,52,84
LW 4
MB 224,56,88
    ds_read_b128 v[44:47], v16 offset:27648
MB 232,56,92
    buffer_load_dwordx4 v19, s[8:11], s68 offen offset:1024 sc1 lds
LW 4
MB 228,60,88
    ds_read_b128 v[48:51], v16 offset:28672
MB 236,60,92
LW 4
MB 224,32,96
    ds_read_b128 v[52:55], v16 offset:29696
MB 232,32,100
LW 4
MB 228,36,96
    ds_read_b128 v[56:59], v16 offset:30720
MB 236,36,100
LW 4
MB 224,40,104
    ds_read_b128 v[60:63], v16 offset:31744
MB 232,40,108
    buffer_load_dwordx4 v19, s[8:11], s68 offen offset:2048 sc1 lds
LW 4
MB 228,44,104
    s_waitcnt vmcnt(15)
    s_barrier
    ds_read_b128 v[32:35], v16 offset:32768
MB 236,44,108
LW 4
MB 224,48,112
    ds_read_b128 v[36:39], v16 offset:33792
MB 232,48,116
LW 4
MB 228,52,112
    ds_read_b128 v[40:43], v16 offset:34816
MB 236,52,116
LW 4
MB 224,56,120
    ds_read_b128 v[44:47], v16 offset:35840
MB 232,56,124
    buffer_load_dwordx4 v19, s[8:11], s68 offen offset:3072 sc1 lds
LW 4
MB 228,60,120
    ds_read_b128 v[48:51], v16 offset:36864
MB 236,60,124
LW 4
MB 128,32,128
    ds_read_b128 v[52:55], v16 offset:37888
    s_add_u32 m0, s38, 114688
    s_add_u32 s68, s22, 49152
MB 136,32,132
LW 4
MB 132,36,128
    ds_read_b128 v[56:59], v16 offset:38912
MB 140,36,132
LW 4
MB 128,40,136
    ds_read_b128 v[60:63], v16 offset:39936
MB 136,40,140
    buffer_load_dwordx4 v19, s[8:11], s68 offen offset:0 sc1 lds
LW 4
MB 132,44,136
    ds_read_b128 v[32:35], v16 offset:40960
MB 140,44,140
LW 4
MB 128,48,144
    ds_read_b128 v[36:39], v16 offset:41984
MB 136,48,148
LW 4
MB 132,52,144
    ds_read_b128 v[40:43], v16 offset:43008
MB 140,52,148
LW 4
MB 128,56,152
    ds_read_b128 v[44:47], v16 offset:44032
MB 136,56,156
    buffer_load_dwordx4 v19, s[8:11], s68 offen offset:1024 sc1 lds
LW 4
MB 132,60,152
    ds_read_b128 v[48:51], v16 offset:45056
MB 140,60,156
LW 4
MB 128,32,160
    ds_read_b128 v[52:55], v16 offset:46080
MB 136,32,164
LW 4
MB 132,36,160
    ds_read_b128 v[56:59], v16 offset:47104
MB 140,36,164
LW 4
MB 128,40,168
    ds_read_b128 v[60:63], v16 offset:48128
MB 136,40,172
    buffer_load_dwordx4 v19, s[8:11], s68 offen offset:2048 sc1 lds
LW 4
MB 132,44,168
    ds_read_b128 v[32:35], v16 offset:49152
MB 140,44,172
LW 4
MB 128,48,176
    ds_read_b128 v[36:39], v16 offset:50176
MB 136,48,180
LW 4
MB 132,52,176
    ds_read_b128 v[40:43], v16 offset:51200
MB 140,52,180
LW 4
MB 128,56,184
    ds_read_b128 v[44:47], v16 offset:52224
MB 136,56,188
    buffer_load_dwordx4 v19, s[8:11], s68 offen offset:3072 sc1 lds
LW 4
MB 132,60,184
    ds_read_b128 v[48:51], v16 offset:53248
MB 140,60,188
    s_waitcnt vmcnt(8)
LW 4
MB 128,32,192
    ds_read_b128 v[52:55], v16 offset:54272
    s_add_u32 m0, s38, 131072
    s_add_u32 s68, s23, 32768
MB 136,32,196
LW 4
MB 132,36,192
    ds_read_b128 v[56:59], v16 offset:55296
MB 140,36,196
LW 4
MB 128,40,200
    ds_read_b128 v[60:63], v16 offset:56320
MB 136,40,204
    buffer_load_dwordx4 v19, s[8:11], s68 offen offset:0 sc1 lds
LW 4
MB 132,44,200
    ds_read_b128 v[32:35], v16 offset:57344
MB 140,44,204
LW 4
MB 128,48,208
    ds_read_b128 v[36:39], v16 offset:58368
MB 136,48,212
LW 4
MB 132,52,208
    ds_read_b128 v[40:43], v16 offset:59392
MB 140,52,212
LW 4
MB 128,56,216
    ds_read_b128 v[44:47], v16 offset:60416
MB 136,56,220
    buffer_load_dwordx4 v19, s[8:11], s68 offen offset:1024 sc1 lds
LW 4
MB 132,60,216
    ds_read_b128 v[48:51], v16 offset:61440
MB 140,60,220
LW 4
MB 128,32,224
    ds_read_b128 v[52:55], v16 offset:62464
MB 136,32,228
LW 4
MB 132,36,224
    ds_read_b128 v[56:59], v16 offset:63488
MB 140,36,228
LW 4
MB 128,40,232
    ds_read_b128 v[60:63], v16 offset:64512
MB 136,40,236
    buffer_load_dwordx4 v19, s[8:11], s68 offen offset:2048 sc1 lds
LW 4
MB 132,44,232
    s_barrier
    ds_read_b128 v[32:35], v17 offset:0
MB 140,44,236
LW 4
MB 128,48,240
    ds_read_b128 v[36:39], v17 offset:1024
MB 136,48,244
LW 4
MB 132,52,240
    ds_read_b128 v[40:43], v17 offset:2048
MB 140,52,244
LW 4
MB 128,56,248
    ds_read_b128 v[44:47], v17 offset:3072
MB 136,56,252
    buffer_load_dwordx4 v19, s[8:11], s68 offen offset:3072 sc1 lds
LW 4
MB 132,60,248
    ds_read_b128 v[48:51], v17 offset:4096
MB 140,60,252
LW 4
MB 144,32,128
    ds_read_b128 v[52:55], v17 offset:5120
    s_add_u32 m0, s38, 147456
    s_add_u32 s68, s23, 49152
MB 152,32,132
LW 4
MB 148,36,128
    ds_read_b128 v[56:59], v17 offset:6144
MB 156,36,132
LW 4
MB 144,40,136
    ds_read_b128 v[60:63], v17 offset:7168
    s_lshr_b32 s66, s20, 10
MB 152,40,140
    buffer_load_dwordx4 v19, s[8:11], s68 offen offset:0 sc1 lds
LW 4
MB 148,44,136
    ds_read_b128 v[32:35], v17 offset:8192
    s_add_u32 s66, s66, s27
MB 156,44,140
LW 4
MB 144,48,144
    ds_read_b128 v[36:39], v17 offset:9216
    s_add_u32 s67, s66, 114688
MB 152,48,148
LW 4
MB 148,52,144
    ds_read_b128 v[40:43], v17 offset:10240
    v_cvt_pk_bf16_f32 v240, v128, v129
MB 156,52,148
LW 4
MB 144,56,152
    ds_read_b128 v[44:47], v17 offset:11264
    v_cvt_pk_bf16_f32 v241, v130, v131
MB 152,56,156
    buffer_load_dwordx4 v19, s[8:11], s68 offen offset:1024 sc1 lds
LW 4
MB 148,60,152
    ds_read_b128 v[48:51], v17 offset:12288
    v_cvt_pk_bf16_f32 v242, v132, v133
MB 156,60,156
LW 4
MB 144,32,160
    ds_read_b128 v[52:55], v17 offset:13312
    v_cvt_pk_bf16_f32 v243, v134, v135
MB 152,32,164
LW 4
MB 148,36,160
    ds_read_b128 v[56:59], v17 offset:14336
    buffer_store_dwordx4 v[240:243], v20, s[12:15], s66 offen sc1
MB 156,36,164
LW 4
MB 144,40,168
    ds_read_b128 v[60:63], v17 offset:15360
    v_cvt_pk_bf16_f32 v244, v136, v137
MB 152,40,172
    buffer_load_dwordx4 v19, s[8:11], s68 offen offset:2048 sc1 lds
LW 4
MB 148,44,168
    ds_read_b128 v[32:35], v17 offset:16384
    v_cvt_pk_bf16_f32 v245, v138, v139
MB 156,44,172
LW 4
MB 144,48,176
    ds_read_b128 v[36:39], v17 offset:17408
    v_cvt_pk_bf16_f32 v246, v140, v141
MB 152,48,180
LW 4
MB 148,52,176
    ds_read_b128 v[40:43], v17 offset:18432
    v_cvt_pk_bf16_f32 v247, v142, v143
MB 156,52,180
LW 4
MB 144,56,184
    ds_read_b128 v[44:47], v17 offset:19456
    buffer_store_dwordx4 v[244:247], v20, s[12:15], s67 offen sc1
MB 152,56,188
    buffer_load_dwordx4 v19, s[8:11], s68 offen offset:3072 sc1 lds
LW 4
MB 148,60,184
    ds_read_b128 v[48:51], v17 offset:20480
MB 156,60,188
LW 4
MB 144,32,192
    ds_read_b128 v[52:55], v17 offset:21504
    s_add_u32 m0, s38, 0
    s_add_u32 s68, s24, 32768
MB 152,32,196
LW 4
MB 148,36,192
    ds_read_b128 v[56:59], v17 offset:22528
MB 156,36,196
LW 4
MB 144,40,200
    ds_read_b128 v[60:63], v17 offset:23552
MB 152,40,204
    buffer_load_dwordx4 v19, s[8:11], s68 offen offset:0 sc1 lds
LW 4
MB 148,44,200
    ds_read_b128 v[32:35], v17 offset:24576
MB 156,44,204
LW 4
MB 144,48,208
    ds_read_b128 v[36:39], v17 offset:25600
MB 152,48,212
LW 4
MB 148,52,208
    ds_read_b128 v[40:43], v17 offset:26624
MB 156,52,212
LW 4
MB 144,56,216
    ds_read_b128 v[44:47], v17 offset:27648
MB 152,56,220
    buffer_load_dwordx4 v19, s[8:11], s68 offen offset:1024 sc1 lds
LW 4
MB 148,60,216
    ds_read_b128 v[48:51], v17 offset:28672
MB 156,60,220
LW 4
MB 144,32,224
    ds_read_b128 v[52:55], v17 offset:29696
MB 152,32,228
LW 4
MB 148,36,224
    ds_read_b128 v[56:59], v17 offset:30720
MB 156,36,228
LW 4
MB 144,40,232
    ds_read_b128 v[60:63], v17 offset:31744
MB 152,40,236
    buffer_load_dwordx4 v19, s[8:11], s68 offen offset:2048 sc1 lds
LW 4
MB 148,44,232
    s_waitcnt vmcnt(13)
    s_barrier
    ds_read_b128 v[32:35], v17 offset:32768
MB 156,44,236
LW 4
MB 144,48,240
    ds_read_b128 v[36:39], v17 offset:33792
MB 152,48,244
LW 4
MB 148,52,240
    ds_read_b128 v[40:43], v17 offset:34816
MB 156,52,244
LW 4
MB 144,56,248
    ds_read_b128 v[44:47], v17 offset:35840
MB 152,56,252
    buffer_load_dwordx4 v19, s[8:11], s68 offen offset:3072 sc1 lds
LW 4
MB 148,60,248
    ds_read_b128 v[48:51], v17 offset:36864
MB 156,60,252
LW 4
MB 160,32,128
    ds_read_b128 v[52:55], v17 offset:37888
    s_add_u32 m0, s38, 16384
    s_add_u32 s68, s24, 49152
MB 168,32,132
LW 4
MB 164,36,128
    ds_read_b128 v[56:59], v17 offset:38912
MB 172,36,132
LW 4
MB 160,40,136
    ds_read_b128 v[60:63], v17 offset:39936
    s_lshr_b32 s66, s21, 10
MB 168,40,140
    buffer_load_dwordx4 v19, s[8:11], s68 offen offset:0 sc1 lds
LW 4
MB 164,44,136
    ds_read_b128 v[32:35], v17 offset:40960
    s_add_u32 s66, s66, s27
MB 172,44,140
LW 4
MB 160,48,144
    ds_read_b128 v[36:39], v17 offset:41984
    s_add_u32 s67, s66, 114688
MB 168,48,148
LW 4
MB 164,52,144
    ds_read_b128 v[40:43], v17 offset:43008
    v_cvt_pk_bf16_f32 v240, v144, v145
MB 172,52,148
LW 4
MB 160,56,152
    ds_read_b128 v[44:47], v17 offset:44032
    v_cvt_pk_bf16_f32 v241, v146, v147
MB 168,56,156
    buffer_load_dwordx4 v19, s[8:11], s68 offen offset:1024 sc1 lds
LW 4
MB 164,60,152
    ds_read_b128 v[48:51], v17 offset:45056
    v_cvt_pk_bf16_f32 v242, v148, v149
MB 172,60,156
LW 4
MB 160,32,160
    ds_read_b128 v[52:55], v17 offset:46080
    v_cvt_pk_bf16_f32 v243, v150, v151
MB 168,32,164
LW 4
MB 164,36,160
    ds_read_b128 v[56:59], v17 offset:47104
    buffer_store_dwordx4 v[240:243], v20, s[12:15], s66 offen sc1
MB 172,36,164
LW 4
MB 160,40,168
    ds_read_b128 v[60:63], v17 offset:48128
    v_cvt_pk_bf16_f32 v244, v152, v153
MB 168,40,172
    buffer_load_dwordx4 v19, s[8:11], s68 offen offset:2048 sc1 lds
LW 4
MB 164,44,168
    ds_read_b128 v[32:35], v17 offset:49152
    v_cvt_pk_bf16_f32 v245, v154, v155
MB 172,44,172
LW 4
MB 160,48,176
    ds_read_b128 v[36:39], v17 offset:50176
    v_cvt_pk_bf16_f32 v246, v156, v157
MB 168,48,180
LW 4
MB 164,52,176
    ds_read_b128 v[40:43], v17 offset:51200
    v_cvt_pk_bf16_f32 v247, v158, v159
MB 172,52,180
LW 4
MB 160,56,184
    ds_read_b128 v[44:47], v17 offset:52224
    buffer_store_dwordx4 v[244:247], v20, s[12:15], s67 offen sc1
MB 168,56,188
    buffer_load_dwordx4 v19, s[8:11], s68 offen offset:3072 sc1 lds
LW 4
MB 164,60,184
    ds_read_b128 v[48:51], v17 offset:53248
MB 172,60,188
LW 4
MB 160,32,192
    ds_read_b128 v[52:55], v17 offset:54272
    s_add_u32 m0, s38, 32768
    s_add_u32 s68, s25, 32768
MB 168,32,196
LW 4
MB 164,36,192
    ds_read_b128 v[56:59], v17 offset:55296
MB 172,36,196
LW 4
MB 160,40,200
    ds_read_b128 v[60:63], v17 offset:56320
MB 168,40,204
    buffer_load_dwordx4 v19, s[8:11], s68 offen offset:0 sc1 lds
LW 4
MB 164,44,200
    ds_read_b128 v[32:35], v17 offset:57344
MB 172,44,204
LW 4
MB 160,48,208
    ds_read_b128 v[36:39], v17 offset:58368
MB 168,48,212
LW 4
MB 164,52,208
    ds_read_b128 v[40:43], v17 offset:59392
MB 172,52,212
LW 4
MB 160,56,216
    ds_read_b128 v[44:47], v17 offset:60416
MB 168,56,220
    buffer_load_dwordx4 v19, s[8:11], s68 offen offset:1024 sc1 lds
LW 4
MB 164,60,216
    ds_read_b128 v[48:51], v17 offset:61440
MB 172,60,220
LW 4
MB 160,32,224
    ds_read_b128 v[52:55], v17 offset:62464
MB 168,32,228
LW 4
MB 164,36,224
    ds_read_b128 v[56:59], v17 offset:63488
MB 172,36,228
LW 4
MB 160,40,232
    ds_read_b128 v[60:63], v17 offset:64512
MB 168,40,236
    buffer_load_dwordx4 v19, s[8:11], s68 offen offset:2048 sc1 lds
LW 4
MB 164,44,232
    s_waitcnt vmcnt(13)
    s_barrier
    ds_read_b128 v[32:35], v18 offset:0
MB 172,44,236
LW 4
MB 160,48,240
    ds_read_b128 v[36:39], v18 offset:1024
MB 168,48,244
LW 4
MB 164,52,240
    ds_read_b128 v[40:43], v18 offset:2048
MB 172,52,244
LW 4
MB 160,56,248
    ds_read_b128 v[44:47], v18 offset:3072
MB 168,56,252
    buffer_load_dwordx4 v19, s[8:11], s68 offen offset:3072 sc1 lds
LW 4
MB 164,60,248
    ds_read_b128 v[48:51], v18 offset:4096
MB 172,60,252
LW 4
MB 176,32,128
    ds_read_b128 v[52:55], v18 offset:5120
    s_add_u32 m0, s38, 49152
    s_add_u32 s68, s25, 49152
MB 184,32,132
LW 4
MB 180,36,128
    ds_read_b128 v[56:59], v18 offset:6144
MB 188,36,132
LW 4
MB 176,40,136
    ds_read_b128 v[60:63], v18 offset:7168
    s_lshr_b32 s66, s22, 10
MB 184,40,140
    buffer_load_dwordx4 v19, s[8:11], s68 offen offset:0 sc1 lds
LW 4
MB 180,44,136
    ds_read_b128 v[32:35], v18 offset:8192
    s_add_u32 s66, s66, s27
MB 188,44,140
LW 4
MB 176,48,144
    ds_read_b128 v[36:39], v18 offset:9216
    s_add_u32 s67, s66, 114688
MB 184,48,148
LW 4
MB 180,52,144
    ds_read_b128 v[40:43], v18 offset:10240
    v_cvt_pk_bf16_f32 v240, v160, v161
MB 188,52,148
LW 4
MB 176,56,152
    ds_read_b128 v[44:47], v18 offset:11264
    v_cvt_pk_bf16_f32 v241, v162, v163
MB 184,56,156
    buffer_load_dwordx4 v19, s[8:11], s68 offen offset:1024 sc1 lds
LW 4
MB 180,60,152
    ds_read_b128 v[48:51], v18 offset:12288
    v_cvt_pk_bf16_f32 v242, v164, v165
MB 188,60,156
LW 4
MB 176,32,160
    ds_read_b128 v[52:55], v18 offset:13312
    v_cvt_pk_bf16_f32 v243, v166, v167
MB 184,32,164
LW 4
MB 180,36,160
    ds_read_b128 v[56:59], v18 offset:14336
    buffer_store_dwordx4 v[240:243], v20, s[12:15], s66 offen sc1
MB 188,36,164
LW 4
MB 176,40,168
    ds_read_b128 v[60:63], v18 offset:15360
    v_cvt_pk_bf16_f32 v244, v168, v169
MB 184,40,172
    buffer_load_dwordx4 v19, s[8:11], s68 offen offset:2048 sc1 lds
LW 4
MB 180,44,168
    ds_read_b128 v[32:35], v18 offset:16384
    v_cvt_pk_bf16_f32 v245, v170, v171
MB 188,44,172
LW 4
MB 176,48,176
    ds_read_b128 v[36:39], v18 offset:17408
    v_cvt_pk_bf16_f32 v246, v172, v173
MB 184,48,180
LW 4
MB 180,52,176
    ds_read_b128 v[40:43], v18 offset:18432
    v_cvt_pk_bf16_f32 v247, v174, v175
MB 188,52,180
LW 4
MB 176,56,184
    ds_read_b128 v[44:47], v18 offset:19456
    buffer_store_dwordx4 v[244:247], v20, s[12:15], s67 offen sc1
MB 184,56,188
    buffer_load_dwordx4 v19, s[8:11], s68 offen offset:3072 sc1 lds
LW 4
MB 180,60,184
    ds_read_b128 v[48:51], v18 offset:20480
MB 188,60,188
LW 4
MB 176,32,192
    ds_read_b128 v[52:55], v18 offset:21504
    s_add_u32 m0, s38, 65536
    s_add_u32 s68, s26, 32768
MB 184,32,196
LW 4
MB 180,36,192
    ds_read_b128 v[56:59], v18 offset:22528
MB 188,36,196
LW 4
MB 176,40,200
    ds_read_b128 v[60:63], v18 offset:23552
MB 184,40,204
    buffer_load_dwordx4 v19, s[8:11], s68 offen offset:0 sc1 lds
LW 4
MB 180,44,200
    ds_read_b128 v[32:35], v18 offset:24576
MB 188,44,204
LW 4
MB 176,48,208
    ds_read_b128 v[36:39], v18 offset:25600
MB 184,48,212
LW 4
MB 180,52,208
    ds_read_b128 v[40:43], v18 offset:26624
MB 188,52,212
LW 4
MB 176,56,216
    ds_read_b128 v[44:47], v18 offset:27648
MB 184,56,220
    buffer_load_dwordx4 v19, s[8:11], s68 offen offset:1024 sc1 lds
LW 4
MB 180,60,216
    ds_read_b128 v[48:51], v18 offset:28672
MB 188,60,220
LW 4
MB 176,32,224
    ds_read_b128 v[52:55], v18 offset:29696
MB 184,32,228
LW 4
MB 180,36,224
    ds_read_b128 v[56:59], v18 offset:30720
MB 188,36,228
LW 4
MB 176,40,232
    ds_read_b128 v[60:63], v18 offset:31744
MB 184,40,236
    buffer_load_dwordx4 v19, s[8:11], s68 offen offset:2048 sc1 lds
LW 4
MB 180,44,232
    s_waitcnt vmcnt(13)
    s_barrier
    ds_read_b128 v[32:35], v16 offset:0
MB 188,44,236
LW 4
MB 176,48,240
    ds_read_b128 v[36:39], v16 offset:1024
MB 184,48,244
LW 4
MB 180,52,240
    ds_read_b128 v[40:43], v16 offset:2048
MB 188,52,244
LW 4
MB 176,56,248
    ds_read_b128 v[44:47], v16 offset:3072
MB 184,56,252
    buffer_load_dwordx4 v19, s[8:11], s68 offen offset:3072 sc1 lds
LW 4
MB 180,60,248
    ds_read_b128 v[48:51], v16 offset:4096
MB 188,60,252
LW 4
MB 192,32,128
    ds_read_b128 v[52:55], v16 offset:5120
    s_add_u32 m0, s38, 81920
    s_add_u32 s68, s26, 49152
MB 200,32,132
LW 4
MB 196,36,128
    ds_read_b128 v[56:59], v16 offset:6144
MB 204,36,132
LW 4
MB 192,40,136
    ds_read_b128 v[60:63], v16 offset:7168
    s_lshr_b32 s66, s23, 10
MB 200,40,140
    buffer_load_dwordx4 v19, s[8:11], s68 offen offset:0 sc1 lds
LW 4
MB 196,44,136
    ds_read_b128 v[32:35], v16 offset:8192
    s_add_u32 s66, s66, s27
MB 204,44,140
LW 4
MB 192,48,144
    ds_read_b128 v[36:39], v16 offset:9216
    s_add_u32 s67, s66, 114688
MB 200,48,148
LW 4
MB 196,52,144
    ds_read_b128 v[40:43], v16 offset:10240
    v_cvt_pk_bf16_f32 v240, v176, v177
MB 204,52,148
LW 4
MB 192,56,152
    ds_read_b128 v[44:47], v16 offset:11264
    v_cvt_pk_bf16_f32 v241, v178, v179
MB 200,56,156
    buffer_load_dwordx4 v19, s[8:11], s68 offen offset:1024 sc1 lds
LW 4
MB 196,60,152
    ds_read_b128 v[48:51], v16 offset:12288
    v_cvt_pk_bf16_f32 v242, v180, v181
MB 204,60,156
LW 4
MB 192,32,160
    ds_read_b128 v[52:55], v16 offset:13312
    v_cvt_pk_bf16_f32 v243, v182, v183
MB 200,32,164
LW 4
MB 196,36,160
    ds_read_b128 v[56:59], v16 offset:14336
    buffer_store_dwordx4 v[240:243], v20, s[12:15], s66 offen sc1
MB 204,36,164
LW 4
MB 192,40,168
    ds_read_b128 v[60:63], v16 offset:15360
    v_cvt_pk_bf16_f32 v244, v184, v185
MB 200,40,172
    buffer_load_dwordx4 v19, s[8:11], s68 offen offset:2048 sc1 lds
LW 4
MB 196,44,168
    ds_read_b128 v[32:35], v16 offset:16384
    v_cvt_pk_bf16_f32 v245, v186, v187
MB 204,44,172
LW 4
MB 192,48,176
    ds_read_b128 v[36:39], v16 offset:17408
    v_cvt_pk_bf16_f32 v246, v188, v189
MB 200,48,180
LW 4
MB 196,52,176
    ds_read_b128 v[40:43], v16 offset:18432
    v_cvt_pk_bf16_f32 v247, v190, v191
MB 204,52,180
LW 4
MB 192,56,184
    ds_read_b128 v[44:47], v16 offset:19456
    buffer_store_dwordx4 v[244:247], v20, s[12:15], s67 offen sc1
MB 200,56,188
    buffer_load_dwordx4 v19, s[8:11], s68 offen offset:3072 sc1 lds
LW 4
MB 196,60,184
    ds_read_b128 v[48:51], v16 offset:20480
MB 204,60,188
LW 4
MB 192,32,192
    ds_read_b128 v[52:55], v16 offset:21504
MB 200,32,196
LW 4
MB 196,36,192
    ds_read_b128 v[56:59], v16 offset:22528
MB 204,36,196
LW 4
MB 192,40,200
    ds_read_b128 v[60:63], v16 offset:23552
MB 200,40,204
LW 4
MB 196,44,200
    ds_read_b128 v[32:35], v16 offset:24576
MB 204,44,204
LW 4
MB 192,48,208
    ds_read_b128 v[36:39], v16 offset:25600
MB 200,48,212
LW 4
MB 196,52,208
    ds_read_b128 v[40:43], v16 offset:26624
MB 204,52,212
LW 4
MB 192,56,216
    ds_read_b128 v[44:47], v16 offset:27648
MB 200,56,220
LW 4
MB 196,60,216
    ds_read_b128 v[48:51], v16 offset:28672
MB 204,60,220
LW 4
MB 192,32,224
    ds_read_b128 v[52:55], v16 offset:29696
MB 200,32,228
LW 4
MB 196,36,224
    ds_read_b128 v[56:59], v16 offset:30720
MB 204,36,228
LW 4
MB 192,40,232
    ds_read_b128 v[60:63], v16 offset:31744
MB 200,40,236
LW 4
MB 196,44,232
    s_waitcnt vmcnt(10)
    s_barrier
    ds_read_b128 v[32:35], v16 offset:32768
MB 204,44,236
LW 4
MB 192,48,240
    ds_read_b128 v[36:39], v16 offset:33792
MB 200,48,244
LW 4
MB 196,52,240
    ds_read_b128 v[40:43], v16 offset:34816
MB 204,52,244
LW 4
MB 192,56,248
    ds_read_b128 v[44:47], v16 offset:35840
MB 200,56,252
LW 4
MB 196,60,248
    ds_read_b128 v[48:51], v16 offset:36864
MB 204,60,252
LW 4
MB 208,32,128
    ds_read_b128 v[52:55], v16 offset:37888
MB 216,32,132
LW 4
MB 212,36,128
    ds_read_b128 v[56:59], v16 offset:38912
MB 220,36,132
LW 4
MB 208,40,136
    ds_read_b128 v[60:63], v16 offset:39936
    s_lshr_b32 s66, s24, 10
MB 216,40,140
LW 4
MB 212,44,136
    ds_read_b128 v[32:35], v16 offset:40960
    s_add_u32 s66, s66, s27
MB 220,44,140
LW 4
MB 208,48,144
    ds_read_b128 v[36:39], v16 offset:41984
    s_add_u32 s67, s66, 114688
MB 216,48,148
LW 4
MB 212,52,144
    ds_read_b128 v[40:43], v16 offset:43008
    v_cvt_pk_bf16_f32 v240, v192, v193
MB 220,52,148
LW 4
MB 208,56,152
    ds_read_b128 v[44:47], v16 offset:44032
    v_cvt_pk_bf16_f32 v241, v194, v195
MB 216,56,156
LW 4
MB 212,60,152
    ds_read_b128 v[48:51], v16 offset:45056
    v_cvt_pk_bf16_f32 v242, v196, v197
MB 220,60,156
LW 4
MB 208,32,160
    ds_read_b128 v[52:55], v16 offset:46080
    v_cvt_pk_bf16_f32 v243, v198, v199
MB 216,32,164
LW 4
MB 212,36,160
    ds_read_b128 v[56:59], v16 offset:47104
    buffer_store_dwordx4 v[240:243], v20, s[12:15], s66 offen sc1
MB 220,36,164
LW 4
MB 208,40,168
    ds_read_b128 v[60:63], v16 offset:48128
    v_cvt_pk_bf16_f32 v244, v200, v201
MB 216,40,172
LW 4
MB 212,44,168
    ds_read_b128 v[32:35], v16 offset:49152
    v_cvt_pk_bf16_f32 v245, v202, v203
MB 220,44,172
LW 4
MB 208,48,176
    ds_read_b128 v[36:39], v16 offset:50176
    v_cvt_pk_bf16_f32 v246, v204, v205
MB 216,48,180
LW 4
MB 212,52,176
    ds_read_b128 v[40:43], v16 offset:51200
    v_cvt_pk_bf16_f32 v247, v206, v207
MB 220,52,180
LW 4
MB 208,56,184
    ds_read_b128 v[44:47], v16 offset:52224
    buffer_store_dwordx4 v[244:247], v20, s[12:15], s67 offen sc1
MB 216,56,188
LW 4
MB 212,60,184
    ds_read_b128 v[48:51], v16 offset:53248
MB 220,60,188
LW 4
MB 208,32,192
    ds_read_b128 v[52:55], v16 offset:54272
MB 216,32,196
LW 4
MB 212,36,192
    ds_read_b128 v[56:59], v16 offset:55296
MB 220,36,196
LW 4
MB 208,40,200
    ds_read_b128 v[60:63], v16 offset:56320
MB 216,40,204
LW 4
MB 212,44,200
    ds_read_b128 v[32:35], v16 offset:57344
MB 220,44,204
LW 4
MB 208,48,208
    ds_read_b128 v[36:39], v16 offset:58368
MB 216,48,212
LW 4
MB 212,52,208
    ds_read_b128 v[40:43], v16 offset:59392
MB 220,52,212
LW 4
MB 208,56,216
    ds_read_b128 v[44:47], v16 offset:60416
MB 216,56,220
LW 4
MB 212,60,216
    ds_read_b128 v[48:51], v16 offset:61440
MB 220,60,220
LW 4
MB 208,32,224
    ds_read_b128 v[52:55], v16 offset:62464
MB 216,32,228
LW 4
MB 212,36,224
    ds_read_b128 v[56:59], v16 offset:63488
MB 220,36,228
LW 4
MB 208,40,232
    ds_read_b128 v[60:63], v16 offset:64512
MB 216,40,236
LW 4
MB 212,44,232
    s_waitcnt vmcnt(2)
    s_barrier
    ds_read_b128 v[32:35], v17 offset:0
MB 220,44,236
LW 4
MB 208,48,240
    ds_read_b128 v[36:39], v17 offset:1024
MB 216,48,244
LW 4
MB 212,52,240
    ds_read_b128 v[40:43], v17 offset:2048
MB 220,52,244
LW 4
MB 208,56,248
    ds_read_b128 v[44:47], v17 offset:3072
MB 216,56,252
LW 4
MB 212,60,248
    ds_read_b128 v[48:51], v17 offset:4096
MB 220,60,252
LW 4
MB 224,32,128
    ds_read_b128 v[52:55], v17 offset:5120
MB 232,32,132
LW 4
MB 228,36,128
    ds_read_b128 v[56:59], v17 offset:6144
MB 236,36,132
LW 4
MB 224,40,136
    ds_read_b128 v[60:63], v17 offset:7168
    s_lshr_b32 s66, s25, 10
MB 232,40,140
LW 4
MB 228,44,136
    ds_read_b128 v[32:35], v17 offset:8192
    s_add_u32 s66, s66, s27
MB 236,44,140
LW 4
MB 224,48,144
    ds_read_b128 v[36:39], v17 offset:9216
    s_add_u32 s67, s66, 114688
MB 232,48,148
LW 4
MB 228,52,144
    ds_read_b128 v[40:43], v17 offset:10240
    v_cvt_pk_bf16_f32 v240, v208, v209
MB 236,52,148
LW 4
MB 224,56,152
    ds_read_b128 v[44:47], v17 offset:11264
    v_cvt_pk_bf16_f32 v241, v210, v211
MB 232,56,156
LW 4
MB 228,60,152
    ds_read_b128 v[48:51], v17 offset:12288
    v_cvt_pk_bf16_f32 v242, v212, v213
MB 236,60,156
LW 4
MB 224,32,160
    ds_read_b128 v[52:55], v17 offset:13312
    v_cvt_pk_bf16_f32 v243, v214, v215
MB 232,32,164
LW 4
MB 228,36,160
    ds_read_b128 v[56:59], v17 offset:14336
    buffer_store_dwordx4 v[240:243], v20, s[12:15], s66 offen sc1
MB 236,36,164
LW 4
MB 224,40,168
    ds_read_b128 v[60:63], v17 offset:15360
    v_cvt_pk_bf16_f32 v244, v216, v217
MB 232,40,172
LW 4
MB 228,44,168
    ds_read_b128 v[32:35], v17 offset:16384
    v_cvt_pk_bf16_f32 v245, v218, v219
MB 236,44,172
LW 4
MB 224,48,176
    ds_read_b128 v[36:39], v17 offset:17408
    v_cvt_pk_bf16_f32 v246, v220, v221
MB 232,48,180
LW 4
MB 228,52,176
    ds_read_b128 v[40:43], v17 offset:18432
    v_cvt_pk_bf16_f32 v247, v222, v223
MB 236,52,180
LW 4
MB 224,56,184
    ds_read_b128 v[44:47], v17 offset:19456
    buffer_store_dwordx4 v[244:247], v20, s[12:15], s67 offen sc1
MB 232,56,188
LW 4
MB 228,60,184
    ds_read_b128 v[48:51], v17 offset:20480
MB 236,60,188
LW 4
MB 224,32,192
    ds_read_b128 v[52:55], v17 offset:21504
MB 232,32,196
LW 4
MB 228,36,192
    ds_read_b128 v[56:59], v17 offset:22528
MB 236,36,196
LW 4
MB 224,40,200
    ds_read_b128 v[60:63], v17 offset:23552
MB 232,40,204
LW 4
MB 228,44,200
    ds_read_b128 v[32:35], v17 offset:24576
MB 236,44,204
LW 4
MB 224,48,208
    ds_read_b128 v[36:39], v17 offset:25600
MB 232,48,212
LW 4
MB 228,52,208
    ds_read_b128 v[40:43], v17 offset:26624
MB 236,52,212
LW 4
MB 224,56,216
    ds_read_b128 v[44:47], v17 offset:27648
MB 232,56,220
LW 4
MB 228,60,216
    ds_read_b128 v[48:51], v17 offset:28672
MB 236,60,220
LW 4
MB 224,32,224
    ds_read_b128 v[52:55], v17 offset:29696
MB 232,32,228
LW 4
MB 228,36,224
    ds_read_b128 v[56:59], v17 offset:30720
MB 236,36,228
LW 4
MB 224,40,232
    ds_read_b128 v[60:63], v17 offset:31744
MB 232,40,236
LW 4
MB 228,44,232
MB 236,44,236
LW 3
MB 224,48,240
MB 232,48,244
LW 2
MB 228,52,240
MB 236,52,244
LW 1
MB 224,56,248
MB 232,56,252
LW 0
MB 228,60,248
MB 236,60,252
    s_nop 4
    s_lshr_b32 s66, s26, 10
    s_add_u32 s66, s66, s27
    s_add_u32 s67, s66, 114688
    v_cvt_pk_bf16_f32 v240, v224, v225
    v_cvt_pk_bf16_f32 v241, v226, v227
    v_cvt_pk_bf16_f32 v242, v228, v229
    v_cvt_pk_bf16_f32 v243, v230, v231
    buffer_store_dwordx4 v[240:243], v20, s[12:15], s66 offen sc1
    v_cvt_pk_bf16_f32 v244, v232, v233
    v_cvt_pk_bf16_f32 v245, v234, v235
    v_cvt_pk_bf16_f32 v246, v236, v237
    v_cvt_pk_bf16_f32 v247, v238, v239
    buffer_store_dwordx4 v[244:247], v20, s[12:15], s67 offen sc1
L_end:
    s_endpgm
L_miss51:
    s_mov_b32 s39, 4194304
    s_branch L_pld56
L_poll56:
    s_sub_u32 s39, s39, 1
    s_cbranch_scc1 L_end
    s_sleep 1
L_pld56:
    s_bfm_b64 exec, 16, 8
    buffer_load_dwordx2 v[22:23], v21, s[8:11], 0 offen offset:0 sc1
    s_mov_b64 exec, -1
    s_waitcnt vmcnt(0)
L_pchk56:
    v_cmp_ne_u64 vcc, s[56:57], v[22:23]
    s_nop 1
    s_bfe_u64 vcc, vcc, 0x100008
    s_cbranch_scc1 L_poll56
    s_branch L_back51
L_miss53:
    s_mov_b32 s39, 4194304
    s_branch L_pld57
L_poll57:
    s_sub_u32 s39, s39, 1
    s_cbranch_scc1 L_end
    s_sleep 1
L_pld57:
    buffer_load_dwordx2 v[10:11], v3, s[8:11], 0 offen offset:128 sc1
    s_waitcnt vmcnt(0)
L_pchk57:
    v_cmp_ne_u64 vcc, s[56:57], v[10:11]
    s_nop 1
    s_cmp_lg_u64 vcc, 0
    s_cbranch_scc1 L_poll57
    s_branch L_back53
L_miss54:
    s_mov_b32 s39, 4194304
    s_branch L_pld58
L_poll58:
    s_sub_u32 s39, s39, 1
    s_cbranch_scc1 L_end
    s_sleep 1
L_pld58:
    s_bfm_b64 exec, 16, 24
    buffer_load_dwordx2 v[22:23], v21, s[8:11], 0 offen offset:0 sc1
    s_mov_b64 exec, -1
    s_waitcnt vmcnt(0)
L_pchk58:
    v_cmp_ne_u64 vcc, s[56:57], v[22:23]
    s_nop 1
    s_bfe_u64 vcc, vcc, 0x100018
    s_cbranch_scc1 L_poll58
    s_branch L_back54
L_miss55:
    s_mov_b32 s39, 4194304
    s_branch L_pld59
L_poll59:
    s_sub_u32 s39, s39, 1
    s_cbranch_scc1 L_end
    s_sleep 1
L_pld59:
    s_bfm_b64 exec, 16, 40
    buffer_load_dwordx2 v[22:23], v21, s[8:11], 0 offen offset:0 sc1
    s_mov_b64 exec, -1
    s_waitcnt vmcnt(0)
L_pchk59:
    v_cmp_ne_u64 vcc, s[56:57], v[22:23]
    s_nop 1
    s_bfe_u64 vcc, vcc, 0x100028
    s_cbranch_scc1 L_poll59
    s_branch L_back55
L_codeend:
.section .rodata,"a"
.p2align 6
.amdhsa_kernel standalone__weight_only_int_quip__prompt_kernel
  .amdhsa_next_free_vgpr 512
  .amdhsa_next_free_sgpr 102
  .amdhsa_accum_offset 256
  .amdhsa_group_segment_fixed_size 0
  .amdhsa_kernarg_size 72
  .amdhsa_user_sgpr_count 2
  .amdhsa_user_sgpr_kernarg_segment_ptr 1
  .amdhsa_system_sgpr_workgroup_id_x 1
  .amdhsa_float_denorm_mode_32 3
  .amdhsa_float_denorm_mode_16_64 3
.end_amdhsa_kernel
```
